```python
import torch

def _softmax(x, axis=-1):
    return torch.softmax(x, dim=axis)

def _gelu(x):
    return torch.nn.functional.gelu(x, approximate='tanh')

def _silu(x):
    return torch.nn.functional.silu(x)

def _sigmoid(x):
    return torch.sigmoid(x)

def _layernorm(x, axis=-1, eps=1e-05):
    m = x.mean(dim=axis, keepdim=True)
    v = x.var(dim=axis, keepdim=True, unbiased=False)
    return (x - m) / torch.sqrt(v + eps)

def _scatter_add(tgt, idx, src, axis=0):
    return tgt.clone().index_add_(axis, idx, src)

def _segment_sum(src, seg, n):
    out = torch.zeros((n,) + src.shape[1:], dtype=src.dtype)
    return out.index_add_(0, seg, src)

def _pad(x, pw):
    flat = tuple((v for pair in reversed(pw) for v in pair))
    return torch.nn.functional.pad(x, flat)
kernel_name = 'sequential_preLN__grouped_kv_mqa__mixer_gmlp__prompt'

def setup_inputs():

    _w = lambda a: (lambda t: t.to(torch.bfloat16) if t.is_floating_point() else t)(torch.as_tensor(a))

    def _A_setup():
        B, S, D, H = (1, 2048, 512, 32)
        Dh = D // H
        return {'x': _w((lambda *s: torch.randn(*s, dtype=torch.bfloat16) * 0.05)(B, S, D)), 'wq': _w((lambda *s: torch.randn(*s, dtype=torch.bfloat16) * 0.05)(D, H * Dh)), 'wk': _w((lambda *s: torch.randn(*s, dtype=torch.bfloat16) * 0.05)(D, Dh)), 'wv': _w((lambda *s: torch.randn(*s, dtype=torch.bfloat16) * 0.05)(D, Dh)), 'wo': _w((lambda *s: torch.randn(*s, dtype=torch.bfloat16) * 0.05)(H * Dh, D))}
    _A_in = _A_setup()

    def _B_setup():
        B, S, D, F = (1, 2048, 512, 1792)
        Fh = F // 2
        return {'x': _w((lambda *s: torch.randn(*s, dtype=torch.bfloat16) * 0.05)(B, S, D)), 'w_in': _w((lambda *s: torch.randn(*s, dtype=torch.bfloat16) * 0.8)(D, 2 * Fh)), 'w_sp': _w(0.01 * (lambda *s: torch.randn(*s, dtype=torch.bfloat16) * 0.8)(S, S)), 'b_sp': _w(1.0 + 0.01 * (lambda *s: torch.randn(*s, dtype=torch.bfloat16) * 0.05)(S)), 'w_out': _w((lambda *s: torch.randn(*s, dtype=torch.bfloat16) * 0.05)(Fh, D))}
    _B_in = _B_setup()
    return {'A_x': _A_in['x'], 'A_wq': _A_in['wq'], 'A_wk': _A_in['wk'], 'A_wv': _A_in['wv'], 'A_wo': _A_in['wo'], 'B_x': _B_in['x'], 'B_w_in': _B_in['w_in'], 'B_w_sp': _B_in['w_sp'], 'B_b_sp': _B_in['b_sp'], 'B_w_out': _B_in['w_out']}

def reference(A_x, A_wq, A_wk, A_wv, A_wo, B_x, B_w_in, B_w_sp, B_b_sp, B_w_out):

    def _A_ref(x, wq, wk, wv, wo):
        B, S, D = x.shape
        H = 32
        Dh = D // H
        q = (lambda x, *d: x.permute(*d))((x @ wq).reshape(B, S, H, Dh), 0, 2, 1, 3)
        k = x @ wk
        v = x @ wv
        scores = torch.einsum('bhqd,bkd->bhqk', q, k) * Dh ** (-0.5)
        p = _softmax(scores, axis=-1)
        o = torch.einsum('bhqk,bkd->bhqd', p, v)
        return (lambda x, *d: x.permute(*d))(o, 0, 2, 1, 3).reshape(B, S, H * Dh) @ wo

    def _B_ref(x, w_in, w_sp, b_sp, w_out):
        B, S, D = x.shape
        F = w_in.shape[-1]
        Fh = F // 2
        z = _gelu(torch.einsum('bsd,df->bsf', x, w_in))
        z1 = z[..., :Fh].clone()
        z2 = _layernorm(z[..., Fh:], axis=-1)
        g = torch.einsum('ts,bsf->btf', w_sp, z2) + b_sp[None, :, None]
        return torch.einsum('bsf,fd->bsd', z1 * g, w_out)
    x = A_x
    h = x + _A_ref(_layernorm(x, axis=-1), A_wq, A_wk, A_wv, A_wo)
    h2 = h + _B_ref(_layernorm(h, axis=-1), B_w_in, B_w_sp, B_b_sp, B_w_out)
    return h2
```

```asm
; @launch grid=(256,1,1) block=(512,1,1) lds=163840
.amdgcn_target "amdgcn-amd-amdhsa--gfx950"
.text
.globl sequential_preLN__grouped_kv_mqa__mixer_gmlp__prompt_kernel
.p2align 8
.type sequential_preLN__grouped_kv_mqa__mixer_gmlp__prompt_kernel,@function
sequential_preLN__grouped_kv_mqa__mixer_gmlp__prompt_kernel:
    s_cmp_ge_u32 s2, 256
    s_cbranch_scc1 sequential_preLN__grouped_kv_mqa__mixer_gmlp__prompt_kernel_end
    s_load_dwordx16 s[4:19], s[0:1], 0
    s_load_dwordx8 s[20:27], s[0:1], 64
    s_load_dwordx2 s[28:29], s[0:1], 96
    v_lshrrev_b32 v2, 6, v0
    v_and_b32 v1, 63, v0
    v_readfirstlane_b32 s3, v2
    v_lshlrev_b32 v5, 4, v1
    v_lshlrev_b32 v6, 2, v1
    s_and_b32 s30, s2, 7
    s_lshl_b32 s30, s30, 2
    s_lshr_b32 s38, s2, 3
    s_and_b32 s38, s38, 3
    s_add_u32 s30, s30, s38
    s_lshr_b32 s31, s2, 5
    s_and_b32 s38, s3, 3
    s_lshr_b32 s39, s3, 2
    s_getpc_b64 s[40:41]
pc_ref:
    s_cmp_eq_u32 s3, 1
    s_cbranch_scc0 no_codepf
    s_sub_u32 s40, s40, pc_ref-sequential_preLN__grouped_kv_mqa__mixer_gmlp__prompt_kernel
    s_subb_u32 s41, s41, 0
    s_lshr_b32 s32, s2, 3
    s_lshl_b32 s32, s32, 11
    v_add_u32 v2, s32, v5
    v_add_u32 v3, 1024, v2
    s_mov_b32 s32, sequential_preLN__grouped_kv_mqa__mixer_gmlp__prompt_kernel_end-sequential_preLN__grouped_kv_mqa__mixer_gmlp__prompt_kernel-12
    v_min_u32 v2, s32, v2
    v_min_u32 v3, s32, v3
    v_and_b32 v2, 0xfffffffc, v2
    v_and_b32 v3, 0xfffffffc, v3
    global_load_dwordx4 v[252:255], v2, s[40:41]
    global_load_dwordx4 v[248:251], v3, s[40:41]
no_codepf:
    s_waitcnt lgkmcnt(0)
    v_mov_b32 v0, 0
    s_memrealtime s[40:41]
    s_waitcnt lgkmcnt(0)
    v_writelane_b32 v0, s40, 0
    s_memtime s[40:41]
    s_waitcnt lgkmcnt(0)
    v_writelane_b32 v0, s40, 1
    s_mov_b32 s44, s28
    s_and_b32 s45, s29, 0xffff
    s_mov_b32 s46, 50331648
    s_mov_b32 s47, 0x20000
    s_mov_b32 s48, s4
    s_and_b32 s49, s5, 0xffff
    s_mov_b32 s50, 2097152
    s_mov_b32 s51, 0x20000
    s_mov_b32 s52, s6
    s_and_b32 s53, s7, 0xffff
    s_mov_b32 s54, 524288
    s_mov_b32 s55, 0x20000
    s_mov_b32 s56, s26
    s_and_b32 s57, s27, 0xffff
    s_mov_b32 s58, 256
    s_mov_b32 s59, 0x20000
    s_bitcmp1_b32 s31, 0
    s_cselect_b32 s42, s10, s8
    s_cselect_b32 s43, s11, s9
    s_mov_b32 s60, s42
    s_and_b32 s61, s43, 0xffff
    s_mov_b32 s62, 16384
    s_mov_b32 s63, 0x20000
    v_lshrrev_b32 v2, 4, v1
    v_sub_u32 v2, 0, v2
    v_xor_b32 v2, v2, v1
    v_and_b32 v2, 3, v2
    v_lshlrev_b32 v2, 4, v2
    v_lshrrev_b32 v3, 2, v1
    v_lshlrev_b32 v3, 10, v3
    v_add_u32 v128, v2, v3
    s_lshr_b32 s64, s31, 1
    s_cmp_eq_u32 s3, 0
    s_cbranch_scc0 p1_bulk
    s_setprio 3
    s_lshl_b32 s32, s64, 14
    s_lshl_b32 s33, s30, 16
    s_add_u32 s33, s33, s32
    s_mov_b32 m0, 131072
    s_mov_b32 s98, 0
    buffer_load_dwordx4 v5, s[60:63], s98 offen lds
    s_add_u32 m0, s32, 0
    s_add_u32 s98, s33, 0
    buffer_load_dwordx4 v128, s[48:51], s98 offen lds
    s_mov_b32 m0, 132096
    s_mov_b32 s98, 1024
    buffer_load_dwordx4 v5, s[60:63], s98 offen lds
    s_add_u32 m0, s32, 1024
    s_add_u32 s98, s33, 64
    buffer_load_dwordx4 v128, s[48:51], s98 offen lds
    s_mov_b32 m0, 133120
    s_mov_b32 s98, 2048
    buffer_load_dwordx4 v5, s[60:63], s98 offen lds
    s_add_u32 m0, s32, 2048
    s_add_u32 s98, s33, 128
    buffer_load_dwordx4 v128, s[48:51], s98 offen lds
    s_mov_b32 m0, 134144
    s_mov_b32 s98, 3072
    buffer_load_dwordx4 v5, s[60:63], s98 offen lds
    s_add_u32 m0, s32, 3072
    s_add_u32 s98, s33, 192
    buffer_load_dwordx4 v128, s[48:51], s98 offen lds
    s_mov_b32 m0, 135168
    s_mov_b32 s98, 4096
    buffer_load_dwordx4 v5, s[60:63], s98 offen lds
    s_add_u32 m0, s32, 4096
    s_add_u32 s98, s33, 256
    buffer_load_dwordx4 v128, s[48:51], s98 offen lds
    s_mov_b32 m0, 136192
    s_mov_b32 s98, 5120
    buffer_load_dwordx4 v5, s[60:63], s98 offen lds
    s_add_u32 m0, s32, 5120
    s_add_u32 s98, s33, 320
    buffer_load_dwordx4 v128, s[48:51], s98 offen lds
    s_mov_b32 m0, 137216
    s_mov_b32 s98, 6144
    buffer_load_dwordx4 v5, s[60:63], s98 offen lds
    s_add_u32 m0, s32, 6144
    s_add_u32 s98, s33, 384
    buffer_load_dwordx4 v128, s[48:51], s98 offen lds
    s_mov_b32 m0, 138240
    s_mov_b32 s98, 7168
    buffer_load_dwordx4 v5, s[60:63], s98 offen lds
    s_add_u32 m0, s32, 7168
    s_add_u32 s98, s33, 448
    buffer_load_dwordx4 v128, s[48:51], s98 offen lds
    s_mov_b32 m0, 139264
    s_mov_b32 s98, 8192
    buffer_load_dwordx4 v5, s[60:63], s98 offen lds
    s_add_u32 m0, s32, 8192
    s_add_u32 s98, s33, 512
    buffer_load_dwordx4 v128, s[48:51], s98 offen lds
    s_mov_b32 m0, 140288
    s_mov_b32 s98, 9216
    buffer_load_dwordx4 v5, s[60:63], s98 offen lds
    s_add_u32 m0, s32, 9216
    s_add_u32 s98, s33, 576
    buffer_load_dwordx4 v128, s[48:51], s98 offen lds
    s_mov_b32 m0, 141312
    s_mov_b32 s98, 10240
    buffer_load_dwordx4 v5, s[60:63], s98 offen lds
    s_add_u32 m0, s32, 10240
    s_add_u32 s98, s33, 640
    buffer_load_dwordx4 v128, s[48:51], s98 offen lds
    s_mov_b32 m0, 142336
    s_mov_b32 s98, 11264
    buffer_load_dwordx4 v5, s[60:63], s98 offen lds
    s_add_u32 m0, s32, 11264
    s_add_u32 s98, s33, 704
    buffer_load_dwordx4 v128, s[48:51], s98 offen lds
    s_mov_b32 m0, 143360
    s_mov_b32 s98, 12288
    buffer_load_dwordx4 v5, s[60:63], s98 offen lds
    s_add_u32 m0, s32, 12288
    s_add_u32 s98, s33, 768
    buffer_load_dwordx4 v128, s[48:51], s98 offen lds
    s_mov_b32 m0, 144384
    s_mov_b32 s98, 13312
    buffer_load_dwordx4 v5, s[60:63], s98 offen lds
    s_add_u32 m0, s32, 13312
    s_add_u32 s98, s33, 832
    buffer_load_dwordx4 v128, s[48:51], s98 offen lds
    s_mov_b32 m0, 145408
    s_mov_b32 s98, 14336
    buffer_load_dwordx4 v5, s[60:63], s98 offen lds
    s_add_u32 m0, s32, 14336
    s_add_u32 s98, s33, 896
    buffer_load_dwordx4 v128, s[48:51], s98 offen lds
    s_mov_b32 m0, 146432
    s_mov_b32 s98, 15360
    buffer_load_dwordx4 v5, s[60:63], s98 offen lds
    s_add_u32 m0, s32, 15360
    s_add_u32 s98, s33, 960
    buffer_load_dwordx4 v128, s[48:51], s98 offen lds
    s_cmp_eq_u32 s2, 0
    s_cbranch_scc0 p1_nononce
    s_memrealtime s[66:67]
    s_waitcnt lgkmcnt(0)
    s_or_b32 s32, s66, 1
    v_mov_b32 v2, s32
    s_mov_b64 exec, 1
    buffer_store_dword v2, v6, s[56:59], 0 offen sc0 sc1
    s_mov_b64 exec, -1
p1_nononce:
    buffer_load_dword v129, v6, s[56:59], 0 offen sc0 sc1
    s_branch p1_bulkdone
p1_bulk:
    s_cmp_ge_u32 s3, 4
    s_cbranch_scc1 p1_bulkwq
    s_add_u32 s35, s64, s3
    s_and_b32 s35, s35, 3
    s_lshl_b32 s35, s35, 14
    s_lshl_b32 s33, s30, 16
    s_add_u32 s33, s33, s35
    s_add_u32 m0, s35, 0
    s_add_u32 s98, s33, 0
    buffer_load_dwordx4 v128, s[48:51], s98 offen lds
    s_add_u32 m0, s35, 1024
    s_add_u32 s98, s33, 64
    buffer_load_dwordx4 v128, s[48:51], s98 offen lds
    s_add_u32 m0, s35, 2048
    s_add_u32 s98, s33, 128
    buffer_load_dwordx4 v128, s[48:51], s98 offen lds
    s_add_u32 m0, s35, 3072
    s_add_u32 s98, s33, 192
    buffer_load_dwordx4 v128, s[48:51], s98 offen lds
    s_add_u32 m0, s35, 4096
    s_add_u32 s98, s33, 256
    buffer_load_dwordx4 v128, s[48:51], s98 offen lds
    s_add_u32 m0, s35, 5120
    s_add_u32 s98, s33, 320
    buffer_load_dwordx4 v128, s[48:51], s98 offen lds
    s_add_u32 m0, s35, 6144
    s_add_u32 s98, s33, 384
    buffer_load_dwordx4 v128, s[48:51], s98 offen lds
    s_add_u32 m0, s35, 7168
    s_add_u32 s98, s33, 448
    buffer_load_dwordx4 v128, s[48:51], s98 offen lds
    s_add_u32 m0, s35, 8192
    s_add_u32 s98, s33, 512
    buffer_load_dwordx4 v128, s[48:51], s98 offen lds
    s_add_u32 m0, s35, 9216
    s_add_u32 s98, s33, 576
    buffer_load_dwordx4 v128, s[48:51], s98 offen lds
    s_add_u32 m0, s35, 10240
    s_add_u32 s98, s33, 640
    buffer_load_dwordx4 v128, s[48:51], s98 offen lds
    s_add_u32 m0, s35, 11264
    s_add_u32 s98, s33, 704
    buffer_load_dwordx4 v128, s[48:51], s98 offen lds
    s_add_u32 m0, s35, 12288
    s_add_u32 s98, s33, 768
    buffer_load_dwordx4 v128, s[48:51], s98 offen lds
    s_add_u32 m0, s35, 13312
    s_add_u32 s98, s33, 832
    buffer_load_dwordx4 v128, s[48:51], s98 offen lds
    s_add_u32 m0, s35, 14336
    s_add_u32 s98, s33, 896
    buffer_load_dwordx4 v128, s[48:51], s98 offen lds
    s_add_u32 m0, s35, 15360
    s_add_u32 s98, s33, 960
    buffer_load_dwordx4 v128, s[48:51], s98 offen lds
    s_branch p1_bulkdone
p1_bulkwq:
    v_lshrrev_b32 v2, 4, v1
    v_and_b32 v2, 1, v2
    v_lshlrev_b32 v2, 1, v2
    v_and_b32 v3, 7, v1
    v_xor_b32 v2, v2, v3
    v_lshlrev_b32 v2, 4, v2
    v_lshrrev_b32 v3, 3, v1
    v_lshlrev_b32 v3, 10, v3
    v_add_u32 v130, v2, v3
    v_xor_b32 v131, 64, v130
    s_sub_u32 s35, s3, 4
    s_lshl_b32 s32, s31, 7
    s_lshl_b32 s33, s35, 15
    s_add_u32 s32, s32, s33
    s_lshl_b32 s33, s35, 12
    s_add_u32 m0, s33, 65536
    s_add_u32 s98, s32, 0
    buffer_load_dwordx4 v130, s[52:55], s98 offen lds
    s_add_u32 m0, s33, 66560
    s_add_u32 s98, s32, 8192
    buffer_load_dwordx4 v131, s[52:55], s98 offen lds
    s_add_u32 m0, s33, 67584
    s_add_u32 s98, s32, 16384
    buffer_load_dwordx4 v130, s[52:55], s98 offen lds
    s_add_u32 m0, s33, 68608
    s_add_u32 s98, s32, 24576
    buffer_load_dwordx4 v131, s[52:55], s98 offen lds
    s_add_u32 m0, s33, 81920
    s_add_u32 s98, s32, 131072
    buffer_load_dwordx4 v130, s[52:55], s98 offen lds
    s_add_u32 m0, s33, 82944
    s_add_u32 s98, s32, 139264
    buffer_load_dwordx4 v131, s[52:55], s98 offen lds
    s_add_u32 m0, s33, 83968
    s_add_u32 s98, s32, 147456
    buffer_load_dwordx4 v130, s[52:55], s98 offen lds
    s_add_u32 m0, s33, 84992
    s_add_u32 s98, s32, 155648
    buffer_load_dwordx4 v131, s[52:55], s98 offen lds
    s_add_u32 m0, s33, 98304
    s_add_u32 s98, s32, 262144
    buffer_load_dwordx4 v130, s[52:55], s98 offen lds
    s_add_u32 m0, s33, 99328
    s_add_u32 s98, s32, 270336
    buffer_load_dwordx4 v131, s[52:55], s98 offen lds
    s_add_u32 m0, s33, 100352
    s_add_u32 s98, s32, 278528
    buffer_load_dwordx4 v130, s[52:55], s98 offen lds
    s_add_u32 m0, s33, 101376
    s_add_u32 s98, s32, 286720
    buffer_load_dwordx4 v131, s[52:55], s98 offen lds
    s_add_u32 m0, s33, 114688
    s_add_u32 s98, s32, 393216
    buffer_load_dwordx4 v130, s[52:55], s98 offen lds
    s_add_u32 m0, s33, 115712
    s_add_u32 s98, s32, 401408
    buffer_load_dwordx4 v131, s[52:55], s98 offen lds
    s_add_u32 m0, s33, 116736
    s_add_u32 s98, s32, 409600
    buffer_load_dwordx4 v130, s[52:55], s98 offen lds
    s_add_u32 m0, s33, 117760
    s_add_u32 s98, s32, 417792
    buffer_load_dwordx4 v131, s[52:55], s98 offen lds
p1_bulkdone:
    s_lshl_b32 s65, s3, 8
    s_add_u32 s65, s65, s2
    s_lshl_b32 s74, s3, 11
    s_add_u32 s74, s74, 147456
    v_lshrrev_b32 v2, 4, v1
    v_lshrrev_b32 v3, 2, v1
    v_and_b32 v3, 3, v3
    v_and_b32 v4, 3, v1
    s_cmp_ge_u32 s65, 256
    s_cbranch_scc1 prep_in
    s_mov_b32 s68, s12
    s_and_b32 s69, s13, 0xffff
    s_mov_b32 s70, 524288
    s_mov_b32 s71, 0x20000
    s_mov_b32 s66, 1024
    s_lshr_b32 s32, s65, 4
    s_and_b32 s33, s65, 15
    s_lshl_b32 s67, s32, 15
    s_lshl_b32 s34, s33, 6
    s_add_u32 s67, s67, s34
    s_lshl_b32 s72, s33, 15
    s_lshl_b32 s34, s32, 10
    s_add_u32 s72, s72, s34
    s_add_u32 s72, s72, 22020096
    s_mov_b32 s73, 16384
    v_and_b32 v132, 1, v2
    v_lshlrev_b32 v132, 4, v132
    v_add_u32 v132, v132, v3
    v_lshrrev_b32 v2, 1, v2
    v_lshl_add_u32 v132, v2, 2, v132
    v_lshlrev_b32 v132, 6, v132
    v_lshl_add_u32 v132, v4, 4, v132
    s_mov_b32 s75, 512
    s_mov_b32 s76, 8
    s_branch prep_go
prep_in:
    s_cmp_ge_u32 s65, 1152
    s_cbranch_scc1 prep_out
    s_mov_b32 s68, s16
    s_and_b32 s69, s17, 0xffff
    s_mov_b32 s70, 1835008
    s_mov_b32 s71, 0x20000
    s_mov_b32 s66, 3584
    s_sub_u32 s34, s65, 256
    s_and_b32 s32, s34, 15
    s_lshr_b32 s33, s34, 4
    s_mul_i32 s67, s32, 114688
    s_lshl_b32 s34, s33, 6
    s_add_u32 s67, s67, s34
    s_lshl_b32 s72, s33, 15
    s_lshl_b32 s34, s32, 10
    s_add_u32 s72, s72, s34
    s_add_u32 s72, s72, 23068672
    s_mov_b32 s73, 16384
    v_lshl_add_u32 v132, v2, 3, v3
    v_lshlrev_b32 v132, 6, v132
    v_lshl_add_u32 v132, v4, 3, v132
    s_mov_b32 s75, 256
    s_mov_b32 s76, 32
    s_branch prep_go
prep_out:
    s_min_u32 s65, s65, 1663
    s_mov_b32 s68, s22
    s_and_b32 s69, s23, 0xffff
    s_mov_b32 s70, 917504
    s_mov_b32 s71, 0x20000
    s_mov_b32 s66, 1024
    s_sub_u32 s34, s65, 1152
    s_lshr_b32 s32, s34, 4
    s_and_b32 s33, s34, 15
    s_lshr_b32 s67, s32, 2
    s_mul_i32 s67, s67, 112
    s_and_b32 s34, s32, 3
    s_lshl_b32 s34, s34, 5
    s_add_u32 s67, s67, s34
    s_lshl_b32 s67, s67, 10
    s_lshl_b32 s34, s33, 6
    s_add_u32 s67, s67, s34
    s_lshl_b32 s72, s33, 16
    s_lshl_b32 s34, s32, 10
    s_add_u32 s72, s72, s34
    s_add_u32 s72, s72, 47185920
    s_mov_b32 s73, 32768
    v_lshl_add_u32 v132, v2, 2, v3
    v_lshlrev_b32 v132, 6, v132
    v_lshl_add_u32 v132, v4, 4, v132
    s_mov_b32 s75, 1024
    s_mov_b32 s76, 8
prep_go:
    v_lshrrev_b32 v2, 2, v1
    v_mul_lo_u32 v2, v2, s66
    v_and_b32 v3, 3, v1
    v_lshl_add_u32 v133, v3, 4, v2
    s_mov_b32 m0, s74
    s_lshl_b32 s34, s66, 4
    buffer_load_dwordx4 v133, s[68:71], s67 offen lds
    s_add_u32 m0, s74, 1024
    s_add_u32 s67, s67, s34
    buffer_load_dwordx4 v133, s[68:71], s67 offen lds
    v_add_u32 v132, s74, v132
    v_lshrrev_b32 v2, 2, v1
    v_and_b32 v2, 3, v2
    v_sub_u32 v2, 0, v2
    v_lshrrev_b32 v3, 4, v1
    v_xor_b32 v2, v2, v3
    v_and_b32 v2, 3, v2
    v_lshlrev_b32 v2, 4, v2
    v_and_b32 v3, 15, v1
    v_lshlrev_b32 v3, 6, v3
    v_add_u32 v134, v2, v3
    v_lshrrev_b32 v2, 4, v1
    v_lshrrev_b32 v3, 2, v1
    v_and_b32 v3, 3, v3
    v_lshl_add_u32 v4, v2, 3, v3
    v_lshlrev_b32 v136, 7, v4
    v_lshlrev_b32 v135, 5, v4
    v_lshrrev_b32 v3, 1, v3
    v_and_b32 v2, 1, v2
    v_lshl_or_b32 v2, v2, 1, v3
    s_lshl_b32 s32, s39, 1
    v_xor_b32 v2, s32, v2
    v_and_b32 v3, 3, v1
    v_lshlrev_b32 v3, 3, v3
    v_add_u32 v136, v136, v3
    v_add_u32 v135, v135, v3
    v_add_u32 v136, 65536, v136
    v_xor_b32 v3, 1, v2
    v_lshlrev_b32 v2, 5, v2
    v_lshlrev_b32 v3, 5, v3
    v_add_u32 v137, v136, v3
    v_add_u32 v136, v136, v2
    v_add_u32 v135, 131072, v135
    v_mov_b32 v140, 0x3f803f80
    v_mov_b32 v141, 0x3f803f80
    v_mov_b32 v142, 0x3f803f80
    v_mov_b32 v143, 0x3f803f80
    s_lshl_b32 s32, s64, 14
    v_add_u32 v168, s32, v134
    s_lshl_b32 s32, s38, 14
    v_add_u32 v169, s32, v134
    s_memtime s[40:41]
    s_waitcnt lgkmcnt(0)
    v_writelane_b32 v0, s40, 2
    s_cmp_eq_u32 s3, 0
    s_cbranch_scc0 p1_kvdone
    s_waitcnt vmcnt(33)
    ds_read_b128 v[152:155], v168 offset:0
    ds_read_b64_tr_b16 v[160:161], v135 offset:0
    ds_read_b64_tr_b16 v[162:163], v135 offset:128
    s_waitcnt vmcnt(31)
    ds_read_b128 v[156:159], v168 offset:1024
    ds_read_b64_tr_b16 v[164:165], v135 offset:1024
    ds_read_b64_tr_b16 v[166:167], v135 offset:1152
    s_waitcnt lgkmcnt(3)
    v_mfma_f32_16x16x32_bf16 v[144:147], v[160:163], v[152:155], 0
    v_mfma_f32_16x16x32_bf16 v[148:151], v[160:163], v[140:143], 0
    v_dot2_f32_bf16 v138, v152, v140, 0
    v_dot2_f32_bf16 v139, v152, v152, 0
    v_dot2_f32_bf16 v138, v153, v140, v138
    v_dot2_f32_bf16 v139, v153, v153, v139
    v_dot2_f32_bf16 v138, v154, v140, v138
    v_dot2_f32_bf16 v139, v154, v154, v139
    v_dot2_f32_bf16 v138, v155, v140, v138
    v_dot2_f32_bf16 v139, v155, v155, v139
    s_waitcnt vmcnt(29)
    ds_read_b128 v[152:155], v168 offset:2048
    ds_read_b64_tr_b16 v[160:161], v135 offset:2048
    ds_read_b64_tr_b16 v[162:163], v135 offset:2176
    s_waitcnt lgkmcnt(3)
    v_mfma_f32_16x16x32_bf16 v[144:147], v[164:167], v[156:159], v[144:147]
    v_mfma_f32_16x16x32_bf16 v[148:151], v[164:167], v[140:143], v[148:151]
    v_dot2_f32_bf16 v138, v156, v140, v138
    v_dot2_f32_bf16 v139, v156, v156, v139
    v_dot2_f32_bf16 v138, v157, v140, v138
    v_dot2_f32_bf16 v139, v157, v157, v139
    v_dot2_f32_bf16 v138, v158, v140, v138
    v_dot2_f32_bf16 v139, v158, v158, v139
    v_dot2_f32_bf16 v138, v159, v140, v138
    v_dot2_f32_bf16 v139, v159, v159, v139
    s_waitcnt vmcnt(27)
    ds_read_b128 v[156:159], v168 offset:3072
    ds_read_b64_tr_b16 v[164:165], v135 offset:3072
    ds_read_b64_tr_b16 v[166:167], v135 offset:3200
    s_waitcnt lgkmcnt(3)
    v_mfma_f32_16x16x32_bf16 v[144:147], v[160:163], v[152:155], v[144:147]
    v_mfma_f32_16x16x32_bf16 v[148:151], v[160:163], v[140:143], v[148:151]
    v_dot2_f32_bf16 v138, v152, v140, v138
    v_dot2_f32_bf16 v139, v152, v152, v139
    v_dot2_f32_bf16 v138, v153, v140, v138
    v_dot2_f32_bf16 v139, v153, v153, v139
    v_dot2_f32_bf16 v138, v154, v140, v138
    v_dot2_f32_bf16 v139, v154, v154, v139
    v_dot2_f32_bf16 v138, v155, v140, v138
    v_dot2_f32_bf16 v139, v155, v155, v139
    s_waitcnt vmcnt(25)
    ds_read_b128 v[152:155], v168 offset:4096
    ds_read_b64_tr_b16 v[160:161], v135 offset:4096
    ds_read_b64_tr_b16 v[162:163], v135 offset:4224
    s_waitcnt lgkmcnt(3)
    v_mfma_f32_16x16x32_bf16 v[144:147], v[164:167], v[156:159], v[144:147]
    v_mfma_f32_16x16x32_bf16 v[148:151], v[164:167], v[140:143], v[148:151]
    v_dot2_f32_bf16 v138, v156, v140, v138
    v_dot2_f32_bf16 v139, v156, v156, v139
    v_dot2_f32_bf16 v138, v157, v140, v138
    v_dot2_f32_bf16 v139, v157, v157, v139
    v_dot2_f32_bf16 v138, v158, v140, v138
    v_dot2_f32_bf16 v139, v158, v158, v139
    v_dot2_f32_bf16 v138, v159, v140, v138
    v_dot2_f32_bf16 v139, v159, v159, v139
    s_waitcnt vmcnt(23)
    ds_read_b128 v[156:159], v168 offset:5120
    ds_read_b64_tr_b16 v[164:165], v135 offset:5120
    ds_read_b64_tr_b16 v[166:167], v135 offset:5248
    s_waitcnt lgkmcnt(3)
    v_mfma_f32_16x16x32_bf16 v[144:147], v[160:163], v[152:155], v[144:147]
    v_mfma_f32_16x16x32_bf16 v[148:151], v[160:163], v[140:143], v[148:151]
    v_dot2_f32_bf16 v138, v152, v140, v138
    v_dot2_f32_bf16 v139, v152, v152, v139
    v_dot2_f32_bf16 v138, v153, v140, v138
    v_dot2_f32_bf16 v139, v153, v153, v139
    v_dot2_f32_bf16 v138, v154, v140, v138
    v_dot2_f32_bf16 v139, v154, v154, v139
    v_dot2_f32_bf16 v138, v155, v140, v138
    v_dot2_f32_bf16 v139, v155, v155, v139
    s_waitcnt vmcnt(21)
    ds_read_b128 v[152:155], v168 offset:6144
    ds_read_b64_tr_b16 v[160:161], v135 offset:6144
    ds_read_b64_tr_b16 v[162:163], v135 offset:6272
    s_waitcnt lgkmcnt(3)
    v_mfma_f32_16x16x32_bf16 v[144:147], v[164:167], v[156:159], v[144:147]
    v_mfma_f32_16x16x32_bf16 v[148:151], v[164:167], v[140:143], v[148:151]
    v_dot2_f32_bf16 v138, v156, v140, v138
    v_dot2_f32_bf16 v139, v156, v156, v139
    v_dot2_f32_bf16 v138, v157, v140, v138
    v_dot2_f32_bf16 v139, v157, v157, v139
    v_dot2_f32_bf16 v138, v158, v140, v138
    v_dot2_f32_bf16 v139, v158, v158, v139
    v_dot2_f32_bf16 v138, v159, v140, v138
    v_dot2_f32_bf16 v139, v159, v159, v139
    s_waitcnt vmcnt(19)
    ds_read_b128 v[156:159], v168 offset:7168
    ds_read_b64_tr_b16 v[164:165], v135 offset:7168
    ds_read_b64_tr_b16 v[166:167], v135 offset:7296
    s_waitcnt lgkmcnt(3)
    v_mfma_f32_16x16x32_bf16 v[144:147], v[160:163], v[152:155], v[144:147]
    v_mfma_f32_16x16x32_bf16 v[148:151], v[160:163], v[140:143], v[148:151]
    v_dot2_f32_bf16 v138, v152, v140, v138
    v_dot2_f32_bf16 v139, v152, v152, v139
    v_dot2_f32_bf16 v138, v153, v140, v138
    v_dot2_f32_bf16 v139, v153, v153, v139
    v_dot2_f32_bf16 v138, v154, v140, v138
    v_dot2_f32_bf16 v139, v154, v154, v139
    v_dot2_f32_bf16 v138, v155, v140, v138
    v_dot2_f32_bf16 v139, v155, v155, v139
    s_waitcnt vmcnt(17)
    ds_read_b128 v[152:155], v168 offset:8192
    ds_read_b64_tr_b16 v[160:161], v135 offset:8192
    ds_read_b64_tr_b16 v[162:163], v135 offset:8320
    s_waitcnt lgkmcnt(3)
    v_mfma_f32_16x16x32_bf16 v[144:147], v[164:167], v[156:159], v[144:147]
    v_mfma_f32_16x16x32_bf16 v[148:151], v[164:167], v[140:143], v[148:151]
    v_dot2_f32_bf16 v138, v156, v140, v138
    v_dot2_f32_bf16 v139, v156, v156, v139
    v_dot2_f32_bf16 v138, v157, v140, v138
    v_dot2_f32_bf16 v139, v157, v157, v139
    v_dot2_f32_bf16 v138, v158, v140, v138
    v_dot2_f32_bf16 v139, v158, v158, v139
    v_dot2_f32_bf16 v138, v159, v140, v138
    v_dot2_f32_bf16 v139, v159, v159, v139
    s_waitcnt vmcnt(15)
    ds_read_b128 v[156:159], v168 offset:9216
    ds_read_b64_tr_b16 v[164:165], v135 offset:9216
    ds_read_b64_tr_b16 v[166:167], v135 offset:9344
    s_waitcnt lgkmcnt(3)
    v_mfma_f32_16x16x32_bf16 v[144:147], v[160:163], v[152:155], v[144:147]
    v_mfma_f32_16x16x32_bf16 v[148:151], v[160:163], v[140:143], v[148:151]
    v_dot2_f32_bf16 v138, v152, v140, v138
    v_dot2_f32_bf16 v139, v152, v152, v139
    v_dot2_f32_bf16 v138, v153, v140, v138
    v_dot2_f32_bf16 v139, v153, v153, v139
    v_dot2_f32_bf16 v138, v154, v140, v138
    v_dot2_f32_bf16 v139, v154, v154, v139
    v_dot2_f32_bf16 v138, v155, v140, v138
    v_dot2_f32_bf16 v139, v155, v155, v139
    s_waitcnt vmcnt(13)
    ds_read_b128 v[152:155], v168 offset:10240
    ds_read_b64_tr_b16 v[160:161], v135 offset:10240
    ds_read_b64_tr_b16 v[162:163], v135 offset:10368
    s_waitcnt lgkmcnt(3)
    v_mfma_f32_16x16x32_bf16 v[144:147], v[164:167], v[156:159], v[144:147]
    v_mfma_f32_16x16x32_bf16 v[148:151], v[164:167], v[140:143], v[148:151]
    v_dot2_f32_bf16 v138, v156, v140, v138
    v_dot2_f32_bf16 v139, v156, v156, v139
    v_dot2_f32_bf16 v138, v157, v140, v138
    v_dot2_f32_bf16 v139, v157, v157, v139
    v_dot2_f32_bf16 v138, v158, v140, v138
    v_dot2_f32_bf16 v139, v158, v158, v139
    v_dot2_f32_bf16 v138, v159, v140, v138
    v_dot2_f32_bf16 v139, v159, v159, v139
    s_waitcnt vmcnt(11)
    ds_read_b128 v[156:159], v168 offset:11264
    ds_read_b64_tr_b16 v[164:165], v135 offset:11264
    ds_read_b64_tr_b16 v[166:167], v135 offset:11392
    s_waitcnt lgkmcnt(3)
    v_mfma_f32_16x16x32_bf16 v[144:147], v[160:163], v[152:155], v[144:147]
    v_mfma_f32_16x16x32_bf16 v[148:151], v[160:163], v[140:143], v[148:151]
    v_dot2_f32_bf16 v138, v152, v140, v138
    v_dot2_f32_bf16 v139, v152, v152, v139
    v_dot2_f32_bf16 v138, v153, v140, v138
    v_dot2_f32_bf16 v139, v153, v153, v139
    v_dot2_f32_bf16 v138, v154, v140, v138
    v_dot2_f32_bf16 v139, v154, v154, v139
    v_dot2_f32_bf16 v138, v155, v140, v138
    v_dot2_f32_bf16 v139, v155, v155, v139
    s_waitcnt vmcnt(9)
    ds_read_b128 v[152:155], v168 offset:12288
    ds_read_b64_tr_b16 v[160:161], v135 offset:12288
    ds_read_b64_tr_b16 v[162:163], v135 offset:12416
    s_waitcnt lgkmcnt(3)
    v_mfma_f32_16x16x32_bf16 v[144:147], v[164:167], v[156:159], v[144:147]
    v_mfma_f32_16x16x32_bf16 v[148:151], v[164:167], v[140:143], v[148:151]
    v_dot2_f32_bf16 v138, v156, v140, v138
    v_dot2_f32_bf16 v139, v156, v156, v139
    v_dot2_f32_bf16 v138, v157, v140, v138
    v_dot2_f32_bf16 v139, v157, v157, v139
    v_dot2_f32_bf16 v138, v158, v140, v138
    v_dot2_f32_bf16 v139, v158, v158, v139
    v_dot2_f32_bf16 v138, v159, v140, v138
    v_dot2_f32_bf16 v139, v159, v159, v139
    s_waitcnt vmcnt(7)
    ds_read_b128 v[156:159], v168 offset:13312
    ds_read_b64_tr_b16 v[164:165], v135 offset:13312
    ds_read_b64_tr_b16 v[166:167], v135 offset:13440
    s_waitcnt lgkmcnt(3)
    v_mfma_f32_16x16x32_bf16 v[144:147], v[160:163], v[152:155], v[144:147]
    v_mfma_f32_16x16x32_bf16 v[148:151], v[160:163], v[140:143], v[148:151]
    v_dot2_f32_bf16 v138, v152, v140, v138
    v_dot2_f32_bf16 v139, v152, v152, v139
    v_dot2_f32_bf16 v138, v153, v140, v138
    v_dot2_f32_bf16 v139, v153, v153, v139
    v_dot2_f32_bf16 v138, v154, v140, v138
    v_dot2_f32_bf16 v139, v154, v154, v139
    v_dot2_f32_bf16 v138, v155, v140, v138
    v_dot2_f32_bf16 v139, v155, v155, v139
    s_waitcnt vmcnt(5)
    ds_read_b128 v[152:155], v168 offset:14336
    ds_read_b64_tr_b16 v[160:161], v135 offset:14336
    ds_read_b64_tr_b16 v[162:163], v135 offset:14464
    s_waitcnt lgkmcnt(3)
    v_mfma_f32_16x16x32_bf16 v[144:147], v[164:167], v[156:159], v[144:147]
    v_mfma_f32_16x16x32_bf16 v[148:151], v[164:167], v[140:143], v[148:151]
    v_dot2_f32_bf16 v138, v156, v140, v138
    v_dot2_f32_bf16 v139, v156, v156, v139
    v_dot2_f32_bf16 v138, v157, v140, v138
    v_dot2_f32_bf16 v139, v157, v157, v139
    v_dot2_f32_bf16 v138, v158, v140, v138
    v_dot2_f32_bf16 v139, v158, v158, v139
    v_dot2_f32_bf16 v138, v159, v140, v138
    v_dot2_f32_bf16 v139, v159, v159, v139
    s_waitcnt vmcnt(3)
    ds_read_b128 v[156:159], v168 offset:15360
    ds_read_b64_tr_b16 v[164:165], v135 offset:15360
    ds_read_b64_tr_b16 v[166:167], v135 offset:15488
    s_waitcnt lgkmcnt(3)
    v_mfma_f32_16x16x32_bf16 v[144:147], v[160:163], v[152:155], v[144:147]
    v_mfma_f32_16x16x32_bf16 v[148:151], v[160:163], v[140:143], v[148:151]
    v_dot2_f32_bf16 v138, v152, v140, v138
    v_dot2_f32_bf16 v139, v152, v152, v139
    v_dot2_f32_bf16 v138, v153, v140, v138
    v_dot2_f32_bf16 v139, v153, v153, v139
    v_dot2_f32_bf16 v138, v154, v140, v138
    v_dot2_f32_bf16 v139, v154, v154, v139
    v_dot2_f32_bf16 v138, v155, v140, v138
    v_dot2_f32_bf16 v139, v155, v155, v139
    s_waitcnt lgkmcnt(0)
    v_mfma_f32_16x16x32_bf16 v[144:147], v[164:167], v[156:159], v[144:147]
    v_mfma_f32_16x16x32_bf16 v[148:151], v[164:167], v[140:143], v[148:151]
    v_dot2_f32_bf16 v138, v156, v140, v138
    v_dot2_f32_bf16 v139, v156, v156, v139
    v_dot2_f32_bf16 v138, v157, v140, v138
    v_dot2_f32_bf16 v139, v157, v157, v139
    v_dot2_f32_bf16 v138, v158, v140, v138
    v_dot2_f32_bf16 v139, v158, v158, v139
    v_dot2_f32_bf16 v138, v159, v140, v138
    v_dot2_f32_bf16 v139, v159, v159, v139
    s_nop 3
    v_mov_b32 v3, v138
    s_nop 1
    v_permlane16_swap_b32 v138, v3
    v_add_f32 v138, v138, v3
    v_mov_b32 v3, v138
    s_nop 1
    v_permlane32_swap_b32 v138, v3
    v_add_f32 v138, v138, v3
    v_mov_b32 v3, v139
    s_nop 1
    v_permlane16_swap_b32 v139, v3
    v_add_f32 v139, v139, v3
    v_mov_b32 v3, v139
    s_nop 1
    v_permlane32_swap_b32 v139, v3
    v_add_f32 v139, v139, v3
    s_nop 3
    v_mov_b32 v172, v144
    v_mov_b32 v180, v148
    v_mov_b32 v173, v145
    v_mov_b32 v181, v149
    v_mov_b32 v174, v146
    v_mov_b32 v182, v150
    v_mov_b32 v175, v147
    v_mov_b32 v183, v151
    v_mov_b32 v184, v138
    v_mov_b32 v185, v139
    v_mul_f32 v186, 0x3b000000, v184
    v_mul_f32 v185, 0x3b000000, v185
    v_fma_f32 v185, -v186, v186, v185
    v_max_f32 v185, 0, v185
    v_add_f32 v185, 0x3727c5ac, v185
    v_rsq_f32 v187, v185
    s_nop 0
    v_fma_f32 v172, -v186, v180, v172
    v_mul_f32 v172, v187, v172
    v_fma_f32 v173, -v186, v181, v173
    v_mul_f32 v173, v187, v173
    v_fma_f32 v174, -v186, v182, v174
    v_mul_f32 v174, v187, v174
    v_fma_f32 v175, -v186, v183, v175
    v_mul_f32 v175, v187, v175
    v_cvt_pk_bf16_f32 v180, v172, v173
    v_cvt_pk_bf16_f32 v181, v174, v175
    s_lshr_b32 s32, s64, 1
    s_lshl_b32 s33, s30, 1
    s_add_u32 s32, s32, s33
    s_lshl_b32 s32, s32, 10
    s_and_b32 s33, s64, 1
    v_dot2_f32_bf16 v4, v180, v180, 0
    v_dot2_f32_bf16 v176, v181, v181, v4
    s_bitcmp1_b32 s31, 0
    s_cbranch_scc1 p1_vstore
    v_lshrrev_b32 v2, 5, v1
    v_lshlrev_b32 v2, 9, v2
    v_and_b32 v3, 15, v1
    v_lshl_add_u32 v2, v3, 4, v2
    v_lshrrev_b32 v3, 4, v1
    v_and_b32 v3, 1, v3
    v_lshl_add_u32 v2, v3, 3, v2
    s_lshl_b32 s33, s33, 8
    s_add_u32 s32, s32, s33
    s_add_u32 s32, s32, 0
    buffer_store_dwordx2 v[180:181], v2, s[44:47], s32 offen sc0 sc1
    s_mov_b32 s34, 131072
    s_branch p1_kvst
p1_vstore:
    v_lshrrev_b32 v2, 4, v1
    v_lshlrev_b32 v2, 6, v2
    v_lshrrev_b32 v3, 2, v1
    v_and_b32 v3, 1, v3
    v_lshl_add_u32 v2, v3, 8, v2
    v_and_b32 v3, 3, v1
    v_lshl_add_u32 v2, v3, 1, v2
    v_lshrrev_b32 v3, 3, v1
    v_and_b32 v3, 1, v3
    v_lshl_add_u32 v2, v3, 3, v2
    s_lshl_b32 s33, s33, 9
    s_add_u32 s32, s32, s33
    s_add_u32 s32, s32, 65536
    buffer_store_short v180, v2, s[44:47], s32 offen sc0 sc1
    buffer_store_short_d16_hi v180, v2, s[44:47], s32 offen offset:16 sc0 sc1
    buffer_store_short v181, v2, s[44:47], s32 offen offset:32 sc0 sc1
    buffer_store_short_d16_hi v181, v2, s[44:47], s32 offen offset:48 sc0 sc1
    s_mov_b32 s34, 131584
p1_kvst:
    v_mov_b32 v3, v176
    s_nop 1
    v_permlane16_swap_b32 v176, v3
    v_add_f32 v176, v176, v3
    v_mov_b32 v3, v176
    s_nop 1
    v_permlane32_swap_b32 v176, v3
    v_add_f32 v176, v176, v3
    s_nop 1
    v_max_f32_dpp v176, v176, v176 row_ror:8 row_mask:0xf bank_mask:0xf
    s_nop 1
    v_max_f32_dpp v176, v176, v176 row_ror:4 row_mask:0xf bank_mask:0xf
    s_nop 1
    v_max_f32_dpp v176, v176, v176 row_ror:2 row_mask:0xf bank_mask:0xf
    s_nop 1
    v_max_f32_dpp v176, v176, v176 row_ror:1 row_mask:0xf bank_mask:0xf
    s_lshl_b32 s32, s30, 2
    s_add_u32 s32, s32, s64
    s_lshl_b32 s32, s32, 2
    s_add_u32 s32, s32, s34
    s_mov_b64 exec, 1
    buffer_store_dword v176, v6, s[44:47], s32 offen sc0 sc1
    s_mov_b64 exec, -1
    s_setprio 0
p1_kvdone:
    s_waitcnt vmcnt(14)
    s_barrier
    s_memtime s[40:41]
    s_waitcnt lgkmcnt(0)
    v_writelane_b32 v0, s40, 3
    ds_read_b128 v[152:155], v169 offset:0
    ds_read_b64_tr_b16 v[188:189], v136 offset:0
    ds_read_b64_tr_b16 v[190:191], v136 offset:512
    ds_read_b64_tr_b16 v[196:197], v137 offset:0
    ds_read_b64_tr_b16 v[198:199], v137 offset:512
    ds_read_b128 v[156:159], v169 offset:1024
    ds_read_b64_tr_b16 v[192:193], v136 offset:4096
    ds_read_b64_tr_b16 v[194:195], v136 offset:4608
    ds_read_b64_tr_b16 v[200:201], v137 offset:4096
    ds_read_b64_tr_b16 v[202:203], v137 offset:4608
    s_waitcnt lgkmcnt(5)
    v_mfma_f32_16x16x32_bf16 v[172:175], v[188:191], v[152:155], 0
    v_mfma_f32_16x16x32_bf16 v[176:179], v[196:199], v[152:155], 0
    v_mfma_f32_16x16x32_bf16 v[180:183], v[188:191], v[140:143], 0
    v_mfma_f32_16x16x32_bf16 v[184:187], v[196:199], v[140:143], 0
    v_dot2_f32_bf16 v138, v152, v140, 0
    v_dot2_f32_bf16 v139, v152, v152, 0
    v_dot2_f32_bf16 v138, v153, v140, v138
    v_dot2_f32_bf16 v139, v153, v153, v139
    v_dot2_f32_bf16 v138, v154, v140, v138
    v_dot2_f32_bf16 v139, v154, v154, v139
    v_dot2_f32_bf16 v138, v155, v140, v138
    v_dot2_f32_bf16 v139, v155, v155, v139
    ds_read_b128 v[152:155], v169 offset:2048
    ds_read_b64_tr_b16 v[188:189], v136 offset:8192
    ds_read_b64_tr_b16 v[190:191], v136 offset:8704
    ds_read_b64_tr_b16 v[196:197], v137 offset:8192
    ds_read_b64_tr_b16 v[198:199], v137 offset:8704
    s_waitcnt lgkmcnt(5)
    v_mfma_f32_16x16x32_bf16 v[172:175], v[192:195], v[156:159], v[172:175]
    v_mfma_f32_16x16x32_bf16 v[176:179], v[200:203], v[156:159], v[176:179]
    v_mfma_f32_16x16x32_bf16 v[180:183], v[192:195], v[140:143], v[180:183]
    v_mfma_f32_16x16x32_bf16 v[184:187], v[200:203], v[140:143], v[184:187]
    v_dot2_f32_bf16 v138, v156, v140, v138
    v_dot2_f32_bf16 v139, v156, v156, v139
    v_dot2_f32_bf16 v138, v157, v140, v138
    v_dot2_f32_bf16 v139, v157, v157, v139
    v_dot2_f32_bf16 v138, v158, v140, v138
    v_dot2_f32_bf16 v139, v158, v158, v139
    v_dot2_f32_bf16 v138, v159, v140, v138
    v_dot2_f32_bf16 v139, v159, v159, v139
    ds_read_b128 v[156:159], v169 offset:3072
    ds_read_b64_tr_b16 v[192:193], v136 offset:12288
    ds_read_b64_tr_b16 v[194:195], v136 offset:12800
    ds_read_b64_tr_b16 v[200:201], v137 offset:12288
    ds_read_b64_tr_b16 v[202:203], v137 offset:12800
    s_waitcnt lgkmcnt(5)
    v_mfma_f32_16x16x32_bf16 v[172:175], v[188:191], v[152:155], v[172:175]
    v_mfma_f32_16x16x32_bf16 v[176:179], v[196:199], v[152:155], v[176:179]
    v_mfma_f32_16x16x32_bf16 v[180:183], v[188:191], v[140:143], v[180:183]
    v_mfma_f32_16x16x32_bf16 v[184:187], v[196:199], v[140:143], v[184:187]
    v_dot2_f32_bf16 v138, v152, v140, v138
    v_dot2_f32_bf16 v139, v152, v152, v139
    v_dot2_f32_bf16 v138, v153, v140, v138
    v_dot2_f32_bf16 v139, v153, v153, v139
    v_dot2_f32_bf16 v138, v154, v140, v138
    v_dot2_f32_bf16 v139, v154, v154, v139
    v_dot2_f32_bf16 v138, v155, v140, v138
    v_dot2_f32_bf16 v139, v155, v155, v139
    s_waitcnt lgkmcnt(0)
    v_mfma_f32_16x16x32_bf16 v[172:175], v[192:195], v[156:159], v[172:175]
    v_mfma_f32_16x16x32_bf16 v[176:179], v[200:203], v[156:159], v[176:179]
    v_mfma_f32_16x16x32_bf16 v[180:183], v[192:195], v[140:143], v[180:183]
    v_mfma_f32_16x16x32_bf16 v[184:187], v[200:203], v[140:143], v[184:187]
    v_dot2_f32_bf16 v138, v156, v140, v138
    v_dot2_f32_bf16 v139, v156, v156, v139
    v_dot2_f32_bf16 v138, v157, v140, v138
    v_dot2_f32_bf16 v139, v157, v157, v139
    v_dot2_f32_bf16 v138, v158, v140, v138
    v_dot2_f32_bf16 v139, v158, v158, v139
    v_dot2_f32_bf16 v138, v159, v140, v138
    v_dot2_f32_bf16 v139, v159, v159, v139
    s_cmp_eq_u32 s3, 0
    s_cbranch_scc0 p1_noflag
    s_waitcnt vmcnt(0)
    v_readfirstlane_b32 s37, v129
    s_cmp_lg_u32 s37, 0
    s_cbranch_scc1 p1_npoll_ok
    s_mov_b32 s36, 0
p1_npoll:
    buffer_load_dword v129, v6, s[56:59], 0 offen sc0 sc1
    s_waitcnt vmcnt(0)
    v_readfirstlane_b32 s37, v129
    s_add_u32 s36, s36, 1
    s_cmp_lg_u32 s37, 0
    s_cbranch_scc1 p1_npoll_ok
    s_cmp_lt_u32 s36, 40000
    s_cbranch_scc1 p1_npoll
p1_npoll_ok:
    s_lshl_b32 s32, s2, 2
    s_add_u32 s32, s32, 139264
    v_mov_b32 v2, s37
    s_mov_b64 exec, 1
    buffer_store_dword v2, v6, s[44:47], s32 offen sc0 sc1
    s_mov_b64 exec, -1
    v_mov_b32 v2, 138240
    v_mov_b32 v129, s37
    ds_write_b32 v2, v129
    s_waitcnt lgkmcnt(0)
p1_noflag:
    s_waitcnt vmcnt(10)
    s_barrier
    ds_read_b128 v[152:155], v169 offset:4096
    ds_read_b64_tr_b16 v[188:189], v136 offset:16384
    ds_read_b64_tr_b16 v[190:191], v136 offset:16896
    ds_read_b64_tr_b16 v[196:197], v137 offset:16384
    ds_read_b64_tr_b16 v[198:199], v137 offset:16896
    ds_read_b128 v[156:159], v169 offset:5120
    ds_read_b64_tr_b16 v[192:193], v136 offset:20480
    ds_read_b64_tr_b16 v[194:195], v136 offset:20992
    ds_read_b64_tr_b16 v[200:201], v137 offset:20480
    ds_read_b64_tr_b16 v[202:203], v137 offset:20992
    s_waitcnt lgkmcnt(5)
    v_mfma_f32_16x16x32_bf16 v[172:175], v[188:191], v[152:155], v[172:175]
    v_mfma_f32_16x16x32_bf16 v[176:179], v[196:199], v[152:155], v[176:179]
    v_mfma_f32_16x16x32_bf16 v[180:183], v[188:191], v[140:143], v[180:183]
    v_mfma_f32_16x16x32_bf16 v[184:187], v[196:199], v[140:143], v[184:187]
    v_dot2_f32_bf16 v138, v152, v140, v138
    v_dot2_f32_bf16 v139, v152, v152, v139
    v_dot2_f32_bf16 v138, v153, v140, v138
    v_dot2_f32_bf16 v139, v153, v153, v139
    v_dot2_f32_bf16 v138, v154, v140, v138
    v_dot2_f32_bf16 v139, v154, v154, v139
    v_dot2_f32_bf16 v138, v155, v140, v138
    v_dot2_f32_bf16 v139, v155, v155, v139
    ds_read_b128 v[152:155], v169 offset:6144
    ds_read_b64_tr_b16 v[188:189], v136 offset:24576
    ds_read_b64_tr_b16 v[190:191], v136 offset:25088
    ds_read_b64_tr_b16 v[196:197], v137 offset:24576
    ds_read_b64_tr_b16 v[198:199], v137 offset:25088
    s_waitcnt lgkmcnt(5)
    v_mfma_f32_16x16x32_bf16 v[172:175], v[192:195], v[156:159], v[172:175]
    v_mfma_f32_16x16x32_bf16 v[176:179], v[200:203], v[156:159], v[176:179]
    v_mfma_f32_16x16x32_bf16 v[180:183], v[192:195], v[140:143], v[180:183]
    v_mfma_f32_16x16x32_bf16 v[184:187], v[200:203], v[140:143], v[184:187]
    v_dot2_f32_bf16 v138, v156, v140, v138
    v_dot2_f32_bf16 v139, v156, v156, v139
    v_dot2_f32_bf16 v138, v157, v140, v138
    v_dot2_f32_bf16 v139, v157, v157, v139
    v_dot2_f32_bf16 v138, v158, v140, v138
    v_dot2_f32_bf16 v139, v158, v158, v139
    v_dot2_f32_bf16 v138, v159, v140, v138
    v_dot2_f32_bf16 v139, v159, v159, v139
    ds_read_b128 v[156:159], v169 offset:7168
    ds_read_b64_tr_b16 v[192:193], v136 offset:28672
    ds_read_b64_tr_b16 v[194:195], v136 offset:29184
    ds_read_b64_tr_b16 v[200:201], v137 offset:28672
    ds_read_b64_tr_b16 v[202:203], v137 offset:29184
    s_waitcnt lgkmcnt(5)
    v_mfma_f32_16x16x32_bf16 v[172:175], v[188:191], v[152:155], v[172:175]
    v_mfma_f32_16x16x32_bf16 v[176:179], v[196:199], v[152:155], v[176:179]
    v_mfma_f32_16x16x32_bf16 v[180:183], v[188:191], v[140:143], v[180:183]
    v_mfma_f32_16x16x32_bf16 v[184:187], v[196:199], v[140:143], v[184:187]
    v_dot2_f32_bf16 v138, v152, v140, v138
    v_dot2_f32_bf16 v139, v152, v152, v139
    v_dot2_f32_bf16 v138, v153, v140, v138
    v_dot2_f32_bf16 v139, v153, v153, v139
    v_dot2_f32_bf16 v138, v154, v140, v138
    v_dot2_f32_bf16 v139, v154, v154, v139
    v_dot2_f32_bf16 v138, v155, v140, v138
    v_dot2_f32_bf16 v139, v155, v155, v139
    s_waitcnt lgkmcnt(0)
    v_mfma_f32_16x16x32_bf16 v[172:175], v[192:195], v[156:159], v[172:175]
    v_mfma_f32_16x16x32_bf16 v[176:179], v[200:203], v[156:159], v[176:179]
    v_mfma_f32_16x16x32_bf16 v[180:183], v[192:195], v[140:143], v[180:183]
    v_mfma_f32_16x16x32_bf16 v[184:187], v[200:203], v[140:143], v[184:187]
    v_dot2_f32_bf16 v138, v156, v140, v138
    v_dot2_f32_bf16 v139, v156, v156, v139
    v_dot2_f32_bf16 v138, v157, v140, v138
    v_dot2_f32_bf16 v139, v157, v157, v139
    v_dot2_f32_bf16 v138, v158, v140, v138
    v_dot2_f32_bf16 v139, v158, v158, v139
    v_dot2_f32_bf16 v138, v159, v140, v138
    v_dot2_f32_bf16 v139, v159, v159, v139
    s_waitcnt vmcnt(6)
    s_barrier
    ds_read_b128 v[152:155], v169 offset:8192
    ds_read_b64_tr_b16 v[188:189], v136 offset:32768
    ds_read_b64_tr_b16 v[190:191], v136 offset:33280
    ds_read_b64_tr_b16 v[196:197], v137 offset:32768
    ds_read_b64_tr_b16 v[198:199], v137 offset:33280
    ds_read_b128 v[156:159], v169 offset:9216
    ds_read_b64_tr_b16 v[192:193], v136 offset:36864
    ds_read_b64_tr_b16 v[194:195], v136 offset:37376
    ds_read_b64_tr_b16 v[200:201], v137 offset:36864
    ds_read_b64_tr_b16 v[202:203], v137 offset:37376
    s_waitcnt lgkmcnt(5)
    v_mfma_f32_16x16x32_bf16 v[172:175], v[188:191], v[152:155], v[172:175]
    v_mfma_f32_16x16x32_bf16 v[176:179], v[196:199], v[152:155], v[176:179]
    v_mfma_f32_16x16x32_bf16 v[180:183], v[188:191], v[140:143], v[180:183]
    v_mfma_f32_16x16x32_bf16 v[184:187], v[196:199], v[140:143], v[184:187]
    v_dot2_f32_bf16 v138, v152, v140, v138
    v_dot2_f32_bf16 v139, v152, v152, v139
    v_dot2_f32_bf16 v138, v153, v140, v138
    v_dot2_f32_bf16 v139, v153, v153, v139
    v_dot2_f32_bf16 v138, v154, v140, v138
    v_dot2_f32_bf16 v139, v154, v154, v139
    v_dot2_f32_bf16 v138, v155, v140, v138
    v_dot2_f32_bf16 v139, v155, v155, v139
    ds_read_b128 v[152:155], v169 offset:10240
    ds_read_b64_tr_b16 v[188:189], v136 offset:40960
    ds_read_b64_tr_b16 v[190:191], v136 offset:41472
    ds_read_b64_tr_b16 v[196:197], v137 offset:40960
    ds_read_b64_tr_b16 v[198:199], v137 offset:41472
    s_waitcnt lgkmcnt(5)
    v_mfma_f32_16x16x32_bf16 v[172:175], v[192:195], v[156:159], v[172:175]
    v_mfma_f32_16x16x32_bf16 v[176:179], v[200:203], v[156:159], v[176:179]
    v_mfma_f32_16x16x32_bf16 v[180:183], v[192:195], v[140:143], v[180:183]
    v_mfma_f32_16x16x32_bf16 v[184:187], v[200:203], v[140:143], v[184:187]
    v_dot2_f32_bf16 v138, v156, v140, v138
    v_dot2_f32_bf16 v139, v156, v156, v139
    v_dot2_f32_bf16 v138, v157, v140, v138
    v_dot2_f32_bf16 v139, v157, v157, v139
    v_dot2_f32_bf16 v138, v158, v140, v138
    v_dot2_f32_bf16 v139, v158, v158, v139
    v_dot2_f32_bf16 v138, v159, v140, v138
    v_dot2_f32_bf16 v139, v159, v159, v139
    ds_read_b128 v[156:159], v169 offset:11264
    ds_read_b64_tr_b16 v[192:193], v136 offset:45056
    ds_read_b64_tr_b16 v[194:195], v136 offset:45568
    ds_read_b64_tr_b16 v[200:201], v137 offset:45056
    ds_read_b64_tr_b16 v[202:203], v137 offset:45568
    s_waitcnt lgkmcnt(5)
    v_mfma_f32_16x16x32_bf16 v[172:175], v[188:191], v[152:155], v[172:175]
    v_mfma_f32_16x16x32_bf16 v[176:179], v[196:199], v[152:155], v[176:179]
    v_mfma_f32_16x16x32_bf16 v[180:183], v[188:191], v[140:143], v[180:183]
    v_mfma_f32_16x16x32_bf16 v[184:187], v[196:199], v[140:143], v[184:187]
    v_dot2_f32_bf16 v138, v152, v140, v138
    v_dot2_f32_bf16 v139, v152, v152, v139
    v_dot2_f32_bf16 v138, v153, v140, v138
    v_dot2_f32_bf16 v139, v153, v153, v139
    v_dot2_f32_bf16 v138, v154, v140, v138
    v_dot2_f32_bf16 v139, v154, v154, v139
    v_dot2_f32_bf16 v138, v155, v140, v138
    v_dot2_f32_bf16 v139, v155, v155, v139
    s_waitcnt lgkmcnt(0)
    v_mfma_f32_16x16x32_bf16 v[172:175], v[192:195], v[156:159], v[172:175]
    v_mfma_f32_16x16x32_bf16 v[176:179], v[200:203], v[156:159], v[176:179]
    v_mfma_f32_16x16x32_bf16 v[180:183], v[192:195], v[140:143], v[180:183]
    v_mfma_f32_16x16x32_bf16 v[184:187], v[200:203], v[140:143], v[184:187]
    v_dot2_f32_bf16 v138, v156, v140, v138
    v_dot2_f32_bf16 v139, v156, v156, v139
    v_dot2_f32_bf16 v138, v157, v140, v138
    v_dot2_f32_bf16 v139, v157, v157, v139
    v_dot2_f32_bf16 v138, v158, v140, v138
    v_dot2_f32_bf16 v139, v158, v158, v139
    v_dot2_f32_bf16 v138, v159, v140, v138
    v_dot2_f32_bf16 v139, v159, v159, v139
    v_mov_b32 v2, 138240
    ds_read_b32 v3, v2
    s_waitcnt lgkmcnt(0)
    v_readfirstlane_b32 s37, v3
    s_waitcnt vmcnt(2)
    s_barrier
    ds_read_b128 v[152:155], v169 offset:12288
    ds_read_b64_tr_b16 v[188:189], v136 offset:49152
    ds_read_b64_tr_b16 v[190:191], v136 offset:49664
    ds_read_b64_tr_b16 v[196:197], v137 offset:49152
    ds_read_b64_tr_b16 v[198:199], v137 offset:49664
    ds_read_b128 v[156:159], v169 offset:13312
    ds_read_b64_tr_b16 v[192:193], v136 offset:53248
    ds_read_b64_tr_b16 v[194:195], v136 offset:53760
    ds_read_b64_tr_b16 v[200:201], v137 offset:53248
    ds_read_b64_tr_b16 v[202:203], v137 offset:53760
    s_waitcnt lgkmcnt(5)
    v_mfma_f32_16x16x32_bf16 v[172:175], v[188:191], v[152:155], v[172:175]
    v_mfma_f32_16x16x32_bf16 v[176:179], v[196:199], v[152:155], v[176:179]
    v_mfma_f32_16x16x32_bf16 v[180:183], v[188:191], v[140:143], v[180:183]
    v_mfma_f32_16x16x32_bf16 v[184:187], v[196:199], v[140:143], v[184:187]
    v_dot2_f32_bf16 v138, v152, v140, v138
    v_dot2_f32_bf16 v139, v152, v152, v139
    v_dot2_f32_bf16 v138, v153, v140, v138
    v_dot2_f32_bf16 v139, v153, v153, v139
    v_dot2_f32_bf16 v138, v154, v140, v138
    v_dot2_f32_bf16 v139, v154, v154, v139
    v_dot2_f32_bf16 v138, v155, v140, v138
    v_dot2_f32_bf16 v139, v155, v155, v139
    ds_read_b128 v[152:155], v169 offset:14336
    ds_read_b64_tr_b16 v[188:189], v136 offset:57344
    ds_read_b64_tr_b16 v[190:191], v136 offset:57856
    ds_read_b64_tr_b16 v[196:197], v137 offset:57344
    ds_read_b64_tr_b16 v[198:199], v137 offset:57856
    s_waitcnt lgkmcnt(5)
    v_mfma_f32_16x16x32_bf16 v[172:175], v[192:195], v[156:159], v[172:175]
    v_mfma_f32_16x16x32_bf16 v[176:179], v[200:203], v[156:159], v[176:179]
    v_mfma_f32_16x16x32_bf16 v[180:183], v[192:195], v[140:143], v[180:183]
    v_mfma_f32_16x16x32_bf16 v[184:187], v[200:203], v[140:143], v[184:187]
    v_dot2_f32_bf16 v138, v156, v140, v138
    v_dot2_f32_bf16 v139, v156, v156, v139
    v_dot2_f32_bf16 v138, v157, v140, v138
    v_dot2_f32_bf16 v139, v157, v157, v139
    v_dot2_f32_bf16 v138, v158, v140, v138
    v_dot2_f32_bf16 v139, v158, v158, v139
    v_dot2_f32_bf16 v138, v159, v140, v138
    v_dot2_f32_bf16 v139, v159, v159, v139
    ds_read_b128 v[156:159], v169 offset:15360
    ds_read_b64_tr_b16 v[192:193], v136 offset:61440
    ds_read_b64_tr_b16 v[194:195], v136 offset:61952
    ds_read_b64_tr_b16 v[200:201], v137 offset:61440
    ds_read_b64_tr_b16 v[202:203], v137 offset:61952
    s_waitcnt lgkmcnt(5)
    v_mfma_f32_16x16x32_bf16 v[172:175], v[188:191], v[152:155], v[172:175]
    v_mfma_f32_16x16x32_bf16 v[176:179], v[196:199], v[152:155], v[176:179]
    v_mfma_f32_16x16x32_bf16 v[180:183], v[188:191], v[140:143], v[180:183]
    v_mfma_f32_16x16x32_bf16 v[184:187], v[196:199], v[140:143], v[184:187]
    v_dot2_f32_bf16 v138, v152, v140, v138
    v_dot2_f32_bf16 v139, v152, v152, v139
    v_dot2_f32_bf16 v138, v153, v140, v138
    v_dot2_f32_bf16 v139, v153, v153, v139
    v_dot2_f32_bf16 v138, v154, v140, v138
    v_dot2_f32_bf16 v139, v154, v154, v139
    v_dot2_f32_bf16 v138, v155, v140, v138
    v_dot2_f32_bf16 v139, v155, v155, v139
    s_waitcnt lgkmcnt(0)
    v_mfma_f32_16x16x32_bf16 v[172:175], v[192:195], v[156:159], v[172:175]
    v_mfma_f32_16x16x32_bf16 v[176:179], v[200:203], v[156:159], v[176:179]
    v_mfma_f32_16x16x32_bf16 v[180:183], v[192:195], v[140:143], v[180:183]
    v_mfma_f32_16x16x32_bf16 v[184:187], v[200:203], v[140:143], v[184:187]
    v_dot2_f32_bf16 v138, v156, v140, v138
    v_dot2_f32_bf16 v139, v156, v156, v139
    v_dot2_f32_bf16 v138, v157, v140, v138
    v_dot2_f32_bf16 v139, v157, v157, v139
    v_dot2_f32_bf16 v138, v158, v140, v138
    v_dot2_f32_bf16 v139, v158, v158, v139
    v_dot2_f32_bf16 v138, v159, v140, v138
    v_dot2_f32_bf16 v139, v159, v159, v139
    s_memtime s[40:41]
    s_waitcnt lgkmcnt(0)
    v_writelane_b32 v0, s40, 4
    s_nop 2
    v_mov_b32 v3, v138
    s_nop 1
    v_permlane16_swap_b32 v138, v3
    v_add_f32 v138, v138, v3
    v_mov_b32 v3, v138
    s_nop 1
    v_permlane32_swap_b32 v138, v3
    v_add_f32 v138, v138, v3
    v_mov_b32 v3, v139
    s_nop 1
    v_permlane16_swap_b32 v139, v3
    v_add_f32 v139, v139, v3
    v_mov_b32 v3, v139
    s_nop 1
    v_permlane32_swap_b32 v139, v3
    v_add_f32 v139, v139, v3
    v_mul_f32 v170, 0x3b000000, v138
    v_mul_f32 v139, 0x3b000000, v139
    v_fma_f32 v139, -v170, v170, v139
    v_max_f32 v139, 0, v139
    v_add_f32 v139, 0x3727c5ac, v139
    v_rsq_f32 v171, v139
    s_nop 0
    v_mul_f32 v171, 0x3eb8aa3b, v171
    v_fma_f32 v172, -v170, v180, v172
    v_mul_f32 v172, v171, v172
    v_fma_f32 v173, -v170, v181, v173
    v_mul_f32 v173, v171, v173
    v_fma_f32 v174, -v170, v182, v174
    v_mul_f32 v174, v171, v174
    v_fma_f32 v175, -v170, v183, v175
    v_mul_f32 v175, v171, v175
    v_fma_f32 v176, -v170, v184, v176
    v_mul_f32 v176, v171, v176
    v_fma_f32 v177, -v170, v185, v177
    v_mul_f32 v177, v171, v177
    v_fma_f32 v178, -v170, v186, v178
    v_mul_f32 v178, v171, v178
    v_fma_f32 v179, -v170, v187, v179
    v_mul_f32 v179, v171, v179
    v_cvt_pk_bf16_f32 v204, v172, v173
    v_cvt_pk_bf16_f32 v205, v174, v175
    v_cvt_pk_bf16_f32 v206, v176, v177
    v_cvt_pk_bf16_f32 v207, v178, v179
    s_nop 1
    v_permlane16_swap_b32 v204, v206
    v_permlane16_swap_b32 v205, v207
    s_lshl_b32 s32, s3, 10
    s_add_u32 s32, s32, 139264
    v_add_u32 v2, s32, v5
    ds_write_b128 v2, v[204:207]
    s_waitcnt vmcnt(0)
    s_lshl_b32 s32, s3, 8
    s_add_u32 s32, s32, s2
    s_cmp_ge_u32 s32, 1664
    s_cbranch_scc1 prep_skip
    v_add_u32 v208, s75, v132
    ds_read_b64_tr_b16 v[212:213], v132
    ds_read_b64_tr_b16 v[214:215], v208
    v_add_u32 v132, s76, v132
    v_add_u32 v208, s76, v208
    ds_read_b64_tr_b16 v[216:217], v132
    ds_read_b64_tr_b16 v[218:219], v208
    s_waitcnt lgkmcnt(0)
    buffer_store_dwordx4 v[212:215], v5, s[44:47], s72 offen sc0 sc1
    s_add_u32 s72, s72, s73
    buffer_store_dwordx4 v[216:219], v5, s[44:47], s72 offen sc0 sc1
    s_sub_u32 s32, s32, 256
    s_cmp_ge_u32 s32, 896
    s_cbranch_scc1 prep_skip
    v_mov_b32 v209, 0x3f803f80
    v_dot2_f32_bf16 v210, v212, v209, 0
    v_dot2_f32_bf16 v210, v213, v209, v210
    v_dot2_f32_bf16 v210, v214, v209, v210
    v_dot2_f32_bf16 v210, v215, v209, v210
    v_dot2_f32_bf16 v211, v216, v209, 0
    v_dot2_f32_bf16 v211, v217, v209, v211
    v_dot2_f32_bf16 v211, v218, v209, v211
    v_dot2_f32_bf16 v211, v219, v209, v211
    s_nop 2
    v_mov_b32 v220, v210
    s_nop 1
    v_permlane16_swap_b32 v210, v220
    v_add_f32 v210, v210, v220
    v_mov_b32 v220, v210
    s_nop 1
    v_permlane32_swap_b32 v210, v220
    v_add_f32 v210, v210, v220
    v_mov_b32 v220, v211
    s_nop 1
    v_permlane16_swap_b32 v211, v220
    v_add_f32 v211, v211, v220
    v_mov_b32 v220, v211
    s_nop 1
    v_permlane32_swap_b32 v211, v220
    v_add_f32 v211, v211, v220
    s_and_b32 s33, s32, 15
    s_mul_i32 s33, s33, 7168
    s_lshr_b32 s32, s32, 4
    s_lshl_b32 s32, s32, 7
    s_add_u32 s32, s32, s33
    s_add_u32 s32, s32, 48234496
    s_mov_b64 exec, 0xffff
    buffer_store_dword v210, v6, s[44:47], s32 offen sc0 sc1
    buffer_store_dword v211, v6, s[44:47], s32 offen offset:64 sc0 sc1
    s_mov_b64 exec, -1
prep_skip:
    s_lshl_b32 s32, s3, 6
    v_add_u32 v156, s32, v1
    v_and_b32 v2, 31, v156
    v_cmp_eq_u32 vcc, 0, v2
    v_mov_b32 v2, 0x3f803f80
    s_nop 0
    v_cndmask_b32 v152, 0, v2, vcc
    v_cndmask_b32 v153, 0, v2, vcc
    v_cndmask_b32 v154, 0, v2, vcc
    v_cndmask_b32 v155, 0, v2, vcc
    v_lshlrev_b32 v2, 4, v156
    v_add_u32 v2, 131072, v2
    v_cmp_gt_u32 vcc, 354, v156
    s_and_saveexec_b64 s[96:97], vcc
    s_cbranch_execz p1_skipones
    ds_write_b128 v2, v[152:155]
p1_skipones:
    s_mov_b64 exec, s[96:97]
    s_mov_b32 s52, s18
    s_and_b32 s53, s19, 0xffff
    s_mov_b32 s54, 8388608
    s_mov_b32 s55, 0x20000
    s_cmp_eq_u32 s3, 2
    s_cbranch_scc0 p2_nopoll
    s_mov_b32 s32, 139264
    s_mov_b32 s36, 0
p2_poll:
    buffer_load_dwordx4 v[8:11], v5, s[44:47], s32 offen sc0 sc1
    s_waitcnt vmcnt(0)
    v_xor_b32 v8, s37, v8
    v_xor_b32 v9, s37, v9
    v_xor_b32 v10, s37, v10
    v_xor_b32 v11, s37, v11
    v_or_b32 v8, v8, v9
    v_or_b32 v8, v8, v10
    v_or_b32 v8, v8, v11
    v_cmp_ne_u32 vcc, 0, v8
    s_add_u32 s36, s36, 1
    s_cbranch_vccz p2_poll_ok
    s_cmp_lt_u32 s36, 40000
    s_cbranch_scc1 p2_poll
p2_poll_ok:
p2_nopoll:
    s_waitcnt lgkmcnt(0)
    s_barrier
    s_memtime s[40:41]
    s_waitcnt lgkmcnt(0)
    v_writelane_b32 v0, s40, 5
    s_lshr_b32 s32, s3, 2
    s_lshl_b32 s42, s32, 16
    s_lshr_b32 s32, s3, 1
    s_and_b32 s32, s32, 1
    s_lshl_b32 s32, s32, 15
    s_add_u32 s42, s42, s32
    s_and_b32 s32, s3, 1
    s_lshl_b32 s32, s32, 12
    s_add_u32 s42, s42, s32
    s_lshr_b32 s60, s2, 3
    v_lshlrev_b32 v2, 3, v1
    s_mov_b32 s32, 131072
    buffer_load_dwordx2 v[92:93], v2, s[44:47], s32 offen sc0 sc1
    buffer_load_dwordx2 v[94:95], v2, s[44:47], s32 offen offset:512 sc0 sc1
    s_add_u32 s43, s60, 0
    s_and_b32 s43, s43, 3
    s_lshl_b32 s43, s43, 13
    s_add_u32 s43, s43, s42
    s_add_u32 m0, s42, 0
    s_add_u32 s98, s43, 0
    buffer_load_dwordx4 v5, s[44:47], s98 offen sc0 sc1 lds
    s_add_u32 m0, s42, 1024
    s_add_u32 s98, s43, 1024
    buffer_load_dwordx4 v5, s[44:47], s98 offen sc0 sc1 lds
    s_add_u32 m0, s42, 2048
    s_add_u32 s98, s43, 2048
    buffer_load_dwordx4 v5, s[44:47], s98 offen sc0 sc1 lds
    s_add_u32 m0, s42, 3072
    s_add_u32 s98, s43, 3072
    buffer_load_dwordx4 v5, s[44:47], s98 offen sc0 sc1 lds
    s_add_u32 s43, s60, 1
    s_and_b32 s43, s43, 3
    s_lshl_b32 s43, s43, 13
    s_add_u32 s43, s43, s42
    s_add_u32 m0, s42, 8192
    s_add_u32 s98, s43, 0
    buffer_load_dwordx4 v5, s[44:47], s98 offen sc0 sc1 lds
    s_add_u32 m0, s42, 9216
    s_add_u32 s98, s43, 1024
    buffer_load_dwordx4 v5, s[44:47], s98 offen sc0 sc1 lds
    s_add_u32 m0, s42, 10240
    s_add_u32 s98, s43, 2048
    buffer_load_dwordx4 v5, s[44:47], s98 offen sc0 sc1 lds
    s_add_u32 m0, s42, 11264
    s_add_u32 s98, s43, 3072
    buffer_load_dwordx4 v5, s[44:47], s98 offen sc0 sc1 lds
    s_lshl_b32 s32, s38, 10
    s_add_u32 s32, s32, 139264
    v_add_u32 v2, s32, v5
    ds_read_b128 v[12:15], v2
    ds_read_b128 v[16:19], v2 offset:4096
    s_lshl_b32 s32, s39, 15
    v_add_u32 v116, s32, v5
    v_and_b32 v2, 31, v1
    v_lshrrev_b32 v3, 5, v1
    v_lshlrev_b32 v3, 8, v3
    v_lshl_add_u32 v117, v2, 4, v3
    v_add_u32 v117, s32, v117
    v_add_u32 v117, 65536, v117
    v_subrev_u32 v3, 20, v2
    v_cmp_gt_u32 vcc, 8, v3
    v_mov_b32 v3, 131088
    v_mov_b32 v118, 131136
    v_cndmask_b32 v3, v3, v118, vcc
    v_cmp_eq_u32 vcc, 16, v2
    v_mov_b32 v118, 131072
    s_nop 0
    v_cndmask_b32 v3, v3, v118, vcc
    v_cmp_gt_u32 vcc, 16, v2
    v_mov_b32 v118, 4096
    s_nop 0
    v_cndmask_b32 v117, v3, v117, vcc
    v_cndmask_b32 v118, 0, v118, vcc
    v_and_b32 v2, 15, v1
    v_lshlrev_b32 v2, 12, v2
    v_lshrrev_b32 v3, 4, v1
    v_lshl_add_u32 v119, v3, 4, v2
    s_lshr_b32 s61, s2, 3
    s_lshl_b32 s61, s61, 18
    s_lshl_b32 s33, s3, 9
    s_add_u32 s61, s61, s33
    s_lshr_b32 s63, s2, 3
    s_and_b32 s63, s63, 7
    s_lshr_b32 s66, s3, 1
    s_lshl_b32 s66, s66, 15
    s_and_b32 s67, s3, 1
    s_lshl_b32 s67, s67, 13
    s_add_u32 s66, s66, s67
    s_lshl_b32 s67, s31, 16
    s_lshl_b32 s32, s3, 13
    s_add_u32 s67, s67, s32
    s_add_u32 s67, s67, 22020096
    v_mov_b32 v60, 0
    v_mov_b32 v61, 0
    v_mov_b32 v62, 0
    v_mov_b32 v63, 0
    v_mov_b32 v64, 0
    v_mov_b32 v65, 0
    v_mov_b32 v66, 0
    v_mov_b32 v67, 0
    v_mov_b32 v68, 0
    v_mov_b32 v69, 0
    v_mov_b32 v70, 0
    v_mov_b32 v71, 0
    v_mov_b32 v72, 0
    v_mov_b32 v73, 0
    v_mov_b32 v74, 0
    v_mov_b32 v75, 0
    v_mov_b32 v76, 0
    v_mov_b32 v77, 0
    v_mov_b32 v78, 0
    v_mov_b32 v79, 0
    v_mov_b32 v80, 0
    v_mov_b32 v81, 0
    v_mov_b32 v82, 0
    v_mov_b32 v83, 0
    v_mov_b32 v84, 0
    v_mov_b32 v85, 0
    v_mov_b32 v86, 0
    v_mov_b32 v87, 0
    v_mov_b32 v88, 0
    v_mov_b32 v89, 0
    v_mov_b32 v90, 0
    v_mov_b32 v91, 0
    v_mov_b32 v56, 0
    v_mov_b32 v57, 0
    v_mov_b32 v58, 0
    v_mov_b32 v59, 0
    v_mov_b32 v112, 0
    v_mov_b32 v113, 0
    v_mov_b32 v114, 0
    v_mov_b32 v115, 0
    s_waitcnt lgkmcnt(0)
    v_dot2_f32_bf16 v2, v12, v12, 0
    v_dot2_f32_bf16 v2, v13, v13, v2
    v_dot2_f32_bf16 v2, v14, v14, v2
    v_dot2_f32_bf16 v2, v15, v15, v2
    s_nop 2
    v_mov_b32 v3, v2
    s_nop 1
    v_permlane32_swap_b32 v2, v3
    v_add_f32 v2, v2, v3
    v_dot2_f32_bf16 v4, v16, v16, 0
    v_dot2_f32_bf16 v4, v17, v17, v4
    v_dot2_f32_bf16 v4, v18, v18, v4
    v_dot2_f32_bf16 v4, v19, v19, v4
    s_nop 2
    v_mov_b32 v3, v4
    s_nop 1
    v_permlane32_swap_b32 v4, v3
    v_add_f32 v4, v4, v3
    v_max_f32 v120, v2, v4
    s_waitcnt vmcnt(8)
    v_max_f32 v92, v92, v93
    v_max_f32 v94, v94, v95
    s_nop 1
    v_max_f32_dpp v92, v92, v92 row_ror:8 row_mask:0xf bank_mask:0xf
    s_nop 1
    v_max_f32_dpp v92, v92, v92 row_ror:4 row_mask:0xf bank_mask:0xf
    s_nop 1
    v_max_f32_dpp v92, v92, v92 row_ror:2 row_mask:0xf bank_mask:0xf
    s_nop 1
    v_max_f32_dpp v92, v92, v92 row_ror:1 row_mask:0xf bank_mask:0xf
    v_mov_b32 v3, v92
    s_nop 1
    v_permlane16_swap_b32 v92, v3
    v_max_f32 v92, v92, v3
    v_mov_b32 v3, v92
    s_nop 1
    v_permlane32_swap_b32 v92, v3
    v_max_f32 v92, v92, v3
    s_nop 1
    v_max_f32_dpp v94, v94, v94 row_ror:8 row_mask:0xf bank_mask:0xf
    s_nop 1
    v_max_f32_dpp v94, v94, v94 row_ror:4 row_mask:0xf bank_mask:0xf
    s_nop 1
    v_max_f32_dpp v94, v94, v94 row_ror:2 row_mask:0xf bank_mask:0xf
    s_nop 1
    v_max_f32_dpp v94, v94, v94 row_ror:1 row_mask:0xf bank_mask:0xf
    v_mov_b32 v3, v94
    s_nop 1
    v_permlane16_swap_b32 v94, v3
    v_max_f32 v94, v94, v3
    v_mov_b32 v3, v94
    s_nop 1
    v_permlane32_swap_b32 v94, v3
    v_max_f32 v94, v94, v3
    v_mul_f32 v120, v120, v92
    v_mov_b32 v3, 0x44be79e8
    v_cmp_nle_f32 s[94:95], v120, v3
    v_mov_b32 v3, 0x71800000
    v_cmp_nle_f32 vcc, v94, v3
    s_or_b64 vcc, vcc, s[94:95]
    s_cbranch_vccz p2_safe
    v_mov_b32 v2, 136720
    v_mov_b32 v3, 1
    ds_write_b32 v2, v3
p2_safe:
    s_waitcnt vmcnt(4) lgkmcnt(0)
    s_barrier
    v_mov_b32 v2, 136720
    ds_read_b32 v3, v2
    s_cmp_eq_u32 s3, 1
    s_cbranch_scc0 p2_noprepflag
    s_lshl_b32 s32, s2, 2
    s_add_u32 s32, s32, 140288
    v_mov_b32 v4, s37
    s_mov_b64 exec, 1
    buffer_store_dword v4, v6, s[44:47], s32 offen sc0 sc1
    s_mov_b64 exec, -1
p2_noprepflag:
    s_waitcnt lgkmcnt(0)
    v_readfirstlane_b32 s32, v3
    s_memtime s[40:41]
    s_waitcnt lgkmcnt(0)
    v_writelane_b32 v0, s40, 6
    s_cmp_lg_u32 s32, 0
    s_cbranch_scc1 attn_slow
    s_mov_b32 s68, 0
    v_mov_b32 v50, 0
    v_mov_b32 v51, 0
    ds_read_b128 v[92:95], v116
    ds_read_b128 v[100:103], v117
    ds_read_b128 v[104:107], v117 offset:512
    s_waitcnt lgkmcnt(2)
    v_mfma_f32_32x32x16_bf16 v[20:35], v[92:95], v[12:15], 0
    s_nop 11
    v_exp_f32 v20, v20
    v_cvt_pk_bf16_f32 v59, v50, v51
    v_exp_f32 v21, v21
    v_exp_f32 v22, v22
    v_mfma_f32_32x32x16_bf16 v[76:91], v[112:115], v[56:59], v[76:91]
    ds_read_b128 v[96:99], v116 offset:1024
    ds_read_b128 v[108:111], v117 offset:1024
    ds_read_b128 v[112:115], v117 offset:1536
    v_exp_f32 v23, v23
    v_cvt_pk_bf16_f32 v52, v20, v21
    v_exp_f32 v24, v24
    v_exp_f32 v25, v25
    v_cvt_pk_bf16_f32 v53, v22, v23
    v_exp_f32 v26, v26
    v_exp_f32 v27, v27
    v_mfma_f32_32x32x16_bf16 v[36:51], v[92:95], v[16:19], 0
    v_cvt_pk_bf16_f32 v54, v24, v25
    v_exp_f32 v28, v28
    v_exp_f32 v29, v29
    v_cvt_pk_bf16_f32 v55, v26, v27
    v_exp_f32 v30, v30
    v_exp_f32 v31, v31
    v_cvt_pk_bf16_f32 v56, v28, v29
    s_waitcnt lgkmcnt(3)
    v_mfma_f32_32x32x16_bf16 v[60:75], v[100:103], v[52:55], v[60:75]
    v_exp_f32 v32, v32
    v_exp_f32 v33, v33
    v_cvt_pk_bf16_f32 v57, v30, v31
    s_add_u32 s64, s63, 0
    s_and_b32 s64, s64, 7
    s_lshl_b32 s64, s64, 6
    s_add_u32 s64, s64, s61
    buffer_load_dwordx4 v[128:131], v119, s[52:55], s64 offen
    v_exp_f32 v34, v34
    v_exp_f32 v35, v35
    v_cvt_pk_bf16_f32 v58, v32, v33
    v_exp_f32 v36, v36
    v_cvt_pk_bf16_f32 v59, v34, v35
    v_exp_f32 v37, v37
    v_exp_f32 v38, v38
    v_mfma_f32_32x32x16_bf16 v[60:75], v[104:107], v[56:59], v[60:75]
    v_exp_f32 v39, v39
    v_cvt_pk_bf16_f32 v52, v36, v37
    v_exp_f32 v40, v40
    v_exp_f32 v41, v41
    v_cvt_pk_bf16_f32 v53, v38, v39
    v_exp_f32 v42, v42
    v_exp_f32 v43, v43
    s_waitcnt lgkmcnt(2)
    v_mfma_f32_32x32x16_bf16 v[20:35], v[96:99], v[12:15], 0
    v_cvt_pk_bf16_f32 v54, v40, v41
    v_exp_f32 v44, v44
    v_exp_f32 v45, v45
    v_cvt_pk_bf16_f32 v55, v42, v43
    v_exp_f32 v46, v46
    v_exp_f32 v47, v47
    v_cvt_pk_bf16_f32 v56, v44, v45
    v_mfma_f32_32x32x16_bf16 v[76:91], v[100:103], v[52:55], v[76:91]
    v_exp_f32 v48, v48
    v_exp_f32 v49, v49
    v_cvt_pk_bf16_f32 v57, v46, v47
    s_add_u32 s43, s60, 2
    s_and_b32 s43, s43, 3
    s_lshl_b32 s43, s43, 13
    s_add_u32 s43, s43, s42
    s_add_u32 m0, s42, 16384
    s_add_u32 s98, s43, 0
    buffer_load_dwordx4 v5, s[44:47], s98 offen sc0 sc1 lds
    s_add_u32 m0, s42, 17408
    s_add_u32 s98, s43, 1024
    buffer_load_dwordx4 v5, s[44:47], s98 offen sc0 sc1 lds
    s_add_u32 m0, s42, 18432
    s_add_u32 s98, s43, 2048
    buffer_load_dwordx4 v5, s[44:47], s98 offen sc0 sc1 lds
    s_add_u32 m0, s42, 19456
    s_add_u32 s98, s43, 3072
    buffer_load_dwordx4 v5, s[44:47], s98 offen sc0 sc1 lds
    s_add_u32 s64, s63, 1
    s_and_b32 s64, s64, 7
    s_lshl_b32 s64, s64, 6
    s_add_u32 s64, s64, s61
    buffer_load_dwordx4 v[132:135], v119, s[52:55], s64 offen
    v_exp_f32 v50, v50
    v_exp_f32 v51, v51
    v_cvt_pk_bf16_f32 v58, v48, v49
    v_exp_f32 v20, v20
    v_cvt_pk_bf16_f32 v59, v50, v51
    v_exp_f32 v21, v21
    v_exp_f32 v22, v22
    v_mfma_f32_32x32x16_bf16 v[76:91], v[104:107], v[56:59], v[76:91]
    ds_read_b128 v[92:95], v116 offset:2048
    ds_read_b128 v[100:103], v117 offset:2048
    ds_read_b128 v[104:107], v117 offset:2560
    v_exp_f32 v23, v23
    v_cvt_pk_bf16_f32 v52, v20, v21
    v_exp_f32 v24, v24
    v_exp_f32 v25, v25
    v_cvt_pk_bf16_f32 v53, v22, v23
    v_exp_f32 v26, v26
    v_exp_f32 v27, v27
    v_mfma_f32_32x32x16_bf16 v[36:51], v[96:99], v[16:19], 0
    v_cvt_pk_bf16_f32 v54, v24, v25
    v_exp_f32 v28, v28
    v_exp_f32 v29, v29
    v_cvt_pk_bf16_f32 v55, v26, v27
    v_exp_f32 v30, v30
    v_exp_f32 v31, v31
    v_cvt_pk_bf16_f32 v56, v28, v29
    s_waitcnt lgkmcnt(3)
    v_mfma_f32_32x32x16_bf16 v[60:75], v[108:111], v[52:55], v[60:75]
    v_exp_f32 v32, v32
    v_exp_f32 v33, v33
    v_cvt_pk_bf16_f32 v57, v30, v31
    s_add_u32 s64, s63, 2
    s_and_b32 s64, s64, 7
    s_lshl_b32 s64, s64, 6
    s_add_u32 s64, s64, s61
    buffer_load_dwordx4 v[136:139], v119, s[52:55], s64 offen
    v_exp_f32 v34, v34
    v_exp_f32 v35, v35
    v_cvt_pk_bf16_f32 v58, v32, v33
    v_exp_f32 v36, v36
    v_cvt_pk_bf16_f32 v59, v34, v35
    v_exp_f32 v37, v37
    v_exp_f32 v38, v38
    v_mfma_f32_32x32x16_bf16 v[60:75], v[112:115], v[56:59], v[60:75]
    v_exp_f32 v39, v39
    v_cvt_pk_bf16_f32 v52, v36, v37
    v_exp_f32 v40, v40
    v_exp_f32 v41, v41
    v_cvt_pk_bf16_f32 v53, v38, v39
    v_exp_f32 v42, v42
    v_exp_f32 v43, v43
    s_waitcnt lgkmcnt(2)
    v_mfma_f32_32x32x16_bf16 v[20:35], v[92:95], v[12:15], 0
    v_cvt_pk_bf16_f32 v54, v40, v41
    v_exp_f32 v44, v44
    v_exp_f32 v45, v45
    v_cvt_pk_bf16_f32 v55, v42, v43
    v_exp_f32 v46, v46
    v_exp_f32 v47, v47
    v_cvt_pk_bf16_f32 v56, v44, v45
    v_mfma_f32_32x32x16_bf16 v[76:91], v[108:111], v[52:55], v[76:91]
    v_exp_f32 v48, v48
    v_exp_f32 v49, v49
    v_cvt_pk_bf16_f32 v57, v46, v47
    s_add_u32 s64, s63, 3
    s_and_b32 s64, s64, 7
    s_lshl_b32 s64, s64, 6
    s_add_u32 s64, s64, s61
    buffer_load_dwordx4 v[140:143], v119, s[52:55], s64 offen
    v_exp_f32 v50, v50
    v_exp_f32 v51, v51
    v_cvt_pk_bf16_f32 v58, v48, v49
    v_exp_f32 v20, v20
    v_cvt_pk_bf16_f32 v59, v50, v51
    v_exp_f32 v21, v21
    v_exp_f32 v22, v22
    v_mfma_f32_32x32x16_bf16 v[76:91], v[112:115], v[56:59], v[76:91]
    ds_read_b128 v[96:99], v116 offset:3072
    ds_read_b128 v[108:111], v117 offset:3072
    ds_read_b128 v[112:115], v117 offset:3584
    v_exp_f32 v23, v23
    v_cvt_pk_bf16_f32 v52, v20, v21
    v_exp_f32 v24, v24
    v_exp_f32 v25, v25
    v_cvt_pk_bf16_f32 v53, v22, v23
    v_exp_f32 v26, v26
    v_exp_f32 v27, v27
    v_mfma_f32_32x32x16_bf16 v[36:51], v[92:95], v[16:19], 0
    v_cvt_pk_bf16_f32 v54, v24, v25
    v_exp_f32 v28, v28
    v_exp_f32 v29, v29
    v_cvt_pk_bf16_f32 v55, v26, v27
    v_exp_f32 v30, v30
    v_exp_f32 v31, v31
    v_cvt_pk_bf16_f32 v56, v28, v29
    s_waitcnt lgkmcnt(3)
    v_mfma_f32_32x32x16_bf16 v[60:75], v[100:103], v[52:55], v[60:75]
    v_exp_f32 v32, v32
    v_exp_f32 v33, v33
    v_cvt_pk_bf16_f32 v57, v30, v31
    s_add_u32 s64, s63, 4
    s_and_b32 s64, s64, 7
    s_lshl_b32 s64, s64, 6
    s_add_u32 s64, s64, s61
    buffer_load_dwordx4 v[144:147], v119, s[52:55], s64 offen
    v_exp_f32 v34, v34
    v_exp_f32 v35, v35
    v_cvt_pk_bf16_f32 v58, v32, v33
    v_exp_f32 v36, v36
    v_cvt_pk_bf16_f32 v59, v34, v35
    v_exp_f32 v37, v37
    v_exp_f32 v38, v38
    v_mfma_f32_32x32x16_bf16 v[60:75], v[104:107], v[56:59], v[60:75]
    v_exp_f32 v39, v39
    v_cvt_pk_bf16_f32 v52, v36, v37
    v_exp_f32 v40, v40
    v_exp_f32 v41, v41
    v_cvt_pk_bf16_f32 v53, v38, v39
    v_exp_f32 v42, v42
    v_exp_f32 v43, v43
    s_waitcnt lgkmcnt(2)
    v_mfma_f32_32x32x16_bf16 v[20:35], v[96:99], v[12:15], 0
    v_cvt_pk_bf16_f32 v54, v40, v41
    v_exp_f32 v44, v44
    v_exp_f32 v45, v45
    v_cvt_pk_bf16_f32 v55, v42, v43
    v_exp_f32 v46, v46
    v_exp_f32 v47, v47
    v_cvt_pk_bf16_f32 v56, v44, v45
    v_mfma_f32_32x32x16_bf16 v[76:91], v[100:103], v[52:55], v[76:91]
    v_exp_f32 v48, v48
    v_exp_f32 v49, v49
    v_cvt_pk_bf16_f32 v57, v46, v47
    v_exp_f32 v50, v50
    v_exp_f32 v51, v51
    v_cvt_pk_bf16_f32 v58, v48, v49
    v_exp_f32 v20, v20
    v_cvt_pk_bf16_f32 v59, v50, v51
    v_exp_f32 v21, v21
    v_exp_f32 v22, v22
    v_mfma_f32_32x32x16_bf16 v[76:91], v[104:107], v[56:59], v[76:91]
    ds_read_b128 v[92:95], v116 offset:4096
    ds_read_b128 v[100:103], v117 offset:4096
    ds_read_b128 v[104:107], v117 offset:4608
    v_exp_f32 v23, v23
    v_cvt_pk_bf16_f32 v52, v20, v21
    v_exp_f32 v24, v24
    v_exp_f32 v25, v25
    v_cvt_pk_bf16_f32 v53, v22, v23
    v_exp_f32 v26, v26
    v_exp_f32 v27, v27
    v_mfma_f32_32x32x16_bf16 v[36:51], v[96:99], v[16:19], 0
    v_cvt_pk_bf16_f32 v54, v24, v25
    v_exp_f32 v28, v28
    v_exp_f32 v29, v29
    v_cvt_pk_bf16_f32 v55, v26, v27
    v_exp_f32 v30, v30
    v_exp_f32 v31, v31
    v_cvt_pk_bf16_f32 v56, v28, v29
    s_waitcnt lgkmcnt(3)
    v_mfma_f32_32x32x16_bf16 v[60:75], v[108:111], v[52:55], v[60:75]
    v_exp_f32 v32, v32
    v_exp_f32 v33, v33
    v_cvt_pk_bf16_f32 v57, v30, v31
    s_add_u32 s64, s63, 5
    s_and_b32 s64, s64, 7
    s_lshl_b32 s64, s64, 6
    s_add_u32 s64, s64, s61
    buffer_load_dwordx4 v[148:151], v119, s[52:55], s64 offen
    v_exp_f32 v34, v34
    v_exp_f32 v35, v35
    v_cvt_pk_bf16_f32 v58, v32, v33
    v_exp_f32 v36, v36
    v_cvt_pk_bf16_f32 v59, v34, v35
    v_exp_f32 v37, v37
    v_exp_f32 v38, v38
    v_mfma_f32_32x32x16_bf16 v[60:75], v[112:115], v[56:59], v[60:75]
    v_exp_f32 v39, v39
    v_cvt_pk_bf16_f32 v52, v36, v37
    v_exp_f32 v40, v40
    v_exp_f32 v41, v41
    v_cvt_pk_bf16_f32 v53, v38, v39
    v_exp_f32 v42, v42
    v_exp_f32 v43, v43
    s_waitcnt lgkmcnt(2)
    v_mfma_f32_32x32x16_bf16 v[20:35], v[92:95], v[12:15], 0
    v_cvt_pk_bf16_f32 v54, v40, v41
    v_exp_f32 v44, v44
    v_exp_f32 v45, v45
    v_cvt_pk_bf16_f32 v55, v42, v43
    v_exp_f32 v46, v46
    v_exp_f32 v47, v47
    v_cvt_pk_bf16_f32 v56, v44, v45
    v_mfma_f32_32x32x16_bf16 v[76:91], v[108:111], v[52:55], v[76:91]
    v_exp_f32 v48, v48
    v_exp_f32 v49, v49
    v_cvt_pk_bf16_f32 v57, v46, v47
    v_exp_f32 v50, v50
    v_exp_f32 v51, v51
    v_add_u32 v117, v118, v117
    v_cvt_pk_bf16_f32 v58, v48, v49
    v_exp_f32 v20, v20
    v_cvt_pk_bf16_f32 v59, v50, v51
    v_exp_f32 v21, v21
    v_exp_f32 v22, v22
    v_mfma_f32_32x32x16_bf16 v[76:91], v[112:115], v[56:59], v[76:91]
    ds_read_b128 v[96:99], v116 offset:5120
    ds_read_b128 v[108:111], v117 offset:1024
    ds_read_b128 v[112:115], v117 offset:1536
    v_exp_f32 v23, v23
    v_cvt_pk_bf16_f32 v52, v20, v21
    v_exp_f32 v24, v24
    v_exp_f32 v25, v25
    v_cvt_pk_bf16_f32 v53, v22, v23
    v_exp_f32 v26, v26
    v_exp_f32 v27, v27
    v_mfma_f32_32x32x16_bf16 v[36:51], v[92:95], v[16:19], 0
    v_cvt_pk_bf16_f32 v54, v24, v25
    v_exp_f32 v28, v28
    v_exp_f32 v29, v29
    v_cvt_pk_bf16_f32 v55, v26, v27
    v_exp_f32 v30, v30
    v_exp_f32 v31, v31
    v_cvt_pk_bf16_f32 v56, v28, v29
    s_waitcnt lgkmcnt(3)
    v_mfma_f32_32x32x16_bf16 v[60:75], v[100:103], v[52:55], v[60:75]
    v_exp_f32 v32, v32
    v_exp_f32 v33, v33
    v_cvt_pk_bf16_f32 v57, v30, v31
    s_add_u32 s64, s63, 6
    s_and_b32 s64, s64, 7
    s_lshl_b32 s64, s64, 6
    s_add_u32 s64, s64, s61
    buffer_load_dwordx4 v[152:155], v119, s[52:55], s64 offen
    v_exp_f32 v34, v34
    v_exp_f32 v35, v35
    v_cvt_pk_bf16_f32 v58, v32, v33
    v_exp_f32 v36, v36
    v_cvt_pk_bf16_f32 v59, v34, v35
    v_exp_f32 v37, v37
    v_exp_f32 v38, v38
    v_mfma_f32_32x32x16_bf16 v[60:75], v[104:107], v[56:59], v[60:75]
    v_exp_f32 v39, v39
    v_cvt_pk_bf16_f32 v52, v36, v37
    v_exp_f32 v40, v40
    v_exp_f32 v41, v41
    v_cvt_pk_bf16_f32 v53, v38, v39
    v_exp_f32 v42, v42
    v_exp_f32 v43, v43
    s_waitcnt lgkmcnt(2)
    v_mfma_f32_32x32x16_bf16 v[20:35], v[96:99], v[12:15], 0
    v_cvt_pk_bf16_f32 v54, v40, v41
    v_exp_f32 v44, v44
    v_exp_f32 v45, v45
    v_cvt_pk_bf16_f32 v55, v42, v43
    v_exp_f32 v46, v46
    v_exp_f32 v47, v47
    v_cvt_pk_bf16_f32 v56, v44, v45
    v_mfma_f32_32x32x16_bf16 v[76:91], v[100:103], v[52:55], v[76:91]
    v_exp_f32 v48, v48
    v_exp_f32 v49, v49
    v_cvt_pk_bf16_f32 v57, v46, v47
    s_add_u32 s43, s60, 3
    s_and_b32 s43, s43, 3
    s_lshl_b32 s43, s43, 13
    s_add_u32 s43, s43, s42
    s_add_u32 m0, s42, 24576
    s_add_u32 s98, s43, 0
    buffer_load_dwordx4 v5, s[44:47], s98 offen sc0 sc1 lds
    s_add_u32 m0, s42, 25600
    s_add_u32 s98, s43, 1024
    buffer_load_dwordx4 v5, s[44:47], s98 offen sc0 sc1 lds
    s_add_u32 m0, s42, 26624
    s_add_u32 s98, s43, 2048
    buffer_load_dwordx4 v5, s[44:47], s98 offen sc0 sc1 lds
    s_add_u32 m0, s42, 27648
    s_add_u32 s98, s43, 3072
    buffer_load_dwordx4 v5, s[44:47], s98 offen sc0 sc1 lds
    v_exp_f32 v50, v50
    v_exp_f32 v51, v51
    v_cvt_pk_bf16_f32 v58, v48, v49
    v_exp_f32 v20, v20
    v_cvt_pk_bf16_f32 v59, v50, v51
    v_exp_f32 v21, v21
    v_exp_f32 v22, v22
    v_mfma_f32_32x32x16_bf16 v[76:91], v[104:107], v[56:59], v[76:91]
    ds_read_b128 v[92:95], v116 offset:6144
    ds_read_b128 v[100:103], v117 offset:2048
    ds_read_b128 v[104:107], v117 offset:2560
    v_exp_f32 v23, v23
    v_cvt_pk_bf16_f32 v52, v20, v21
    v_exp_f32 v24, v24
    v_exp_f32 v25, v25
    v_cvt_pk_bf16_f32 v53, v22, v23
    v_exp_f32 v26, v26
    v_exp_f32 v27, v27
    v_mfma_f32_32x32x16_bf16 v[36:51], v[96:99], v[16:19], 0
    v_cvt_pk_bf16_f32 v54, v24, v25
    v_exp_f32 v28, v28
    v_exp_f32 v29, v29
    v_cvt_pk_bf16_f32 v55, v26, v27
    v_exp_f32 v30, v30
    v_exp_f32 v31, v31
    v_cvt_pk_bf16_f32 v56, v28, v29
    s_waitcnt lgkmcnt(3)
    v_mfma_f32_32x32x16_bf16 v[60:75], v[108:111], v[52:55], v[60:75]
    v_exp_f32 v32, v32
    v_exp_f32 v33, v33
    v_cvt_pk_bf16_f32 v57, v30, v31
    s_add_u32 s64, s63, 7
    s_and_b32 s64, s64, 7
    s_lshl_b32 s64, s64, 6
    s_add_u32 s64, s64, s61
    buffer_load_dwordx4 v[156:159], v119, s[52:55], s64 offen
    v_exp_f32 v34, v34
    v_exp_f32 v35, v35
    v_cvt_pk_bf16_f32 v58, v32, v33
    v_exp_f32 v36, v36
    v_cvt_pk_bf16_f32 v59, v34, v35
    v_exp_f32 v37, v37
    v_exp_f32 v38, v38
    v_mfma_f32_32x32x16_bf16 v[60:75], v[112:115], v[56:59], v[60:75]
    v_exp_f32 v39, v39
    v_cvt_pk_bf16_f32 v52, v36, v37
    v_exp_f32 v40, v40
    v_exp_f32 v41, v41
    v_cvt_pk_bf16_f32 v53, v38, v39
    v_exp_f32 v42, v42
    v_exp_f32 v43, v43
    s_waitcnt lgkmcnt(2)
    v_mfma_f32_32x32x16_bf16 v[20:35], v[92:95], v[12:15], 0
    v_cvt_pk_bf16_f32 v54, v40, v41
    v_exp_f32 v44, v44
    v_exp_f32 v45, v45
    v_cvt_pk_bf16_f32 v55, v42, v43
    v_exp_f32 v46, v46
    v_exp_f32 v47, v47
    v_cvt_pk_bf16_f32 v56, v44, v45
    v_mfma_f32_32x32x16_bf16 v[76:91], v[108:111], v[52:55], v[76:91]
    v_exp_f32 v48, v48
    v_exp_f32 v49, v49
    v_cvt_pk_bf16_f32 v57, v46, v47
    v_exp_f32 v50, v50
    v_exp_f32 v51, v51
    v_cvt_pk_bf16_f32 v58, v48, v49
    v_exp_f32 v20, v20
    v_cvt_pk_bf16_f32 v59, v50, v51
    v_exp_f32 v21, v21
    v_exp_f32 v22, v22
    v_mfma_f32_32x32x16_bf16 v[76:91], v[112:115], v[56:59], v[76:91]
    ds_read_b128 v[96:99], v116 offset:7168
    ds_read_b128 v[108:111], v117 offset:3072
    ds_read_b128 v[112:115], v117 offset:3584
    v_exp_f32 v23, v23
    v_cvt_pk_bf16_f32 v52, v20, v21
    v_exp_f32 v24, v24
    v_exp_f32 v25, v25
    v_cvt_pk_bf16_f32 v53, v22, v23
    v_exp_f32 v26, v26
    v_exp_f32 v27, v27
    v_mfma_f32_32x32x16_bf16 v[36:51], v[92:95], v[16:19], 0
    v_cvt_pk_bf16_f32 v54, v24, v25
    v_exp_f32 v28, v28
    v_exp_f32 v29, v29
    v_cvt_pk_bf16_f32 v55, v26, v27
    v_exp_f32 v30, v30
    v_exp_f32 v31, v31
    v_cvt_pk_bf16_f32 v56, v28, v29
    s_waitcnt lgkmcnt(3)
    v_mfma_f32_32x32x16_bf16 v[60:75], v[100:103], v[52:55], v[60:75]
    v_exp_f32 v32, v32
    v_exp_f32 v33, v33
    v_cvt_pk_bf16_f32 v57, v30, v31
    s_add_u32 s64, s63, 0
    s_and_b32 s64, s64, 7
    s_lshl_b32 s64, s64, 6
    s_add_u32 s64, s64, s61
    s_add_u32 s64, s64, 65536
    buffer_load_dwordx4 v[160:163], v119, s[52:55], s64 offen
    v_exp_f32 v34, v34
    v_exp_f32 v35, v35
    v_cvt_pk_bf16_f32 v58, v32, v33
    v_exp_f32 v36, v36
    v_cvt_pk_bf16_f32 v59, v34, v35
    v_exp_f32 v37, v37
    v_exp_f32 v38, v38
    v_mfma_f32_32x32x16_bf16 v[60:75], v[104:107], v[56:59], v[60:75]
    v_exp_f32 v39, v39
    v_cvt_pk_bf16_f32 v52, v36, v37
    v_exp_f32 v40, v40
    v_exp_f32 v41, v41
    v_cvt_pk_bf16_f32 v53, v38, v39
    v_exp_f32 v42, v42
    v_exp_f32 v43, v43
    s_waitcnt lgkmcnt(2)
    v_mfma_f32_32x32x16_bf16 v[20:35], v[96:99], v[12:15], 0
    v_cvt_pk_bf16_f32 v54, v40, v41
    v_exp_f32 v44, v44
    v_exp_f32 v45, v45
    v_cvt_pk_bf16_f32 v55, v42, v43
    v_exp_f32 v46, v46
    v_exp_f32 v47, v47
    v_cvt_pk_bf16_f32 v56, v44, v45
    v_mfma_f32_32x32x16_bf16 v[76:91], v[100:103], v[52:55], v[76:91]
    v_exp_f32 v48, v48
    v_exp_f32 v49, v49
    v_cvt_pk_bf16_f32 v57, v46, v47
    v_exp_f32 v50, v50
    v_exp_f32 v51, v51
    v_cvt_pk_bf16_f32 v58, v48, v49
    v_exp_f32 v20, v20
    v_cvt_pk_bf16_f32 v59, v50, v51
    v_exp_f32 v21, v21
    v_exp_f32 v22, v22
    v_mfma_f32_32x32x16_bf16 v[76:91], v[104:107], v[56:59], v[76:91]
    s_waitcnt vmcnt(17)
    s_barrier
    ds_read_b128 v[92:95], v116 offset:8192
    ds_read_b128 v[100:103], v117 offset:4096
    ds_read_b128 v[104:107], v117 offset:4608
    v_exp_f32 v23, v23
    v_cvt_pk_bf16_f32 v52, v20, v21
    v_exp_f32 v24, v24
    v_exp_f32 v25, v25
    v_cvt_pk_bf16_f32 v53, v22, v23
    v_exp_f32 v26, v26
    v_exp_f32 v27, v27
    v_mfma_f32_32x32x16_bf16 v[36:51], v[96:99], v[16:19], 0
    v_cvt_pk_bf16_f32 v54, v24, v25
    v_exp_f32 v28, v28
    v_exp_f32 v29, v29
    v_cvt_pk_bf16_f32 v55, v26, v27
    v_exp_f32 v30, v30
    v_exp_f32 v31, v31
    v_cvt_pk_bf16_f32 v56, v28, v29
    s_waitcnt lgkmcnt(3)
    v_mfma_f32_32x32x16_bf16 v[60:75], v[108:111], v[52:55], v[60:75]
    v_exp_f32 v32, v32
    v_exp_f32 v33, v33
    v_cvt_pk_bf16_f32 v57, v30, v31
    s_add_u32 s64, s63, 1
    s_and_b32 s64, s64, 7
    s_lshl_b32 s64, s64, 6
    s_add_u32 s64, s64, s61
    s_add_u32 s64, s64, 65536
    buffer_load_dwordx4 v[164:167], v119, s[52:55], s64 offen
    v_exp_f32 v34, v34
    v_exp_f32 v35, v35
    v_cvt_pk_bf16_f32 v58, v32, v33
    v_exp_f32 v36, v36
    v_cvt_pk_bf16_f32 v59, v34, v35
    v_exp_f32 v37, v37
    v_exp_f32 v38, v38
    v_mfma_f32_32x32x16_bf16 v[60:75], v[112:115], v[56:59], v[60:75]
    v_exp_f32 v39, v39
    v_cvt_pk_bf16_f32 v52, v36, v37
    v_exp_f32 v40, v40
    v_exp_f32 v41, v41
    v_cvt_pk_bf16_f32 v53, v38, v39
    v_exp_f32 v42, v42
    v_exp_f32 v43, v43
    s_waitcnt lgkmcnt(2)
    v_mfma_f32_32x32x16_bf16 v[20:35], v[92:95], v[12:15], 0
    v_cvt_pk_bf16_f32 v54, v40, v41
    v_exp_f32 v44, v44
    v_exp_f32 v45, v45
    v_cvt_pk_bf16_f32 v55, v42, v43
    v_exp_f32 v46, v46
    v_exp_f32 v47, v47
    v_cvt_pk_bf16_f32 v56, v44, v45
    v_mfma_f32_32x32x16_bf16 v[76:91], v[108:111], v[52:55], v[76:91]
    v_exp_f32 v48, v48
    v_exp_f32 v49, v49
    v_cvt_pk_bf16_f32 v57, v46, v47
    v_exp_f32 v50, v50
    v_exp_f32 v51, v51
    v_add_u32 v117, v118, v117
    v_cvt_pk_bf16_f32 v58, v48, v49
    v_exp_f32 v20, v20
    v_cvt_pk_bf16_f32 v59, v50, v51
    v_exp_f32 v21, v21
    v_exp_f32 v22, v22
    v_mfma_f32_32x32x16_bf16 v[76:91], v[112:115], v[56:59], v[76:91]
    ds_read_b128 v[96:99], v116 offset:9216
    ds_read_b128 v[108:111], v117 offset:1024
    ds_read_b128 v[112:115], v117 offset:1536
    v_exp_f32 v23, v23
    v_cvt_pk_bf16_f32 v52, v20, v21
    v_exp_f32 v24, v24
    v_exp_f32 v25, v25
    v_cvt_pk_bf16_f32 v53, v22, v23
    v_exp_f32 v26, v26
    v_exp_f32 v27, v27
    v_mfma_f32_32x32x16_bf16 v[36:51], v[92:95], v[16:19], 0
    v_cvt_pk_bf16_f32 v54, v24, v25
    v_exp_f32 v28, v28
    v_exp_f32 v29, v29
    v_cvt_pk_bf16_f32 v55, v26, v27
    v_exp_f32 v30, v30
    v_exp_f32 v31, v31
    v_cvt_pk_bf16_f32 v56, v28, v29
    s_waitcnt lgkmcnt(3)
    v_mfma_f32_32x32x16_bf16 v[60:75], v[100:103], v[52:55], v[60:75]
    v_exp_f32 v32, v32
    v_exp_f32 v33, v33
    v_cvt_pk_bf16_f32 v57, v30, v31
    s_add_u32 s64, s63, 2
    s_and_b32 s64, s64, 7
    s_lshl_b32 s64, s64, 6
    s_add_u32 s64, s64, s61
    s_add_u32 s64, s64, 65536
    buffer_load_dwordx4 v[168:171], v119, s[52:55], s64 offen
    v_exp_f32 v34, v34
    v_exp_f32 v35, v35
    v_cvt_pk_bf16_f32 v58, v32, v33
    v_exp_f32 v36, v36
    v_cvt_pk_bf16_f32 v59, v34, v35
    v_exp_f32 v37, v37
    v_exp_f32 v38, v38
    v_mfma_f32_32x32x16_bf16 v[60:75], v[104:107], v[56:59], v[60:75]
    v_exp_f32 v39, v39
    v_cvt_pk_bf16_f32 v52, v36, v37
    v_exp_f32 v40, v40
    v_exp_f32 v41, v41
    v_cvt_pk_bf16_f32 v53, v38, v39
    v_exp_f32 v42, v42
    v_exp_f32 v43, v43
    s_waitcnt lgkmcnt(2)
    v_mfma_f32_32x32x16_bf16 v[20:35], v[96:99], v[12:15], 0
    v_cvt_pk_bf16_f32 v54, v40, v41
    v_exp_f32 v44, v44
    v_exp_f32 v45, v45
    v_cvt_pk_bf16_f32 v55, v42, v43
    v_exp_f32 v46, v46
    v_exp_f32 v47, v47
    v_cvt_pk_bf16_f32 v56, v44, v45
    v_mfma_f32_32x32x16_bf16 v[76:91], v[100:103], v[52:55], v[76:91]
    v_exp_f32 v48, v48
    v_exp_f32 v49, v49
    v_cvt_pk_bf16_f32 v57, v46, v47
    v_exp_f32 v50, v50
    v_exp_f32 v51, v51
    v_cvt_pk_bf16_f32 v58, v48, v49
    v_exp_f32 v20, v20
    v_cvt_pk_bf16_f32 v59, v50, v51
    v_exp_f32 v21, v21
    v_exp_f32 v22, v22
    v_mfma_f32_32x32x16_bf16 v[76:91], v[104:107], v[56:59], v[76:91]
    ds_read_b128 v[92:95], v116 offset:10240
    ds_read_b128 v[100:103], v117 offset:2048
    ds_read_b128 v[104:107], v117 offset:2560
    v_exp_f32 v23, v23
    v_cvt_pk_bf16_f32 v52, v20, v21
    v_exp_f32 v24, v24
    v_exp_f32 v25, v25
    v_cvt_pk_bf16_f32 v53, v22, v23
    v_exp_f32 v26, v26
    v_exp_f32 v27, v27
    v_mfma_f32_32x32x16_bf16 v[36:51], v[96:99], v[16:19], 0
    v_cvt_pk_bf16_f32 v54, v24, v25
    v_exp_f32 v28, v28
    v_exp_f32 v29, v29
    v_cvt_pk_bf16_f32 v55, v26, v27
    v_exp_f32 v30, v30
    v_exp_f32 v31, v31
    v_cvt_pk_bf16_f32 v56, v28, v29
    s_waitcnt lgkmcnt(3)
    v_mfma_f32_32x32x16_bf16 v[60:75], v[108:111], v[52:55], v[60:75]
    v_exp_f32 v32, v32
    v_exp_f32 v33, v33
    v_cvt_pk_bf16_f32 v57, v30, v31
    s_add_u32 s64, s63, 3
    s_and_b32 s64, s64, 7
    s_lshl_b32 s64, s64, 6
    s_add_u32 s64, s64, s61
    s_add_u32 s64, s64, 65536
    buffer_load_dwordx4 v[172:175], v119, s[52:55], s64 offen
    v_exp_f32 v34, v34
    v_exp_f32 v35, v35
    v_cvt_pk_bf16_f32 v58, v32, v33
    v_exp_f32 v36, v36
    v_cvt_pk_bf16_f32 v59, v34, v35
    v_exp_f32 v37, v37
    v_exp_f32 v38, v38
    v_mfma_f32_32x32x16_bf16 v[60:75], v[112:115], v[56:59], v[60:75]
    v_exp_f32 v39, v39
    v_cvt_pk_bf16_f32 v52, v36, v37
    v_exp_f32 v40, v40
    v_exp_f32 v41, v41
    v_cvt_pk_bf16_f32 v53, v38, v39
    v_exp_f32 v42, v42
    v_exp_f32 v43, v43
    s_waitcnt lgkmcnt(2)
    v_mfma_f32_32x32x16_bf16 v[20:35], v[92:95], v[12:15], 0
    v_cvt_pk_bf16_f32 v54, v40, v41
    v_exp_f32 v44, v44
    v_exp_f32 v45, v45
    v_cvt_pk_bf16_f32 v55, v42, v43
    v_exp_f32 v46, v46
    v_exp_f32 v47, v47
    v_cvt_pk_bf16_f32 v56, v44, v45
    v_mfma_f32_32x32x16_bf16 v[76:91], v[108:111], v[52:55], v[76:91]
    v_exp_f32 v48, v48
    v_exp_f32 v49, v49
    v_cvt_pk_bf16_f32 v57, v46, v47
    v_exp_f32 v50, v50
    v_exp_f32 v51, v51
    v_cvt_pk_bf16_f32 v58, v48, v49
    v_exp_f32 v20, v20
    v_cvt_pk_bf16_f32 v59, v50, v51
    v_exp_f32 v21, v21
    v_exp_f32 v22, v22
    v_mfma_f32_32x32x16_bf16 v[76:91], v[112:115], v[56:59], v[76:91]
    ds_read_b128 v[96:99], v116 offset:11264
    ds_read_b128 v[108:111], v117 offset:3072
    ds_read_b128 v[112:115], v117 offset:3584
    v_exp_f32 v23, v23
    v_cvt_pk_bf16_f32 v52, v20, v21
    v_exp_f32 v24, v24
    v_exp_f32 v25, v25
    v_cvt_pk_bf16_f32 v53, v22, v23
    v_exp_f32 v26, v26
    v_exp_f32 v27, v27
    v_mfma_f32_32x32x16_bf16 v[36:51], v[92:95], v[16:19], 0
    v_cvt_pk_bf16_f32 v54, v24, v25
    v_exp_f32 v28, v28
    v_exp_f32 v29, v29
    v_cvt_pk_bf16_f32 v55, v26, v27
    v_exp_f32 v30, v30
    v_exp_f32 v31, v31
    v_cvt_pk_bf16_f32 v56, v28, v29
    s_waitcnt lgkmcnt(3)
    v_mfma_f32_32x32x16_bf16 v[60:75], v[100:103], v[52:55], v[60:75]
    v_exp_f32 v32, v32
    v_exp_f32 v33, v33
    v_cvt_pk_bf16_f32 v57, v30, v31
    s_add_u32 s64, s63, 4
    s_and_b32 s64, s64, 7
    s_lshl_b32 s64, s64, 6
    s_add_u32 s64, s64, s61
    s_add_u32 s64, s64, 65536
    buffer_load_dwordx4 v[176:179], v119, s[52:55], s64 offen
    v_exp_f32 v34, v34
    v_exp_f32 v35, v35
    v_cvt_pk_bf16_f32 v58, v32, v33
    v_exp_f32 v36, v36
    v_cvt_pk_bf16_f32 v59, v34, v35
    v_exp_f32 v37, v37
    v_exp_f32 v38, v38
    v_mfma_f32_32x32x16_bf16 v[60:75], v[104:107], v[56:59], v[60:75]
    v_exp_f32 v39, v39
    v_cvt_pk_bf16_f32 v52, v36, v37
    v_exp_f32 v40, v40
    v_exp_f32 v41, v41
    v_cvt_pk_bf16_f32 v53, v38, v39
    v_exp_f32 v42, v42
    v_exp_f32 v43, v43
    s_waitcnt lgkmcnt(2)
    v_mfma_f32_32x32x16_bf16 v[20:35], v[96:99], v[12:15], 0
    v_cvt_pk_bf16_f32 v54, v40, v41
    v_exp_f32 v44, v44
    v_exp_f32 v45, v45
    v_cvt_pk_bf16_f32 v55, v42, v43
    v_exp_f32 v46, v46
    v_exp_f32 v47, v47
    v_cvt_pk_bf16_f32 v56, v44, v45
    v_mfma_f32_32x32x16_bf16 v[76:91], v[100:103], v[52:55], v[76:91]
    v_exp_f32 v48, v48
    v_exp_f32 v49, v49
    v_cvt_pk_bf16_f32 v57, v46, v47
    v_exp_f32 v50, v50
    v_exp_f32 v51, v51
    v_cvt_pk_bf16_f32 v58, v48, v49
    v_exp_f32 v20, v20
    v_cvt_pk_bf16_f32 v59, v50, v51
    v_exp_f32 v21, v21
    v_exp_f32 v22, v22
    v_mfma_f32_32x32x16_bf16 v[76:91], v[104:107], v[56:59], v[76:91]
    ds_read_b128 v[92:95], v116 offset:12288
    ds_read_b128 v[100:103], v117 offset:4096
    ds_read_b128 v[104:107], v117 offset:4608
    v_exp_f32 v23, v23
    v_cvt_pk_bf16_f32 v52, v20, v21
    v_exp_f32 v24, v24
    v_exp_f32 v25, v25
    v_cvt_pk_bf16_f32 v53, v22, v23
    v_exp_f32 v26, v26
    v_exp_f32 v27, v27
    v_mfma_f32_32x32x16_bf16 v[36:51], v[96:99], v[16:19], 0
    v_cvt_pk_bf16_f32 v54, v24, v25
    v_exp_f32 v28, v28
    v_exp_f32 v29, v29
    v_cvt_pk_bf16_f32 v55, v26, v27
    v_exp_f32 v30, v30
    v_exp_f32 v31, v31
    v_cvt_pk_bf16_f32 v56, v28, v29
    s_waitcnt lgkmcnt(3)
    v_mfma_f32_32x32x16_bf16 v[60:75], v[108:111], v[52:55], v[60:75]
    v_exp_f32 v32, v32
    v_exp_f32 v33, v33
    v_cvt_pk_bf16_f32 v57, v30, v31
    s_add_u32 s64, s63, 5
    s_and_b32 s64, s64, 7
    s_lshl_b32 s64, s64, 6
    s_add_u32 s64, s64, s61
    s_add_u32 s64, s64, 65536
    buffer_load_dwordx4 v[180:183], v119, s[52:55], s64 offen
    v_exp_f32 v34, v34
    v_exp_f32 v35, v35
    v_cvt_pk_bf16_f32 v58, v32, v33
    v_exp_f32 v36, v36
    v_cvt_pk_bf16_f32 v59, v34, v35
    v_exp_f32 v37, v37
    v_exp_f32 v38, v38
    v_mfma_f32_32x32x16_bf16 v[60:75], v[112:115], v[56:59], v[60:75]
    v_exp_f32 v39, v39
    v_cvt_pk_bf16_f32 v52, v36, v37
    v_exp_f32 v40, v40
    v_exp_f32 v41, v41
    v_cvt_pk_bf16_f32 v53, v38, v39
    v_exp_f32 v42, v42
    v_exp_f32 v43, v43
    s_waitcnt lgkmcnt(2)
    v_mfma_f32_32x32x16_bf16 v[20:35], v[92:95], v[12:15], 0
    v_cvt_pk_bf16_f32 v54, v40, v41
    v_exp_f32 v44, v44
    v_exp_f32 v45, v45
    v_cvt_pk_bf16_f32 v55, v42, v43
    v_exp_f32 v46, v46
    v_exp_f32 v47, v47
    v_cvt_pk_bf16_f32 v56, v44, v45
    v_mfma_f32_32x32x16_bf16 v[76:91], v[108:111], v[52:55], v[76:91]
    v_exp_f32 v48, v48
    v_exp_f32 v49, v49
    v_cvt_pk_bf16_f32 v57, v46, v47
    v_exp_f32 v50, v50
    v_exp_f32 v51, v51
    v_add_u32 v117, v118, v117
    v_cvt_pk_bf16_f32 v58, v48, v49
    v_exp_f32 v20, v20
    v_cvt_pk_bf16_f32 v59, v50, v51
    v_exp_f32 v21, v21
    v_exp_f32 v22, v22
    v_mfma_f32_32x32x16_bf16 v[76:91], v[112:115], v[56:59], v[76:91]
    ds_read_b128 v[96:99], v116 offset:13312
    ds_read_b128 v[108:111], v117 offset:1024
    ds_read_b128 v[112:115], v117 offset:1536
    v_exp_f32 v23, v23
    v_cvt_pk_bf16_f32 v52, v20, v21
    v_exp_f32 v24, v24
    v_exp_f32 v25, v25
    v_cvt_pk_bf16_f32 v53, v22, v23
    v_exp_f32 v26, v26
    v_exp_f32 v27, v27
    v_mfma_f32_32x32x16_bf16 v[36:51], v[92:95], v[16:19], 0
    v_cvt_pk_bf16_f32 v54, v24, v25
    v_exp_f32 v28, v28
    v_exp_f32 v29, v29
    v_cvt_pk_bf16_f32 v55, v26, v27
    v_exp_f32 v30, v30
    v_exp_f32 v31, v31
    v_cvt_pk_bf16_f32 v56, v28, v29
    s_waitcnt lgkmcnt(3)
    v_mfma_f32_32x32x16_bf16 v[60:75], v[100:103], v[52:55], v[60:75]
    v_exp_f32 v32, v32
    v_exp_f32 v33, v33
    v_cvt_pk_bf16_f32 v57, v30, v31
    s_add_u32 s64, s63, 6
    s_and_b32 s64, s64, 7
    s_lshl_b32 s64, s64, 6
    s_add_u32 s64, s64, s61
    s_add_u32 s64, s64, 65536
    buffer_load_dwordx4 v[184:187], v119, s[52:55], s64 offen
    v_exp_f32 v34, v34
    v_exp_f32 v35, v35
    v_cvt_pk_bf16_f32 v58, v32, v33
    v_exp_f32 v36, v36
    v_cvt_pk_bf16_f32 v59, v34, v35
    v_exp_f32 v37, v37
    v_exp_f32 v38, v38
    v_mfma_f32_32x32x16_bf16 v[60:75], v[104:107], v[56:59], v[60:75]
    v_exp_f32 v39, v39
    v_cvt_pk_bf16_f32 v52, v36, v37
    v_exp_f32 v40, v40
    v_exp_f32 v41, v41
    v_cvt_pk_bf16_f32 v53, v38, v39
    v_exp_f32 v42, v42
    v_exp_f32 v43, v43
    s_waitcnt lgkmcnt(2)
    v_mfma_f32_32x32x16_bf16 v[20:35], v[96:99], v[12:15], 0
    v_cvt_pk_bf16_f32 v54, v40, v41
    v_exp_f32 v44, v44
    v_exp_f32 v45, v45
    v_cvt_pk_bf16_f32 v55, v42, v43
    v_exp_f32 v46, v46
    v_exp_f32 v47, v47
    v_cvt_pk_bf16_f32 v56, v44, v45
    v_mfma_f32_32x32x16_bf16 v[76:91], v[100:103], v[52:55], v[76:91]
    v_exp_f32 v48, v48
    v_exp_f32 v49, v49
    v_cvt_pk_bf16_f32 v57, v46, v47
    v_exp_f32 v50, v50
    v_exp_f32 v51, v51
    v_cvt_pk_bf16_f32 v58, v48, v49
    v_exp_f32 v20, v20
    v_cvt_pk_bf16_f32 v59, v50, v51
    v_exp_f32 v21, v21
    v_exp_f32 v22, v22
    v_mfma_f32_32x32x16_bf16 v[76:91], v[104:107], v[56:59], v[76:91]
    ds_read_b128 v[92:95], v116 offset:14336
    ds_read_b128 v[100:103], v117 offset:2048
    ds_read_b128 v[104:107], v117 offset:2560
    v_exp_f32 v23, v23
    v_cvt_pk_bf16_f32 v52, v20, v21
    v_exp_f32 v24, v24
    v_exp_f32 v25, v25
    v_cvt_pk_bf16_f32 v53, v22, v23
    v_exp_f32 v26, v26
    v_exp_f32 v27, v27
    v_mfma_f32_32x32x16_bf16 v[36:51], v[96:99], v[16:19], 0
    v_cvt_pk_bf16_f32 v54, v24, v25
    v_exp_f32 v28, v28
    v_exp_f32 v29, v29
    v_cvt_pk_bf16_f32 v55, v26, v27
    v_exp_f32 v30, v30
    v_exp_f32 v31, v31
    v_cvt_pk_bf16_f32 v56, v28, v29
    s_waitcnt lgkmcnt(3)
    v_mfma_f32_32x32x16_bf16 v[60:75], v[108:111], v[52:55], v[60:75]
    v_exp_f32 v32, v32
    v_exp_f32 v33, v33
    v_cvt_pk_bf16_f32 v57, v30, v31
    s_add_u32 s64, s63, 7
    s_and_b32 s64, s64, 7
    s_lshl_b32 s64, s64, 6
    s_add_u32 s64, s64, s61
    s_add_u32 s64, s64, 65536
    buffer_load_dwordx4 v[188:191], v119, s[52:55], s64 offen
    v_exp_f32 v34, v34
    v_exp_f32 v35, v35
    v_cvt_pk_bf16_f32 v58, v32, v33
    v_exp_f32 v36, v36
    v_cvt_pk_bf16_f32 v59, v34, v35
    v_exp_f32 v37, v37
    v_exp_f32 v38, v38
    v_mfma_f32_32x32x16_bf16 v[60:75], v[112:115], v[56:59], v[60:75]
    v_exp_f32 v39, v39
    v_cvt_pk_bf16_f32 v52, v36, v37
    v_exp_f32 v40, v40
    v_exp_f32 v41, v41
    v_cvt_pk_bf16_f32 v53, v38, v39
    v_exp_f32 v42, v42
    v_exp_f32 v43, v43
    s_waitcnt lgkmcnt(2)
    v_mfma_f32_32x32x16_bf16 v[20:35], v[92:95], v[12:15], 0
    v_cvt_pk_bf16_f32 v54, v40, v41
    v_exp_f32 v44, v44
    v_exp_f32 v45, v45
    v_cvt_pk_bf16_f32 v55, v42, v43
    v_exp_f32 v46, v46
    v_exp_f32 v47, v47
    v_cvt_pk_bf16_f32 v56, v44, v45
    v_mfma_f32_32x32x16_bf16 v[76:91], v[108:111], v[52:55], v[76:91]
    v_exp_f32 v48, v48
    v_exp_f32 v49, v49
    v_cvt_pk_bf16_f32 v57, v46, v47
    v_exp_f32 v50, v50
    v_exp_f32 v51, v51
    v_cvt_pk_bf16_f32 v58, v48, v49
    v_exp_f32 v20, v20
    v_cvt_pk_bf16_f32 v59, v50, v51
    v_exp_f32 v21, v21
    v_exp_f32 v22, v22
    v_mfma_f32_32x32x16_bf16 v[76:91], v[112:115], v[56:59], v[76:91]
    ds_read_b128 v[96:99], v116 offset:15360
    ds_read_b128 v[108:111], v117 offset:3072
    ds_read_b128 v[112:115], v117 offset:3584
    v_exp_f32 v23, v23
    v_cvt_pk_bf16_f32 v52, v20, v21
    v_exp_f32 v24, v24
    v_exp_f32 v25, v25
    v_cvt_pk_bf16_f32 v53, v22, v23
    v_exp_f32 v26, v26
    v_exp_f32 v27, v27
    v_mfma_f32_32x32x16_bf16 v[36:51], v[92:95], v[16:19], 0
    v_cvt_pk_bf16_f32 v54, v24, v25
    v_exp_f32 v28, v28
    v_exp_f32 v29, v29
    v_cvt_pk_bf16_f32 v55, v26, v27
    v_exp_f32 v30, v30
    v_exp_f32 v31, v31
    v_cvt_pk_bf16_f32 v56, v28, v29
    s_waitcnt lgkmcnt(3)
    v_mfma_f32_32x32x16_bf16 v[60:75], v[100:103], v[52:55], v[60:75]
    v_exp_f32 v32, v32
    v_exp_f32 v33, v33
    v_cvt_pk_bf16_f32 v57, v30, v31
    s_add_u32 s64, s63, 0
    s_and_b32 s64, s64, 7
    s_lshl_b32 s64, s64, 6
    s_add_u32 s64, s64, s61
    s_add_u32 s64, s64, 131072
    buffer_load_dwordx4 v[192:195], v119, s[52:55], s64 offen
    v_exp_f32 v34, v34
    v_exp_f32 v35, v35
    v_cvt_pk_bf16_f32 v58, v32, v33
    v_exp_f32 v36, v36
    v_cvt_pk_bf16_f32 v59, v34, v35
    v_exp_f32 v37, v37
    v_exp_f32 v38, v38
    v_mfma_f32_32x32x16_bf16 v[60:75], v[104:107], v[56:59], v[60:75]
    v_exp_f32 v39, v39
    v_cvt_pk_bf16_f32 v52, v36, v37
    v_exp_f32 v40, v40
    v_exp_f32 v41, v41
    v_cvt_pk_bf16_f32 v53, v38, v39
    v_exp_f32 v42, v42
    v_exp_f32 v43, v43
    s_waitcnt lgkmcnt(2)
    v_mfma_f32_32x32x16_bf16 v[20:35], v[96:99], v[12:15], 0
    v_cvt_pk_bf16_f32 v54, v40, v41
    v_exp_f32 v44, v44
    v_exp_f32 v45, v45
    v_cvt_pk_bf16_f32 v55, v42, v43
    v_exp_f32 v46, v46
    v_exp_f32 v47, v47
    v_cvt_pk_bf16_f32 v56, v44, v45
    v_mfma_f32_32x32x16_bf16 v[76:91], v[100:103], v[52:55], v[76:91]
    v_exp_f32 v48, v48
    v_exp_f32 v49, v49
    v_cvt_pk_bf16_f32 v57, v46, v47
    v_exp_f32 v50, v50
    v_exp_f32 v51, v51
    v_cvt_pk_bf16_f32 v58, v48, v49
    v_exp_f32 v20, v20
    v_cvt_pk_bf16_f32 v59, v50, v51
    v_exp_f32 v21, v21
    v_exp_f32 v22, v22
    v_mfma_f32_32x32x16_bf16 v[76:91], v[104:107], v[56:59], v[76:91]
    s_waitcnt vmcnt(20)
    s_barrier
    ds_read_b128 v[92:95], v116 offset:16384
    ds_read_b128 v[100:103], v117 offset:4096
    ds_read_b128 v[104:107], v117 offset:4608
    v_exp_f32 v23, v23
    v_cvt_pk_bf16_f32 v52, v20, v21
    v_exp_f32 v24, v24
    v_exp_f32 v25, v25
    v_cvt_pk_bf16_f32 v53, v22, v23
    v_exp_f32 v26, v26
    v_exp_f32 v27, v27
    v_mfma_f32_32x32x16_bf16 v[36:51], v[96:99], v[16:19], 0
    v_cvt_pk_bf16_f32 v54, v24, v25
    v_exp_f32 v28, v28
    v_exp_f32 v29, v29
    v_cvt_pk_bf16_f32 v55, v26, v27
    v_exp_f32 v30, v30
    v_exp_f32 v31, v31
    v_cvt_pk_bf16_f32 v56, v28, v29
    s_waitcnt lgkmcnt(3)
    v_mfma_f32_32x32x16_bf16 v[60:75], v[108:111], v[52:55], v[60:75]
    v_exp_f32 v32, v32
    v_exp_f32 v33, v33
    v_cvt_pk_bf16_f32 v57, v30, v31
    s_add_u32 s64, s63, 1
    s_and_b32 s64, s64, 7
    s_lshl_b32 s64, s64, 6
    s_add_u32 s64, s64, s61
    s_add_u32 s64, s64, 131072
    buffer_load_dwordx4 v[196:199], v119, s[52:55], s64 offen
    v_exp_f32 v34, v34
    v_exp_f32 v35, v35
    v_cvt_pk_bf16_f32 v58, v32, v33
    v_exp_f32 v36, v36
    v_cvt_pk_bf16_f32 v59, v34, v35
    v_exp_f32 v37, v37
    v_exp_f32 v38, v38
    v_mfma_f32_32x32x16_bf16 v[60:75], v[112:115], v[56:59], v[60:75]
    v_exp_f32 v39, v39
    v_cvt_pk_bf16_f32 v52, v36, v37
    v_exp_f32 v40, v40
    v_exp_f32 v41, v41
    v_cvt_pk_bf16_f32 v53, v38, v39
    v_exp_f32 v42, v42
    v_exp_f32 v43, v43
    s_waitcnt lgkmcnt(2)
    v_mfma_f32_32x32x16_bf16 v[20:35], v[92:95], v[12:15], 0
    v_cvt_pk_bf16_f32 v54, v40, v41
    v_exp_f32 v44, v44
    v_exp_f32 v45, v45
    v_cvt_pk_bf16_f32 v55, v42, v43
    v_exp_f32 v46, v46
    v_exp_f32 v47, v47
    v_cvt_pk_bf16_f32 v56, v44, v45
    v_mfma_f32_32x32x16_bf16 v[76:91], v[108:111], v[52:55], v[76:91]
    v_exp_f32 v48, v48
    v_exp_f32 v49, v49
    v_cvt_pk_bf16_f32 v57, v46, v47
    v_exp_f32 v50, v50
    v_exp_f32 v51, v51
    v_add_u32 v117, v118, v117
    v_cvt_pk_bf16_f32 v58, v48, v49
    v_exp_f32 v20, v20
    v_cvt_pk_bf16_f32 v59, v50, v51
    v_exp_f32 v21, v21
    v_exp_f32 v22, v22
    v_mfma_f32_32x32x16_bf16 v[76:91], v[112:115], v[56:59], v[76:91]
    ds_read_b128 v[96:99], v116 offset:17408
    ds_read_b128 v[108:111], v117 offset:1024
    ds_read_b128 v[112:115], v117 offset:1536
    v_exp_f32 v23, v23
    v_cvt_pk_bf16_f32 v52, v20, v21
    v_exp_f32 v24, v24
    v_exp_f32 v25, v25
    v_cvt_pk_bf16_f32 v53, v22, v23
    v_exp_f32 v26, v26
    v_exp_f32 v27, v27
    v_mfma_f32_32x32x16_bf16 v[36:51], v[92:95], v[16:19], 0
    v_cvt_pk_bf16_f32 v54, v24, v25
    v_exp_f32 v28, v28
    v_exp_f32 v29, v29
    v_cvt_pk_bf16_f32 v55, v26, v27
    v_exp_f32 v30, v30
    v_exp_f32 v31, v31
    v_cvt_pk_bf16_f32 v56, v28, v29
    s_waitcnt lgkmcnt(3)
    v_mfma_f32_32x32x16_bf16 v[60:75], v[100:103], v[52:55], v[60:75]
    v_exp_f32 v32, v32
    v_exp_f32 v33, v33
    v_cvt_pk_bf16_f32 v57, v30, v31
    s_add_u32 s64, s63, 2
    s_and_b32 s64, s64, 7
    s_lshl_b32 s64, s64, 6
    s_add_u32 s64, s64, s61
    s_add_u32 s64, s64, 131072
    buffer_load_dwordx4 v[200:203], v119, s[52:55], s64 offen
    v_exp_f32 v34, v34
    v_exp_f32 v35, v35
    v_cvt_pk_bf16_f32 v58, v32, v33
    v_exp_f32 v36, v36
    v_cvt_pk_bf16_f32 v59, v34, v35
    v_exp_f32 v37, v37
    v_exp_f32 v38, v38
    v_mfma_f32_32x32x16_bf16 v[60:75], v[104:107], v[56:59], v[60:75]
    v_exp_f32 v39, v39
    v_cvt_pk_bf16_f32 v52, v36, v37
    v_exp_f32 v40, v40
    v_exp_f32 v41, v41
    v_cvt_pk_bf16_f32 v53, v38, v39
    v_exp_f32 v42, v42
    v_exp_f32 v43, v43
    s_waitcnt lgkmcnt(2)
    v_mfma_f32_32x32x16_bf16 v[20:35], v[96:99], v[12:15], 0
    v_cvt_pk_bf16_f32 v54, v40, v41
    v_exp_f32 v44, v44
    v_exp_f32 v45, v45
    v_cvt_pk_bf16_f32 v55, v42, v43
    v_exp_f32 v46, v46
    v_exp_f32 v47, v47
    v_cvt_pk_bf16_f32 v56, v44, v45
    v_mfma_f32_32x32x16_bf16 v[76:91], v[100:103], v[52:55], v[76:91]
    v_exp_f32 v48, v48
    v_exp_f32 v49, v49
    v_cvt_pk_bf16_f32 v57, v46, v47
    s_mov_b32 s32, 140288
    buffer_load_dwordx4 v[8:11], v5, s[44:47], s32 offen sc0 sc1
    v_exp_f32 v50, v50
    v_exp_f32 v51, v51
    v_cvt_pk_bf16_f32 v58, v48, v49
    v_exp_f32 v20, v20
    v_cvt_pk_bf16_f32 v59, v50, v51
    v_exp_f32 v21, v21
    v_exp_f32 v22, v22
    v_mfma_f32_32x32x16_bf16 v[76:91], v[104:107], v[56:59], v[76:91]
    ds_read_b128 v[92:95], v116 offset:18432
    ds_read_b128 v[100:103], v117 offset:2048
    ds_read_b128 v[104:107], v117 offset:2560
    v_exp_f32 v23, v23
    v_cvt_pk_bf16_f32 v52, v20, v21
    v_exp_f32 v24, v24
    v_exp_f32 v25, v25
    v_cvt_pk_bf16_f32 v53, v22, v23
    v_exp_f32 v26, v26
    v_exp_f32 v27, v27
    v_mfma_f32_32x32x16_bf16 v[36:51], v[96:99], v[16:19], 0
    v_cvt_pk_bf16_f32 v54, v24, v25
    v_exp_f32 v28, v28
    v_exp_f32 v29, v29
    v_cvt_pk_bf16_f32 v55, v26, v27
    v_exp_f32 v30, v30
    v_exp_f32 v31, v31
    v_cvt_pk_bf16_f32 v56, v28, v29
    s_waitcnt lgkmcnt(3)
    v_mfma_f32_32x32x16_bf16 v[60:75], v[108:111], v[52:55], v[60:75]
    v_exp_f32 v32, v32
    v_exp_f32 v33, v33
    v_cvt_pk_bf16_f32 v57, v30, v31
    s_add_u32 s64, s63, 3
    s_and_b32 s64, s64, 7
    s_lshl_b32 s64, s64, 6
    s_add_u32 s64, s64, s61
    s_add_u32 s64, s64, 131072
    buffer_load_dwordx4 v[204:207], v119, s[52:55], s64 offen
    v_exp_f32 v34, v34
    v_exp_f32 v35, v35
    v_cvt_pk_bf16_f32 v58, v32, v33
    v_exp_f32 v36, v36
    v_cvt_pk_bf16_f32 v59, v34, v35
    v_exp_f32 v37, v37
    v_exp_f32 v38, v38
    v_mfma_f32_32x32x16_bf16 v[60:75], v[112:115], v[56:59], v[60:75]
    v_exp_f32 v39, v39
    v_cvt_pk_bf16_f32 v52, v36, v37
    v_exp_f32 v40, v40
    v_exp_f32 v41, v41
    v_cvt_pk_bf16_f32 v53, v38, v39
    v_exp_f32 v42, v42
    v_exp_f32 v43, v43
    s_waitcnt lgkmcnt(2)
    v_mfma_f32_32x32x16_bf16 v[20:35], v[92:95], v[12:15], 0
    v_cvt_pk_bf16_f32 v54, v40, v41
    v_exp_f32 v44, v44
    v_exp_f32 v45, v45
    v_cvt_pk_bf16_f32 v55, v42, v43
    v_exp_f32 v46, v46
    v_exp_f32 v47, v47
    v_cvt_pk_bf16_f32 v56, v44, v45
    v_mfma_f32_32x32x16_bf16 v[76:91], v[108:111], v[52:55], v[76:91]
    v_exp_f32 v48, v48
    v_exp_f32 v49, v49
    v_cvt_pk_bf16_f32 v57, v46, v47
    v_exp_f32 v50, v50
    v_exp_f32 v51, v51
    v_cvt_pk_bf16_f32 v58, v48, v49
    v_exp_f32 v20, v20
    v_cvt_pk_bf16_f32 v59, v50, v51
    v_exp_f32 v21, v21
    v_exp_f32 v22, v22
    v_mfma_f32_32x32x16_bf16 v[76:91], v[112:115], v[56:59], v[76:91]
    ds_read_b128 v[96:99], v116 offset:19456
    ds_read_b128 v[108:111], v117 offset:3072
    ds_read_b128 v[112:115], v117 offset:3584
    v_exp_f32 v23, v23
    v_cvt_pk_bf16_f32 v52, v20, v21
    v_exp_f32 v24, v24
    v_exp_f32 v25, v25
    v_cvt_pk_bf16_f32 v53, v22, v23
    v_exp_f32 v26, v26
    v_exp_f32 v27, v27
    v_mfma_f32_32x32x16_bf16 v[36:51], v[92:95], v[16:19], 0
    v_cvt_pk_bf16_f32 v54, v24, v25
    v_exp_f32 v28, v28
    v_exp_f32 v29, v29
    v_cvt_pk_bf16_f32 v55, v26, v27
    v_exp_f32 v30, v30
    v_exp_f32 v31, v31
    v_cvt_pk_bf16_f32 v56, v28, v29
    s_waitcnt lgkmcnt(3)
    v_mfma_f32_32x32x16_bf16 v[60:75], v[100:103], v[52:55], v[60:75]
    v_exp_f32 v32, v32
    v_exp_f32 v33, v33
    v_cvt_pk_bf16_f32 v57, v30, v31
    s_add_u32 s64, s63, 4
    s_and_b32 s64, s64, 7
    s_lshl_b32 s64, s64, 6
    s_add_u32 s64, s64, s61
    s_add_u32 s64, s64, 131072
    buffer_load_dwordx4 v[208:211], v119, s[52:55], s64 offen
    v_exp_f32 v34, v34
    v_exp_f32 v35, v35
    v_cvt_pk_bf16_f32 v58, v32, v33
    v_exp_f32 v36, v36
    v_cvt_pk_bf16_f32 v59, v34, v35
    v_exp_f32 v37, v37
    v_exp_f32 v38, v38
    v_mfma_f32_32x32x16_bf16 v[60:75], v[104:107], v[56:59], v[60:75]
    v_exp_f32 v39, v39
    v_cvt_pk_bf16_f32 v52, v36, v37
    v_exp_f32 v40, v40
    v_exp_f32 v41, v41
    v_cvt_pk_bf16_f32 v53, v38, v39
    v_exp_f32 v42, v42
    v_exp_f32 v43, v43
    s_waitcnt lgkmcnt(2)
    v_mfma_f32_32x32x16_bf16 v[20:35], v[96:99], v[12:15], 0
    v_cvt_pk_bf16_f32 v54, v40, v41
    v_exp_f32 v44, v44
    v_exp_f32 v45, v45
    v_cvt_pk_bf16_f32 v55, v42, v43
    v_exp_f32 v46, v46
    v_exp_f32 v47, v47
    v_cvt_pk_bf16_f32 v56, v44, v45
    v_mfma_f32_32x32x16_bf16 v[76:91], v[100:103], v[52:55], v[76:91]
    v_exp_f32 v48, v48
    v_exp_f32 v49, v49
    v_cvt_pk_bf16_f32 v57, v46, v47
    v_exp_f32 v50, v50
    v_exp_f32 v51, v51
    v_cvt_pk_bf16_f32 v58, v48, v49
    v_exp_f32 v20, v20
    v_cvt_pk_bf16_f32 v59, v50, v51
    v_exp_f32 v21, v21
    v_exp_f32 v22, v22
    v_mfma_f32_32x32x16_bf16 v[76:91], v[104:107], v[56:59], v[76:91]
    ds_read_b128 v[92:95], v116 offset:20480
    ds_read_b128 v[100:103], v117 offset:4096
    ds_read_b128 v[104:107], v117 offset:4608
    v_exp_f32 v23, v23
    v_cvt_pk_bf16_f32 v52, v20, v21
    v_exp_f32 v24, v24
    v_exp_f32 v25, v25
    v_cvt_pk_bf16_f32 v53, v22, v23
    v_exp_f32 v26, v26
    v_exp_f32 v27, v27
    v_mfma_f32_32x32x16_bf16 v[36:51], v[96:99], v[16:19], 0
    v_cvt_pk_bf16_f32 v54, v24, v25
    v_exp_f32 v28, v28
    v_exp_f32 v29, v29
    v_cvt_pk_bf16_f32 v55, v26, v27
    v_exp_f32 v30, v30
    v_exp_f32 v31, v31
    v_cvt_pk_bf16_f32 v56, v28, v29
    s_waitcnt lgkmcnt(3)
    v_mfma_f32_32x32x16_bf16 v[60:75], v[108:111], v[52:55], v[60:75]
    v_exp_f32 v32, v32
    v_exp_f32 v33, v33
    v_cvt_pk_bf16_f32 v57, v30, v31
    s_add_u32 s64, s63, 5
    s_and_b32 s64, s64, 7
    s_lshl_b32 s64, s64, 6
    s_add_u32 s64, s64, s61
    s_add_u32 s64, s64, 131072
    buffer_load_dwordx4 v[212:215], v119, s[52:55], s64 offen
    v_exp_f32 v34, v34
    v_exp_f32 v35, v35
    v_cvt_pk_bf16_f32 v58, v32, v33
    v_exp_f32 v36, v36
    v_cvt_pk_bf16_f32 v59, v34, v35
    v_exp_f32 v37, v37
    v_exp_f32 v38, v38
    v_mfma_f32_32x32x16_bf16 v[60:75], v[112:115], v[56:59], v[60:75]
    v_exp_f32 v39, v39
    v_cvt_pk_bf16_f32 v52, v36, v37
    v_exp_f32 v40, v40
    v_exp_f32 v41, v41
    v_cvt_pk_bf16_f32 v53, v38, v39
    v_exp_f32 v42, v42
    v_exp_f32 v43, v43
    s_waitcnt lgkmcnt(2)
    v_mfma_f32_32x32x16_bf16 v[20:35], v[92:95], v[12:15], 0
    v_cvt_pk_bf16_f32 v54, v40, v41
    v_exp_f32 v44, v44
    v_exp_f32 v45, v45
    v_cvt_pk_bf16_f32 v55, v42, v43
    v_exp_f32 v46, v46
    v_exp_f32 v47, v47
    v_cvt_pk_bf16_f32 v56, v44, v45
    v_mfma_f32_32x32x16_bf16 v[76:91], v[108:111], v[52:55], v[76:91]
    v_exp_f32 v48, v48
    v_exp_f32 v49, v49
    v_cvt_pk_bf16_f32 v57, v46, v47
    v_exp_f32 v50, v50
    v_exp_f32 v51, v51
    v_add_u32 v117, v118, v117
    v_cvt_pk_bf16_f32 v58, v48, v49
    v_exp_f32 v20, v20
    v_cvt_pk_bf16_f32 v59, v50, v51
    v_exp_f32 v21, v21
    v_exp_f32 v22, v22
    v_mfma_f32_32x32x16_bf16 v[76:91], v[112:115], v[56:59], v[76:91]
    ds_read_b128 v[96:99], v116 offset:21504
    ds_read_b128 v[108:111], v117 offset:1024
    ds_read_b128 v[112:115], v117 offset:1536
    v_exp_f32 v23, v23
    v_cvt_pk_bf16_f32 v52, v20, v21
    v_exp_f32 v24, v24
    v_exp_f32 v25, v25
    v_cvt_pk_bf16_f32 v53, v22, v23
    v_exp_f32 v26, v26
    v_exp_f32 v27, v27
    v_mfma_f32_32x32x16_bf16 v[36:51], v[92:95], v[16:19], 0
    v_cvt_pk_bf16_f32 v54, v24, v25
    v_exp_f32 v28, v28
    v_exp_f32 v29, v29
    v_cvt_pk_bf16_f32 v55, v26, v27
    v_exp_f32 v30, v30
    v_exp_f32 v31, v31
    v_cvt_pk_bf16_f32 v56, v28, v29
    s_waitcnt lgkmcnt(3)
    v_mfma_f32_32x32x16_bf16 v[60:75], v[100:103], v[52:55], v[60:75]
    v_exp_f32 v32, v32
    v_exp_f32 v33, v33
    v_cvt_pk_bf16_f32 v57, v30, v31
    s_add_u32 s64, s63, 6
    s_and_b32 s64, s64, 7
    s_lshl_b32 s64, s64, 6
    s_add_u32 s64, s64, s61
    s_add_u32 s64, s64, 131072
    buffer_load_dwordx4 v[216:219], v119, s[52:55], s64 offen
    v_exp_f32 v34, v34
    v_exp_f32 v35, v35
    v_cvt_pk_bf16_f32 v58, v32, v33
    v_exp_f32 v36, v36
    v_cvt_pk_bf16_f32 v59, v34, v35
    v_exp_f32 v37, v37
    v_exp_f32 v38, v38
    v_mfma_f32_32x32x16_bf16 v[60:75], v[104:107], v[56:59], v[60:75]
    v_exp_f32 v39, v39
    v_cvt_pk_bf16_f32 v52, v36, v37
    v_exp_f32 v40, v40
    v_exp_f32 v41, v41
    v_cvt_pk_bf16_f32 v53, v38, v39
    v_exp_f32 v42, v42
    v_exp_f32 v43, v43
    s_waitcnt lgkmcnt(2)
    v_mfma_f32_32x32x16_bf16 v[20:35], v[96:99], v[12:15], 0
    v_cvt_pk_bf16_f32 v54, v40, v41
    v_exp_f32 v44, v44
    v_exp_f32 v45, v45
    v_cvt_pk_bf16_f32 v55, v42, v43
    v_exp_f32 v46, v46
    v_exp_f32 v47, v47
    v_cvt_pk_bf16_f32 v56, v44, v45
    v_mfma_f32_32x32x16_bf16 v[76:91], v[100:103], v[52:55], v[76:91]
    v_exp_f32 v48, v48
    v_exp_f32 v49, v49
    v_cvt_pk_bf16_f32 v57, v46, v47
    v_exp_f32 v50, v50
    v_exp_f32 v51, v51
    v_cvt_pk_bf16_f32 v58, v48, v49
    v_exp_f32 v20, v20
    v_cvt_pk_bf16_f32 v59, v50, v51
    v_exp_f32 v21, v21
    v_exp_f32 v22, v22
    v_mfma_f32_32x32x16_bf16 v[76:91], v[104:107], v[56:59], v[76:91]
    ds_read_b128 v[92:95], v116 offset:22528
    ds_read_b128 v[100:103], v117 offset:2048
    ds_read_b128 v[104:107], v117 offset:2560
    v_exp_f32 v23, v23
    v_cvt_pk_bf16_f32 v52, v20, v21
    v_exp_f32 v24, v24
    v_exp_f32 v25, v25
    v_cvt_pk_bf16_f32 v53, v22, v23
    v_exp_f32 v26, v26
    v_exp_f32 v27, v27
    v_mfma_f32_32x32x16_bf16 v[36:51], v[96:99], v[16:19], 0
    v_cvt_pk_bf16_f32 v54, v24, v25
    v_exp_f32 v28, v28
    v_exp_f32 v29, v29
    v_cvt_pk_bf16_f32 v55, v26, v27
    v_exp_f32 v30, v30
    v_exp_f32 v31, v31
    v_cvt_pk_bf16_f32 v56, v28, v29
    s_waitcnt lgkmcnt(3)
    v_mfma_f32_32x32x16_bf16 v[60:75], v[108:111], v[52:55], v[60:75]
    v_exp_f32 v32, v32
    v_exp_f32 v33, v33
    v_cvt_pk_bf16_f32 v57, v30, v31
    s_add_u32 s64, s63, 7
    s_and_b32 s64, s64, 7
    s_lshl_b32 s64, s64, 6
    s_add_u32 s64, s64, s61
    s_add_u32 s64, s64, 131072
    buffer_load_dwordx4 v[220:223], v119, s[52:55], s64 offen
    v_exp_f32 v34, v34
    v_exp_f32 v35, v35
    v_cvt_pk_bf16_f32 v58, v32, v33
    v_exp_f32 v36, v36
    v_cvt_pk_bf16_f32 v59, v34, v35
    v_exp_f32 v37, v37
    v_exp_f32 v38, v38
    v_mfma_f32_32x32x16_bf16 v[60:75], v[112:115], v[56:59], v[60:75]
    v_exp_f32 v39, v39
    v_cvt_pk_bf16_f32 v52, v36, v37
    v_exp_f32 v40, v40
    v_exp_f32 v41, v41
    v_cvt_pk_bf16_f32 v53, v38, v39
    v_exp_f32 v42, v42
    v_exp_f32 v43, v43
    s_waitcnt lgkmcnt(2)
    v_mfma_f32_32x32x16_bf16 v[20:35], v[92:95], v[12:15], 0
    v_cvt_pk_bf16_f32 v54, v40, v41
    v_exp_f32 v44, v44
    v_exp_f32 v45, v45
    v_cvt_pk_bf16_f32 v55, v42, v43
    v_exp_f32 v46, v46
    v_exp_f32 v47, v47
    v_cvt_pk_bf16_f32 v56, v44, v45
    v_mfma_f32_32x32x16_bf16 v[76:91], v[108:111], v[52:55], v[76:91]
    v_exp_f32 v48, v48
    v_exp_f32 v49, v49
    v_cvt_pk_bf16_f32 v57, v46, v47
    v_exp_f32 v50, v50
    v_exp_f32 v51, v51
    v_cvt_pk_bf16_f32 v58, v48, v49
    v_exp_f32 v20, v20
    v_cvt_pk_bf16_f32 v59, v50, v51
    v_exp_f32 v21, v21
    v_exp_f32 v22, v22
    v_mfma_f32_32x32x16_bf16 v[76:91], v[112:115], v[56:59], v[76:91]
    ds_read_b128 v[96:99], v116 offset:23552
    ds_read_b128 v[108:111], v117 offset:3072
    ds_read_b128 v[112:115], v117 offset:3584
    v_exp_f32 v23, v23
    v_cvt_pk_bf16_f32 v52, v20, v21
    v_exp_f32 v24, v24
    v_exp_f32 v25, v25
    v_cvt_pk_bf16_f32 v53, v22, v23
    v_exp_f32 v26, v26
    v_exp_f32 v27, v27
    v_mfma_f32_32x32x16_bf16 v[36:51], v[92:95], v[16:19], 0
    v_cvt_pk_bf16_f32 v54, v24, v25
    v_exp_f32 v28, v28
    v_exp_f32 v29, v29
    v_cvt_pk_bf16_f32 v55, v26, v27
    v_exp_f32 v30, v30
    v_exp_f32 v31, v31
    v_cvt_pk_bf16_f32 v56, v28, v29
    s_waitcnt lgkmcnt(3)
    v_mfma_f32_32x32x16_bf16 v[60:75], v[100:103], v[52:55], v[60:75]
    v_exp_f32 v32, v32
    v_exp_f32 v33, v33
    v_cvt_pk_bf16_f32 v57, v30, v31
    s_add_u32 s64, s63, 0
    s_and_b32 s64, s64, 7
    s_lshl_b32 s64, s64, 6
    s_add_u32 s64, s64, s61
    s_add_u32 s64, s64, 196608
    buffer_load_dwordx4 v[224:227], v119, s[52:55], s64 offen
    s_waitcnt vmcnt(6)
    v_xor_b32 v8, s37, v8
    v_xor_b32 v9, s37, v9
    v_xor_b32 v10, s37, v10
    v_xor_b32 v11, s37, v11
    v_or_b32 v8, v8, v9
    v_or_b32 v10, v10, v11
    v_or_b32 v8, v8, v10
    v_cmp_ne_u32 vcc, 0, v8
    s_cbranch_vccz p2_prepA_ok
    s_mov_b32 s33, 140288
    s_mov_b32 s36, 0
p2_prepA_poll:
    buffer_load_dwordx4 v[8:11], v5, s[44:47], s33 offen sc0 sc1
    s_waitcnt vmcnt(0)
    v_xor_b32 v8, s37, v8
    v_xor_b32 v9, s37, v9
    v_xor_b32 v10, s37, v10
    v_xor_b32 v11, s37, v11
    v_or_b32 v8, v8, v9
    v_or_b32 v8, v8, v10
    v_or_b32 v8, v8, v11
    v_cmp_ne_u32 vcc, 0, v8
    s_add_u32 s36, s36, 1
    s_cbranch_vccz p2_prepA_poll_ok
    s_cmp_lt_u32 s36, 40000
    s_cbranch_scc1 p2_prepA_poll
p2_prepA_poll_ok:
p2_prepA_ok:
    v_exp_f32 v34, v34
    v_exp_f32 v35, v35
    v_cvt_pk_bf16_f32 v58, v32, v33
    v_exp_f32 v36, v36
    v_cvt_pk_bf16_f32 v59, v34, v35
    v_exp_f32 v37, v37
    v_exp_f32 v38, v38
    v_mfma_f32_32x32x16_bf16 v[60:75], v[104:107], v[56:59], v[60:75]
    v_exp_f32 v39, v39
    v_cvt_pk_bf16_f32 v52, v36, v37
    v_exp_f32 v40, v40
    v_exp_f32 v41, v41
    v_cvt_pk_bf16_f32 v53, v38, v39
    v_exp_f32 v42, v42
    v_exp_f32 v43, v43
    s_waitcnt lgkmcnt(2)
    v_mfma_f32_32x32x16_bf16 v[20:35], v[96:99], v[12:15], 0
    v_cvt_pk_bf16_f32 v54, v40, v41
    v_exp_f32 v44, v44
    v_exp_f32 v45, v45
    v_cvt_pk_bf16_f32 v55, v42, v43
    v_exp_f32 v46, v46
    v_exp_f32 v47, v47
    v_cvt_pk_bf16_f32 v56, v44, v45
    v_mfma_f32_32x32x16_bf16 v[76:91], v[100:103], v[52:55], v[76:91]
    v_exp_f32 v48, v48
    v_exp_f32 v49, v49
    v_cvt_pk_bf16_f32 v57, v46, v47
    v_exp_f32 v50, v50
    v_exp_f32 v51, v51
    v_cvt_pk_bf16_f32 v58, v48, v49
    v_exp_f32 v20, v20
    v_cvt_pk_bf16_f32 v59, v50, v51
    v_exp_f32 v21, v21
    v_exp_f32 v22, v22
    v_mfma_f32_32x32x16_bf16 v[76:91], v[104:107], v[56:59], v[76:91]
    s_waitcnt vmcnt(19)
    s_barrier
    ds_read_b128 v[92:95], v116 offset:24576
    ds_read_b128 v[100:103], v117 offset:4096
    ds_read_b128 v[104:107], v117 offset:4608
    v_exp_f32 v23, v23
    v_cvt_pk_bf16_f32 v52, v20, v21
    v_exp_f32 v24, v24
    v_exp_f32 v25, v25
    v_cvt_pk_bf16_f32 v53, v22, v23
    v_exp_f32 v26, v26
    v_exp_f32 v27, v27
    v_mfma_f32_32x32x16_bf16 v[36:51], v[96:99], v[16:19], 0
    v_cvt_pk_bf16_f32 v54, v24, v25
    v_exp_f32 v28, v28
    v_exp_f32 v29, v29
    v_cvt_pk_bf16_f32 v55, v26, v27
    v_exp_f32 v30, v30
    v_exp_f32 v31, v31
    v_cvt_pk_bf16_f32 v56, v28, v29
    s_waitcnt lgkmcnt(3)
    v_mfma_f32_32x32x16_bf16 v[60:75], v[108:111], v[52:55], v[60:75]
    v_exp_f32 v32, v32
    v_exp_f32 v33, v33
    v_cvt_pk_bf16_f32 v57, v30, v31
    s_add_u32 s64, s63, 1
    s_and_b32 s64, s64, 7
    s_lshl_b32 s64, s64, 6
    s_add_u32 s64, s64, s61
    s_add_u32 s64, s64, 196608
    buffer_load_dwordx4 v[228:231], v119, s[52:55], s64 offen
    v_exp_f32 v34, v34
    v_exp_f32 v35, v35
    v_cvt_pk_bf16_f32 v58, v32, v33
    v_exp_f32 v36, v36
    v_cvt_pk_bf16_f32 v59, v34, v35
    v_exp_f32 v37, v37
    v_exp_f32 v38, v38
    v_mfma_f32_32x32x16_bf16 v[60:75], v[112:115], v[56:59], v[60:75]
    v_exp_f32 v39, v39
    v_cvt_pk_bf16_f32 v52, v36, v37
    v_exp_f32 v40, v40
    v_exp_f32 v41, v41
    v_cvt_pk_bf16_f32 v53, v38, v39
    v_exp_f32 v42, v42
    v_exp_f32 v43, v43
    s_waitcnt lgkmcnt(2)
    v_mfma_f32_32x32x16_bf16 v[20:35], v[92:95], v[12:15], 0
    v_cvt_pk_bf16_f32 v54, v40, v41
    v_exp_f32 v44, v44
    v_exp_f32 v45, v45
    v_cvt_pk_bf16_f32 v55, v42, v43
    v_exp_f32 v46, v46
    v_exp_f32 v47, v47
    v_cvt_pk_bf16_f32 v56, v44, v45
    v_mfma_f32_32x32x16_bf16 v[76:91], v[108:111], v[52:55], v[76:91]
    v_exp_f32 v48, v48
    v_exp_f32 v49, v49
    v_cvt_pk_bf16_f32 v57, v46, v47
    s_add_u32 m0, s66, 0
    s_add_u32 s98, s67, 0
    buffer_load_dwordx4 v5, s[44:47], s98 offen sc0 sc1 lds
    v_exp_f32 v50, v50
    v_exp_f32 v51, v51
    v_add_u32 v117, v118, v117
    v_cvt_pk_bf16_f32 v58, v48, v49
    v_exp_f32 v20, v20
    v_cvt_pk_bf16_f32 v59, v50, v51
    v_exp_f32 v21, v21
    v_exp_f32 v22, v22
    v_mfma_f32_32x32x16_bf16 v[76:91], v[112:115], v[56:59], v[76:91]
    ds_read_b128 v[96:99], v116 offset:25600
    ds_read_b128 v[108:111], v117 offset:1024
    ds_read_b128 v[112:115], v117 offset:1536
    v_exp_f32 v23, v23
    v_cvt_pk_bf16_f32 v52, v20, v21
    v_exp_f32 v24, v24
    v_exp_f32 v25, v25
    v_cvt_pk_bf16_f32 v53, v22, v23
    v_exp_f32 v26, v26
    v_exp_f32 v27, v27
    v_mfma_f32_32x32x16_bf16 v[36:51], v[92:95], v[16:19], 0
    v_cvt_pk_bf16_f32 v54, v24, v25
    v_exp_f32 v28, v28
    v_exp_f32 v29, v29
    v_cvt_pk_bf16_f32 v55, v26, v27
    v_exp_f32 v30, v30
    v_exp_f32 v31, v31
    v_cvt_pk_bf16_f32 v56, v28, v29
    s_waitcnt lgkmcnt(3)
    v_mfma_f32_32x32x16_bf16 v[60:75], v[100:103], v[52:55], v[60:75]
    v_exp_f32 v32, v32
    v_exp_f32 v33, v33
    v_cvt_pk_bf16_f32 v57, v30, v31
    s_add_u32 s64, s63, 2
    s_and_b32 s64, s64, 7
    s_lshl_b32 s64, s64, 6
    s_add_u32 s64, s64, s61
    s_add_u32 s64, s64, 196608
    buffer_load_dwordx4 v[232:235], v119, s[52:55], s64 offen
    v_exp_f32 v34, v34
    v_exp_f32 v35, v35
    v_cvt_pk_bf16_f32 v58, v32, v33
    v_exp_f32 v36, v36
    v_cvt_pk_bf16_f32 v59, v34, v35
    v_exp_f32 v37, v37
    v_exp_f32 v38, v38
    v_mfma_f32_32x32x16_bf16 v[60:75], v[104:107], v[56:59], v[60:75]
    v_exp_f32 v39, v39
    v_cvt_pk_bf16_f32 v52, v36, v37
    v_exp_f32 v40, v40
    v_exp_f32 v41, v41
    v_cvt_pk_bf16_f32 v53, v38, v39
    v_exp_f32 v42, v42
    v_exp_f32 v43, v43
    s_waitcnt lgkmcnt(2)
    v_mfma_f32_32x32x16_bf16 v[20:35], v[96:99], v[12:15], 0
    v_cvt_pk_bf16_f32 v54, v40, v41
    v_exp_f32 v44, v44
    v_exp_f32 v45, v45
    v_cvt_pk_bf16_f32 v55, v42, v43
    v_exp_f32 v46, v46
    v_exp_f32 v47, v47
    v_cvt_pk_bf16_f32 v56, v44, v45
    v_mfma_f32_32x32x16_bf16 v[76:91], v[100:103], v[52:55], v[76:91]
    v_exp_f32 v48, v48
    v_exp_f32 v49, v49
    v_cvt_pk_bf16_f32 v57, v46, v47
    s_add_u32 m0, s66, 1024
    s_add_u32 s98, s67, 1024
    buffer_load_dwordx4 v5, s[44:47], s98 offen sc0 sc1 lds
    v_exp_f32 v50, v50
    v_exp_f32 v51, v51
    v_cvt_pk_bf16_f32 v58, v48, v49
    v_exp_f32 v20, v20
    v_cvt_pk_bf16_f32 v59, v50, v51
    v_exp_f32 v21, v21
    v_exp_f32 v22, v22
    v_mfma_f32_32x32x16_bf16 v[76:91], v[104:107], v[56:59], v[76:91]
    ds_read_b128 v[92:95], v116 offset:26624
    ds_read_b128 v[100:103], v117 offset:2048
    ds_read_b128 v[104:107], v117 offset:2560
    v_exp_f32 v23, v23
    v_cvt_pk_bf16_f32 v52, v20, v21
    v_exp_f32 v24, v24
    v_exp_f32 v25, v25
    v_cvt_pk_bf16_f32 v53, v22, v23
    v_exp_f32 v26, v26
    v_exp_f32 v27, v27
    v_mfma_f32_32x32x16_bf16 v[36:51], v[96:99], v[16:19], 0
    v_cvt_pk_bf16_f32 v54, v24, v25
    v_exp_f32 v28, v28
    v_exp_f32 v29, v29
    v_cvt_pk_bf16_f32 v55, v26, v27
    v_exp_f32 v30, v30
    v_exp_f32 v31, v31
    v_cvt_pk_bf16_f32 v56, v28, v29
    s_waitcnt lgkmcnt(3)
    v_mfma_f32_32x32x16_bf16 v[60:75], v[108:111], v[52:55], v[60:75]
    v_exp_f32 v32, v32
    v_exp_f32 v33, v33
    v_cvt_pk_bf16_f32 v57, v30, v31
    s_add_u32 s64, s63, 3
    s_and_b32 s64, s64, 7
    s_lshl_b32 s64, s64, 6
    s_add_u32 s64, s64, s61
    s_add_u32 s64, s64, 196608
    buffer_load_dwordx4 v[236:239], v119, s[52:55], s64 offen
    v_exp_f32 v34, v34
    v_exp_f32 v35, v35
    v_cvt_pk_bf16_f32 v58, v32, v33
    v_exp_f32 v36, v36
    v_cvt_pk_bf16_f32 v59, v34, v35
    v_exp_f32 v37, v37
    v_exp_f32 v38, v38
    v_mfma_f32_32x32x16_bf16 v[60:75], v[112:115], v[56:59], v[60:75]
    v_exp_f32 v39, v39
    v_cvt_pk_bf16_f32 v52, v36, v37
    v_exp_f32 v40, v40
    v_exp_f32 v41, v41
    v_cvt_pk_bf16_f32 v53, v38, v39
    v_exp_f32 v42, v42
    v_exp_f32 v43, v43
    s_waitcnt lgkmcnt(2)
    v_mfma_f32_32x32x16_bf16 v[20:35], v[92:95], v[12:15], 0
    v_cvt_pk_bf16_f32 v54, v40, v41
    v_exp_f32 v44, v44
    v_exp_f32 v45, v45
    v_cvt_pk_bf16_f32 v55, v42, v43
    v_exp_f32 v46, v46
    v_exp_f32 v47, v47
    v_cvt_pk_bf16_f32 v56, v44, v45
    v_mfma_f32_32x32x16_bf16 v[76:91], v[108:111], v[52:55], v[76:91]
    v_exp_f32 v48, v48
    v_exp_f32 v49, v49
    v_cvt_pk_bf16_f32 v57, v46, v47
    s_add_u32 m0, s66, 2048
    s_add_u32 s98, s67, 2048
    buffer_load_dwordx4 v5, s[44:47], s98 offen sc0 sc1 lds
    v_exp_f32 v50, v50
    v_exp_f32 v51, v51
    v_cvt_pk_bf16_f32 v58, v48, v49
    v_exp_f32 v20, v20
    v_cvt_pk_bf16_f32 v59, v50, v51
    v_exp_f32 v21, v21
    v_exp_f32 v22, v22
    v_mfma_f32_32x32x16_bf16 v[76:91], v[112:115], v[56:59], v[76:91]
    ds_read_b128 v[96:99], v116 offset:27648
    ds_read_b128 v[108:111], v117 offset:3072
    ds_read_b128 v[112:115], v117 offset:3584
    v_exp_f32 v23, v23
    v_cvt_pk_bf16_f32 v52, v20, v21
    v_exp_f32 v24, v24
    v_exp_f32 v25, v25
    v_cvt_pk_bf16_f32 v53, v22, v23
    v_exp_f32 v26, v26
    v_exp_f32 v27, v27
    v_mfma_f32_32x32x16_bf16 v[36:51], v[92:95], v[16:19], 0
    v_cvt_pk_bf16_f32 v54, v24, v25
    v_exp_f32 v28, v28
    v_exp_f32 v29, v29
    v_cvt_pk_bf16_f32 v55, v26, v27
    v_exp_f32 v30, v30
    v_exp_f32 v31, v31
    v_cvt_pk_bf16_f32 v56, v28, v29
    s_waitcnt lgkmcnt(3)
    v_mfma_f32_32x32x16_bf16 v[60:75], v[100:103], v[52:55], v[60:75]
    v_exp_f32 v32, v32
    v_exp_f32 v33, v33
    v_cvt_pk_bf16_f32 v57, v30, v31
    s_add_u32 s64, s63, 4
    s_and_b32 s64, s64, 7
    s_lshl_b32 s64, s64, 6
    s_add_u32 s64, s64, s61
    s_add_u32 s64, s64, 196608
    buffer_load_dwordx4 v[240:243], v119, s[52:55], s64 offen
    v_exp_f32 v34, v34
    v_exp_f32 v35, v35
    v_cvt_pk_bf16_f32 v58, v32, v33
    v_exp_f32 v36, v36
    v_cvt_pk_bf16_f32 v59, v34, v35
    v_exp_f32 v37, v37
    v_exp_f32 v38, v38
    v_mfma_f32_32x32x16_bf16 v[60:75], v[104:107], v[56:59], v[60:75]
    v_exp_f32 v39, v39
    v_cvt_pk_bf16_f32 v52, v36, v37
    v_exp_f32 v40, v40
    v_exp_f32 v41, v41
    v_cvt_pk_bf16_f32 v53, v38, v39
    v_exp_f32 v42, v42
    v_exp_f32 v43, v43
    s_waitcnt lgkmcnt(2)
    v_mfma_f32_32x32x16_bf16 v[20:35], v[96:99], v[12:15], 0
    v_cvt_pk_bf16_f32 v54, v40, v41
    v_exp_f32 v44, v44
    v_exp_f32 v45, v45
    v_cvt_pk_bf16_f32 v55, v42, v43
    v_exp_f32 v46, v46
    v_exp_f32 v47, v47
    v_cvt_pk_bf16_f32 v56, v44, v45
    v_mfma_f32_32x32x16_bf16 v[76:91], v[100:103], v[52:55], v[76:91]
    v_exp_f32 v48, v48
    v_exp_f32 v49, v49
    v_cvt_pk_bf16_f32 v57, v46, v47
    s_add_u32 m0, s66, 3072
    s_add_u32 s98, s67, 3072
    buffer_load_dwordx4 v5, s[44:47], s98 offen sc0 sc1 lds
    v_exp_f32 v50, v50
    v_exp_f32 v51, v51
    v_cvt_pk_bf16_f32 v58, v48, v49
    v_exp_f32 v20, v20
    v_cvt_pk_bf16_f32 v59, v50, v51
    v_exp_f32 v21, v21
    v_exp_f32 v22, v22
    v_mfma_f32_32x32x16_bf16 v[76:91], v[104:107], v[56:59], v[76:91]
    ds_read_b128 v[92:95], v116 offset:28672
    ds_read_b128 v[100:103], v117 offset:4096
    ds_read_b128 v[104:107], v117 offset:4608
    v_exp_f32 v23, v23
    v_cvt_pk_bf16_f32 v52, v20, v21
    v_exp_f32 v24, v24
    v_exp_f32 v25, v25
    v_cvt_pk_bf16_f32 v53, v22, v23
    v_exp_f32 v26, v26
    v_exp_f32 v27, v27
    v_mfma_f32_32x32x16_bf16 v[36:51], v[96:99], v[16:19], 0
    v_cvt_pk_bf16_f32 v54, v24, v25
    v_exp_f32 v28, v28
    v_exp_f32 v29, v29
    v_cvt_pk_bf16_f32 v55, v26, v27
    v_exp_f32 v30, v30
    v_exp_f32 v31, v31
    v_cvt_pk_bf16_f32 v56, v28, v29
    s_waitcnt lgkmcnt(3)
    v_mfma_f32_32x32x16_bf16 v[60:75], v[108:111], v[52:55], v[60:75]
    v_exp_f32 v32, v32
    v_exp_f32 v33, v33
    v_cvt_pk_bf16_f32 v57, v30, v31
    s_add_u32 s64, s63, 5
    s_and_b32 s64, s64, 7
    s_lshl_b32 s64, s64, 6
    s_add_u32 s64, s64, s61
    s_add_u32 s64, s64, 196608
    buffer_load_dwordx4 v[244:247], v119, s[52:55], s64 offen
    v_exp_f32 v34, v34
    v_exp_f32 v35, v35
    v_cvt_pk_bf16_f32 v58, v32, v33
    v_exp_f32 v36, v36
    v_cvt_pk_bf16_f32 v59, v34, v35
    v_exp_f32 v37, v37
    v_exp_f32 v38, v38
    v_mfma_f32_32x32x16_bf16 v[60:75], v[112:115], v[56:59], v[60:75]
    v_exp_f32 v39, v39
    v_cvt_pk_bf16_f32 v52, v36, v37
    v_exp_f32 v40, v40
    v_exp_f32 v41, v41
    v_cvt_pk_bf16_f32 v53, v38, v39
    v_exp_f32 v42, v42
    v_exp_f32 v43, v43
    s_waitcnt lgkmcnt(2)
    v_mfma_f32_32x32x16_bf16 v[20:35], v[92:95], v[12:15], 0
    v_cvt_pk_bf16_f32 v54, v40, v41
    v_exp_f32 v44, v44
    v_exp_f32 v45, v45
    v_cvt_pk_bf16_f32 v55, v42, v43
    v_exp_f32 v46, v46
    v_exp_f32 v47, v47
    v_cvt_pk_bf16_f32 v56, v44, v45
    v_mfma_f32_32x32x16_bf16 v[76:91], v[108:111], v[52:55], v[76:91]
    v_exp_f32 v48, v48
    v_exp_f32 v49, v49
    v_cvt_pk_bf16_f32 v57, v46, v47
    s_add_u32 m0, s66, 4096
    s_add_u32 s98, s67, 4096
    buffer_load_dwordx4 v5, s[44:47], s98 offen sc0 sc1 lds
    v_exp_f32 v50, v50
    v_exp_f32 v51, v51
    v_add_u32 v117, v118, v117
    v_cvt_pk_bf16_f32 v58, v48, v49
    v_exp_f32 v20, v20
    v_cvt_pk_bf16_f32 v59, v50, v51
    v_exp_f32 v21, v21
    v_exp_f32 v22, v22
    v_mfma_f32_32x32x16_bf16 v[76:91], v[112:115], v[56:59], v[76:91]
    ds_read_b128 v[96:99], v116 offset:29696
    ds_read_b128 v[108:111], v117 offset:1024
    ds_read_b128 v[112:115], v117 offset:1536
    v_exp_f32 v23, v23
    v_cvt_pk_bf16_f32 v52, v20, v21
    v_exp_f32 v24, v24
    v_exp_f32 v25, v25
    v_cvt_pk_bf16_f32 v53, v22, v23
    v_exp_f32 v26, v26
    v_exp_f32 v27, v27
    v_mfma_f32_32x32x16_bf16 v[36:51], v[92:95], v[16:19], 0
    v_cvt_pk_bf16_f32 v54, v24, v25
    v_exp_f32 v28, v28
    v_exp_f32 v29, v29
    v_cvt_pk_bf16_f32 v55, v26, v27
    v_exp_f32 v30, v30
    v_exp_f32 v31, v31
    v_cvt_pk_bf16_f32 v56, v28, v29
    s_waitcnt lgkmcnt(3)
    v_mfma_f32_32x32x16_bf16 v[60:75], v[100:103], v[52:55], v[60:75]
    v_exp_f32 v32, v32
    v_exp_f32 v33, v33
    v_cvt_pk_bf16_f32 v57, v30, v31
    s_add_u32 s64, s63, 6
    s_and_b32 s64, s64, 7
    s_lshl_b32 s64, s64, 6
    s_add_u32 s64, s64, s61
    s_add_u32 s64, s64, 196608
    buffer_load_dwordx4 v[248:251], v119, s[52:55], s64 offen
    v_exp_f32 v34, v34
    v_exp_f32 v35, v35
    v_cvt_pk_bf16_f32 v58, v32, v33
    v_exp_f32 v36, v36
    v_cvt_pk_bf16_f32 v59, v34, v35
    v_exp_f32 v37, v37
    v_exp_f32 v38, v38
    v_mfma_f32_32x32x16_bf16 v[60:75], v[104:107], v[56:59], v[60:75]
    v_exp_f32 v39, v39
    v_cvt_pk_bf16_f32 v52, v36, v37
    v_exp_f32 v40, v40
    v_exp_f32 v41, v41
    v_cvt_pk_bf16_f32 v53, v38, v39
    v_exp_f32 v42, v42
    v_exp_f32 v43, v43
    s_waitcnt lgkmcnt(2)
    v_mfma_f32_32x32x16_bf16 v[20:35], v[96:99], v[12:15], 0
    v_cvt_pk_bf16_f32 v54, v40, v41
    v_exp_f32 v44, v44
    v_exp_f32 v45, v45
    v_cvt_pk_bf16_f32 v55, v42, v43
    v_exp_f32 v46, v46
    v_exp_f32 v47, v47
    v_cvt_pk_bf16_f32 v56, v44, v45
    v_mfma_f32_32x32x16_bf16 v[76:91], v[100:103], v[52:55], v[76:91]
    v_exp_f32 v48, v48
    v_exp_f32 v49, v49
    v_cvt_pk_bf16_f32 v57, v46, v47
    s_add_u32 m0, s66, 5120
    s_add_u32 s98, s67, 5120
    buffer_load_dwordx4 v5, s[44:47], s98 offen sc0 sc1 lds
    v_exp_f32 v50, v50
    v_exp_f32 v51, v51
    v_cvt_pk_bf16_f32 v58, v48, v49
    v_exp_f32 v20, v20
    v_cvt_pk_bf16_f32 v59, v50, v51
    v_exp_f32 v21, v21
    v_exp_f32 v22, v22
    v_mfma_f32_32x32x16_bf16 v[76:91], v[104:107], v[56:59], v[76:91]
    ds_read_b128 v[92:95], v116 offset:30720
    ds_read_b128 v[100:103], v117 offset:2048
    ds_read_b128 v[104:107], v117 offset:2560
    v_exp_f32 v23, v23
    v_cvt_pk_bf16_f32 v52, v20, v21
    v_exp_f32 v24, v24
    v_exp_f32 v25, v25
    v_cvt_pk_bf16_f32 v53, v22, v23
    v_exp_f32 v26, v26
    v_exp_f32 v27, v27
    v_mfma_f32_32x32x16_bf16 v[36:51], v[96:99], v[16:19], 0
    v_cvt_pk_bf16_f32 v54, v24, v25
    v_exp_f32 v28, v28
    v_exp_f32 v29, v29
    v_cvt_pk_bf16_f32 v55, v26, v27
    v_exp_f32 v30, v30
    v_exp_f32 v31, v31
    v_cvt_pk_bf16_f32 v56, v28, v29
    s_waitcnt lgkmcnt(3)
    v_mfma_f32_32x32x16_bf16 v[60:75], v[108:111], v[52:55], v[60:75]
    v_exp_f32 v32, v32
    v_exp_f32 v33, v33
    v_cvt_pk_bf16_f32 v57, v30, v31
    s_add_u32 s64, s63, 7
    s_and_b32 s64, s64, 7
    s_lshl_b32 s64, s64, 6
    s_add_u32 s64, s64, s61
    s_add_u32 s64, s64, 196608
    buffer_load_dwordx4 v[252:255], v119, s[52:55], s64 offen
    v_exp_f32 v34, v34
    v_exp_f32 v35, v35
    v_cvt_pk_bf16_f32 v58, v32, v33
    v_exp_f32 v36, v36
    v_cvt_pk_bf16_f32 v59, v34, v35
    v_exp_f32 v37, v37
    v_exp_f32 v38, v38
    v_mfma_f32_32x32x16_bf16 v[60:75], v[112:115], v[56:59], v[60:75]
    v_exp_f32 v39, v39
    v_cvt_pk_bf16_f32 v52, v36, v37
    v_exp_f32 v40, v40
    v_exp_f32 v41, v41
    v_cvt_pk_bf16_f32 v53, v38, v39
    v_exp_f32 v42, v42
    v_exp_f32 v43, v43
    s_waitcnt lgkmcnt(2)
    v_mfma_f32_32x32x16_bf16 v[20:35], v[92:95], v[12:15], 0
    v_cvt_pk_bf16_f32 v54, v40, v41
    v_exp_f32 v44, v44
    v_exp_f32 v45, v45
    v_cvt_pk_bf16_f32 v55, v42, v43
    v_exp_f32 v46, v46
    v_exp_f32 v47, v47
    v_cvt_pk_bf16_f32 v56, v44, v45
    v_mfma_f32_32x32x16_bf16 v[76:91], v[108:111], v[52:55], v[76:91]
    v_exp_f32 v48, v48
    v_exp_f32 v49, v49
    v_cvt_pk_bf16_f32 v57, v46, v47
    s_add_u32 m0, s66, 6144
    s_add_u32 s98, s67, 6144
    buffer_load_dwordx4 v5, s[44:47], s98 offen sc0 sc1 lds
    v_exp_f32 v50, v50
    v_exp_f32 v51, v51
    v_cvt_pk_bf16_f32 v58, v48, v49
    v_exp_f32 v20, v20
    v_cvt_pk_bf16_f32 v59, v50, v51
    v_exp_f32 v21, v21
    v_exp_f32 v22, v22
    v_mfma_f32_32x32x16_bf16 v[76:91], v[112:115], v[56:59], v[76:91]
    ds_read_b128 v[96:99], v116 offset:31744
    ds_read_b128 v[108:111], v117 offset:3072
    ds_read_b128 v[112:115], v117 offset:3584
    v_exp_f32 v23, v23
    v_cvt_pk_bf16_f32 v52, v20, v21
    v_exp_f32 v24, v24
    v_exp_f32 v25, v25
    v_cvt_pk_bf16_f32 v53, v22, v23
    v_exp_f32 v26, v26
    v_exp_f32 v27, v27
    v_mfma_f32_32x32x16_bf16 v[36:51], v[92:95], v[16:19], 0
    v_cvt_pk_bf16_f32 v54, v24, v25
    v_exp_f32 v28, v28
    v_exp_f32 v29, v29
    v_cvt_pk_bf16_f32 v55, v26, v27
    v_exp_f32 v30, v30
    v_exp_f32 v31, v31
    v_cvt_pk_bf16_f32 v56, v28, v29
    s_waitcnt lgkmcnt(3)
    v_mfma_f32_32x32x16_bf16 v[60:75], v[100:103], v[52:55], v[60:75]
    v_exp_f32 v32, v32
    v_exp_f32 v33, v33
    v_cvt_pk_bf16_f32 v57, v30, v31
    v_exp_f32 v34, v34
    v_exp_f32 v35, v35
    v_cvt_pk_bf16_f32 v58, v32, v33
    v_exp_f32 v36, v36
    v_cvt_pk_bf16_f32 v59, v34, v35
    v_exp_f32 v37, v37
    v_exp_f32 v38, v38
    v_mfma_f32_32x32x16_bf16 v[60:75], v[104:107], v[56:59], v[60:75]
    v_exp_f32 v39, v39
    v_cvt_pk_bf16_f32 v52, v36, v37
    v_exp_f32 v40, v40
    v_exp_f32 v41, v41
    v_cvt_pk_bf16_f32 v53, v38, v39
    v_exp_f32 v42, v42
    v_exp_f32 v43, v43
    s_waitcnt lgkmcnt(2)
    v_mfma_f32_32x32x16_bf16 v[20:35], v[96:99], v[12:15], 0
    v_cvt_pk_bf16_f32 v54, v40, v41
    v_exp_f32 v44, v44
    v_exp_f32 v45, v45
    v_cvt_pk_bf16_f32 v55, v42, v43
    v_exp_f32 v46, v46
    v_exp_f32 v47, v47
    v_cvt_pk_bf16_f32 v56, v44, v45
    v_mfma_f32_32x32x16_bf16 v[76:91], v[100:103], v[52:55], v[76:91]
    v_exp_f32 v48, v48
    v_exp_f32 v49, v49
    v_cvt_pk_bf16_f32 v57, v46, v47
    s_add_u32 m0, s66, 7168
    s_add_u32 s98, s67, 7168
    buffer_load_dwordx4 v5, s[44:47], s98 offen sc0 sc1 lds
    v_exp_f32 v50, v50
    v_exp_f32 v51, v51
    v_cvt_pk_bf16_f32 v58, v48, v49
    v_exp_f32 v20, v20
    v_cvt_pk_bf16_f32 v59, v50, v51
    v_exp_f32 v21, v21
    v_exp_f32 v22, v22
    v_mfma_f32_32x32x16_bf16 v[76:91], v[104:107], v[56:59], v[76:91]
    v_exp_f32 v23, v23
    v_cvt_pk_bf16_f32 v52, v20, v21
    v_exp_f32 v24, v24
    v_exp_f32 v25, v25
    v_cvt_pk_bf16_f32 v53, v22, v23
    v_exp_f32 v26, v26
    v_exp_f32 v27, v27
    v_mfma_f32_32x32x16_bf16 v[36:51], v[96:99], v[16:19], 0
    v_cvt_pk_bf16_f32 v54, v24, v25
    v_exp_f32 v28, v28
    v_exp_f32 v29, v29
    v_cvt_pk_bf16_f32 v55, v26, v27
    v_exp_f32 v30, v30
    v_exp_f32 v31, v31
    v_cvt_pk_bf16_f32 v56, v28, v29
    s_waitcnt lgkmcnt(0)
    v_mfma_f32_32x32x16_bf16 v[60:75], v[108:111], v[52:55], v[60:75]
    v_exp_f32 v32, v32
    v_exp_f32 v33, v33
    v_cvt_pk_bf16_f32 v57, v30, v31
    v_exp_f32 v34, v34
    v_exp_f32 v35, v35
    v_cvt_pk_bf16_f32 v58, v32, v33
    v_exp_f32 v36, v36
    v_cvt_pk_bf16_f32 v59, v34, v35
    v_exp_f32 v37, v37
    v_exp_f32 v38, v38
    v_mfma_f32_32x32x16_bf16 v[60:75], v[112:115], v[56:59], v[60:75]
    v_exp_f32 v39, v39
    v_cvt_pk_bf16_f32 v52, v36, v37
    v_exp_f32 v40, v40
    v_exp_f32 v41, v41
    v_cvt_pk_bf16_f32 v53, v38, v39
    v_exp_f32 v42, v42
    v_exp_f32 v43, v43
    v_cvt_pk_bf16_f32 v54, v40, v41
    v_exp_f32 v44, v44
    v_exp_f32 v45, v45
    v_cvt_pk_bf16_f32 v55, v42, v43
    v_exp_f32 v46, v46
    v_exp_f32 v47, v47
    v_cvt_pk_bf16_f32 v56, v44, v45
    v_mfma_f32_32x32x16_bf16 v[76:91], v[108:111], v[52:55], v[76:91]
    v_exp_f32 v48, v48
    v_exp_f32 v49, v49
    v_cvt_pk_bf16_f32 v57, v46, v47
    v_exp_f32 v50, v50
    v_exp_f32 v51, v51
    v_cvt_pk_bf16_f32 v58, v48, v49
    s_nop 0
    v_cvt_pk_bf16_f32 v59, v50, v51
    s_nop 1
    v_mfma_f32_32x32x16_bf16 v[76:91], v[112:115], v[56:59], v[76:91]
    v_mov_b32 v120, 0
    v_mov_b32 v121, 0
    s_branch attn_comb
attn_slow:
    s_add_u32 s43, s60, 2
    s_and_b32 s43, s43, 3
    s_lshl_b32 s43, s43, 13
    s_add_u32 s43, s43, s42
    s_add_u32 m0, s42, 16384
    s_add_u32 s98, s43, 0
    buffer_load_dwordx4 v5, s[44:47], s98 offen sc0 sc1 lds
    s_add_u32 m0, s42, 17408
    s_add_u32 s98, s43, 1024
    buffer_load_dwordx4 v5, s[44:47], s98 offen sc0 sc1 lds
    s_add_u32 m0, s42, 18432
    s_add_u32 s98, s43, 2048
    buffer_load_dwordx4 v5, s[44:47], s98 offen sc0 sc1 lds
    s_add_u32 m0, s42, 19456
    s_add_u32 s98, s43, 3072
    buffer_load_dwordx4 v5, s[44:47], s98 offen sc0 sc1 lds
    s_add_u32 s43, s60, 3
    s_and_b32 s43, s43, 3
    s_lshl_b32 s43, s43, 13
    s_add_u32 s43, s43, s42
    s_add_u32 m0, s42, 24576
    s_add_u32 s98, s43, 0
    buffer_load_dwordx4 v5, s[44:47], s98 offen sc0 sc1 lds
    s_add_u32 m0, s42, 25600
    s_add_u32 s98, s43, 1024
    buffer_load_dwordx4 v5, s[44:47], s98 offen sc0 sc1 lds
    s_add_u32 m0, s42, 26624
    s_add_u32 s98, s43, 2048
    buffer_load_dwordx4 v5, s[44:47], s98 offen sc0 sc1 lds
    s_add_u32 m0, s42, 27648
    s_add_u32 s98, s43, 3072
    buffer_load_dwordx4 v5, s[44:47], s98 offen sc0 sc1 lds
    s_add_u32 s64, s63, 0
    s_and_b32 s64, s64, 7
    s_lshl_b32 s64, s64, 6
    s_add_u32 s64, s64, s61
    buffer_load_dwordx4 v[128:131], v119, s[52:55], s64 offen
    s_add_u32 s64, s63, 1
    s_and_b32 s64, s64, 7
    s_lshl_b32 s64, s64, 6
    s_add_u32 s64, s64, s61
    buffer_load_dwordx4 v[132:135], v119, s[52:55], s64 offen
    s_add_u32 s64, s63, 2
    s_and_b32 s64, s64, 7
    s_lshl_b32 s64, s64, 6
    s_add_u32 s64, s64, s61
    buffer_load_dwordx4 v[136:139], v119, s[52:55], s64 offen
    s_add_u32 s64, s63, 3
    s_and_b32 s64, s64, 7
    s_lshl_b32 s64, s64, 6
    s_add_u32 s64, s64, s61
    buffer_load_dwordx4 v[140:143], v119, s[52:55], s64 offen
    s_add_u32 s64, s63, 4
    s_and_b32 s64, s64, 7
    s_lshl_b32 s64, s64, 6
    s_add_u32 s64, s64, s61
    buffer_load_dwordx4 v[144:147], v119, s[52:55], s64 offen
    s_add_u32 s64, s63, 5
    s_and_b32 s64, s64, 7
    s_lshl_b32 s64, s64, 6
    s_add_u32 s64, s64, s61
    buffer_load_dwordx4 v[148:151], v119, s[52:55], s64 offen
    s_add_u32 s64, s63, 6
    s_and_b32 s64, s64, 7
    s_lshl_b32 s64, s64, 6
    s_add_u32 s64, s64, s61
    buffer_load_dwordx4 v[152:155], v119, s[52:55], s64 offen
    s_add_u32 s64, s63, 7
    s_and_b32 s64, s64, 7
    s_lshl_b32 s64, s64, 6
    s_add_u32 s64, s64, s61
    buffer_load_dwordx4 v[156:159], v119, s[52:55], s64 offen
    s_add_u32 s64, s63, 0
    s_and_b32 s64, s64, 7
    s_lshl_b32 s64, s64, 6
    s_add_u32 s64, s64, s61
    s_add_u32 s64, s64, 65536
    buffer_load_dwordx4 v[160:163], v119, s[52:55], s64 offen
    s_add_u32 s64, s63, 1
    s_and_b32 s64, s64, 7
    s_lshl_b32 s64, s64, 6
    s_add_u32 s64, s64, s61
    s_add_u32 s64, s64, 65536
    buffer_load_dwordx4 v[164:167], v119, s[52:55], s64 offen
    s_add_u32 s64, s63, 2
    s_and_b32 s64, s64, 7
    s_lshl_b32 s64, s64, 6
    s_add_u32 s64, s64, s61
    s_add_u32 s64, s64, 65536
    buffer_load_dwordx4 v[168:171], v119, s[52:55], s64 offen
    s_add_u32 s64, s63, 3
    s_and_b32 s64, s64, 7
    s_lshl_b32 s64, s64, 6
    s_add_u32 s64, s64, s61
    s_add_u32 s64, s64, 65536
    buffer_load_dwordx4 v[172:175], v119, s[52:55], s64 offen
    s_add_u32 s64, s63, 4
    s_and_b32 s64, s64, 7
    s_lshl_b32 s64, s64, 6
    s_add_u32 s64, s64, s61
    s_add_u32 s64, s64, 65536
    buffer_load_dwordx4 v[176:179], v119, s[52:55], s64 offen
    s_add_u32 s64, s63, 5
    s_and_b32 s64, s64, 7
    s_lshl_b32 s64, s64, 6
    s_add_u32 s64, s64, s61
    s_add_u32 s64, s64, 65536
    buffer_load_dwordx4 v[180:183], v119, s[52:55], s64 offen
    s_add_u32 s64, s63, 6
    s_and_b32 s64, s64, 7
    s_lshl_b32 s64, s64, 6
    s_add_u32 s64, s64, s61
    s_add_u32 s64, s64, 65536
    buffer_load_dwordx4 v[184:187], v119, s[52:55], s64 offen
    s_add_u32 s64, s63, 7
    s_and_b32 s64, s64, 7
    s_lshl_b32 s64, s64, 6
    s_add_u32 s64, s64, s61
    s_add_u32 s64, s64, 65536
    buffer_load_dwordx4 v[188:191], v119, s[52:55], s64 offen
    s_add_u32 s64, s63, 0
    s_and_b32 s64, s64, 7
    s_lshl_b32 s64, s64, 6
    s_add_u32 s64, s64, s61
    s_add_u32 s64, s64, 131072
    buffer_load_dwordx4 v[192:195], v119, s[52:55], s64 offen
    s_add_u32 s64, s63, 1
    s_and_b32 s64, s64, 7
    s_lshl_b32 s64, s64, 6
    s_add_u32 s64, s64, s61
    s_add_u32 s64, s64, 131072
    buffer_load_dwordx4 v[196:199], v119, s[52:55], s64 offen
    s_add_u32 s64, s63, 2
    s_and_b32 s64, s64, 7
    s_lshl_b32 s64, s64, 6
    s_add_u32 s64, s64, s61
    s_add_u32 s64, s64, 131072
    buffer_load_dwordx4 v[200:203], v119, s[52:55], s64 offen
    s_add_u32 s64, s63, 3
    s_and_b32 s64, s64, 7
    s_lshl_b32 s64, s64, 6
    s_add_u32 s64, s64, s61
    s_add_u32 s64, s64, 131072
    buffer_load_dwordx4 v[204:207], v119, s[52:55], s64 offen
    s_add_u32 s64, s63, 4
    s_and_b32 s64, s64, 7
    s_lshl_b32 s64, s64, 6
    s_add_u32 s64, s64, s61
    s_add_u32 s64, s64, 131072
    buffer_load_dwordx4 v[208:211], v119, s[52:55], s64 offen
    s_add_u32 s64, s63, 5
    s_and_b32 s64, s64, 7
    s_lshl_b32 s64, s64, 6
    s_add_u32 s64, s64, s61
    s_add_u32 s64, s64, 131072
    buffer_load_dwordx4 v[212:215], v119, s[52:55], s64 offen
    s_add_u32 s64, s63, 6
    s_and_b32 s64, s64, 7
    s_lshl_b32 s64, s64, 6
    s_add_u32 s64, s64, s61
    s_add_u32 s64, s64, 131072
    buffer_load_dwordx4 v[216:219], v119, s[52:55], s64 offen
    s_add_u32 s64, s63, 7
    s_and_b32 s64, s64, 7
    s_lshl_b32 s64, s64, 6
    s_add_u32 s64, s64, s61
    s_add_u32 s64, s64, 131072
    buffer_load_dwordx4 v[220:223], v119, s[52:55], s64 offen
    s_add_u32 s64, s63, 0
    s_and_b32 s64, s64, 7
    s_lshl_b32 s64, s64, 6
    s_add_u32 s64, s64, s61
    s_add_u32 s64, s64, 196608
    buffer_load_dwordx4 v[224:227], v119, s[52:55], s64 offen
    s_add_u32 s64, s63, 1
    s_and_b32 s64, s64, 7
    s_lshl_b32 s64, s64, 6
    s_add_u32 s64, s64, s61
    s_add_u32 s64, s64, 196608
    buffer_load_dwordx4 v[228:231], v119, s[52:55], s64 offen
    s_add_u32 s64, s63, 2
    s_and_b32 s64, s64, 7
    s_lshl_b32 s64, s64, 6
    s_add_u32 s64, s64, s61
    s_add_u32 s64, s64, 196608
    buffer_load_dwordx4 v[232:235], v119, s[52:55], s64 offen
    s_add_u32 s64, s63, 3
    s_and_b32 s64, s64, 7
    s_lshl_b32 s64, s64, 6
    s_add_u32 s64, s64, s61
    s_add_u32 s64, s64, 196608
    buffer_load_dwordx4 v[236:239], v119, s[52:55], s64 offen
    s_add_u32 s64, s63, 4
    s_and_b32 s64, s64, 7
    s_lshl_b32 s64, s64, 6
    s_add_u32 s64, s64, s61
    s_add_u32 s64, s64, 196608
    buffer_load_dwordx4 v[240:243], v119, s[52:55], s64 offen
    s_add_u32 s64, s63, 5
    s_and_b32 s64, s64, 7
    s_lshl_b32 s64, s64, 6
    s_add_u32 s64, s64, s61
    s_add_u32 s64, s64, 196608
    buffer_load_dwordx4 v[244:247], v119, s[52:55], s64 offen
    s_add_u32 s64, s63, 6
    s_and_b32 s64, s64, 7
    s_lshl_b32 s64, s64, 6
    s_add_u32 s64, s64, s61
    s_add_u32 s64, s64, 196608
    buffer_load_dwordx4 v[248:251], v119, s[52:55], s64 offen
    s_add_u32 s64, s63, 7
    s_and_b32 s64, s64, 7
    s_lshl_b32 s64, s64, 6
    s_add_u32 s64, s64, s61
    s_add_u32 s64, s64, 196608
    buffer_load_dwordx4 v[252:255], v119, s[52:55], s64 offen
    s_mov_b32 s32, 140288
    buffer_load_dwordx4 v[8:11], v5, s[44:47], s32 offen sc0 sc1
    s_waitcnt vmcnt(0)
    s_barrier
    v_xor_b32 v8, s37, v8
    v_xor_b32 v9, s37, v9
    v_xor_b32 v10, s37, v10
    v_xor_b32 v11, s37, v11
    v_or_b32 v8, v8, v9
    v_or_b32 v10, v10, v11
    v_or_b32 v8, v8, v10
    v_cmp_ne_u32 vcc, 0, v8
    s_cbranch_vccz p2_prepB_ok
    s_mov_b32 s33, 140288
    s_mov_b32 s36, 0
p2_prepB_poll:
    buffer_load_dwordx4 v[8:11], v5, s[44:47], s33 offen sc0 sc1
    s_waitcnt vmcnt(0)
    v_xor_b32 v8, s37, v8
    v_xor_b32 v9, s37, v9
    v_xor_b32 v10, s37, v10
    v_xor_b32 v11, s37, v11
    v_or_b32 v8, v8, v9
    v_or_b32 v8, v8, v10
    v_or_b32 v8, v8, v11
    v_cmp_ne_u32 vcc, 0, v8
    s_add_u32 s36, s36, 1
    s_cbranch_vccz p2_prepB_poll_ok
    s_cmp_lt_u32 s36, 40000
    s_cbranch_scc1 p2_prepB_poll
p2_prepB_poll_ok:
p2_prepB_ok:
    s_mov_b32 s68, 1
    v_lshrrev_b32 v118, 2, v118
    v_mov_b32 v120, 0xff800000
    s_mov_b32 s36, 0
attn_slow_loop0:
    ds_read_b128 v[92:95], v116
    ds_read_b128 v[100:103], v117
    ds_read_b128 v[104:107], v117 offset:512
    s_waitcnt lgkmcnt(0)
    v_mfma_f32_32x32x16_bf16 v[20:35], v[92:95], v[12:15], 0
    s_nop 11
    v_max3_f32 v96, v20, v21, v120
    v_max3_f32 v96, v22, v23, v96
    v_max3_f32 v96, v24, v25, v96
    v_max3_f32 v96, v26, v27, v96
    v_max3_f32 v96, v28, v29, v96
    v_max3_f32 v96, v30, v31, v96
    v_max3_f32 v96, v32, v33, v96
    v_max3_f32 v96, v34, v35, v96
    v_mov_b32 v97, v96
    s_nop 1
    v_permlane32_swap_b32 v96, v97
    v_max_f32 v96, v96, v97
    v_sub_f32 v97, v120, v96
    v_exp_f32 v97, v97
    v_mov_b32 v120, v96
    v_sub_f32 v20, v20, v96
    v_exp_f32 v20, v20
    v_sub_f32 v21, v21, v96
    v_exp_f32 v21, v21
    v_sub_f32 v22, v22, v96
    v_exp_f32 v22, v22
    v_sub_f32 v23, v23, v96
    v_exp_f32 v23, v23
    v_sub_f32 v24, v24, v96
    v_exp_f32 v24, v24
    v_sub_f32 v25, v25, v96
    v_exp_f32 v25, v25
    v_sub_f32 v26, v26, v96
    v_exp_f32 v26, v26
    v_sub_f32 v27, v27, v96
    v_exp_f32 v27, v27
    v_sub_f32 v28, v28, v96
    v_exp_f32 v28, v28
    v_sub_f32 v29, v29, v96
    v_exp_f32 v29, v29
    v_sub_f32 v30, v30, v96
    v_exp_f32 v30, v30
    v_sub_f32 v31, v31, v96
    v_exp_f32 v31, v31
    v_sub_f32 v32, v32, v96
    v_exp_f32 v32, v32
    v_sub_f32 v33, v33, v96
    v_exp_f32 v33, v33
    v_sub_f32 v34, v34, v96
    v_exp_f32 v34, v34
    v_sub_f32 v35, v35, v96
    v_exp_f32 v35, v35
    v_mul_f32 v60, v97, v60
    v_mul_f32 v61, v97, v61
    v_mul_f32 v62, v97, v62
    v_mul_f32 v63, v97, v63
    v_mul_f32 v64, v97, v64
    v_mul_f32 v65, v97, v65
    v_mul_f32 v66, v97, v66
    v_mul_f32 v67, v97, v67
    v_mul_f32 v68, v97, v68
    v_cvt_pk_bf16_f32 v52, v20, v21
    v_cvt_pk_bf16_f32 v53, v22, v23
    v_cvt_pk_bf16_f32 v54, v24, v25
    v_cvt_pk_bf16_f32 v55, v26, v27
    v_cvt_pk_bf16_f32 v56, v28, v29
    v_cvt_pk_bf16_f32 v57, v30, v31
    v_cvt_pk_bf16_f32 v58, v32, v33
    v_cvt_pk_bf16_f32 v59, v34, v35
    s_nop 1
    v_mfma_f32_32x32x16_bf16 v[60:75], v[100:103], v[52:55], v[60:75]
    v_mfma_f32_32x32x16_bf16 v[60:75], v[104:107], v[56:59], v[60:75]
    v_add_u32 v116, 1024, v116
    v_add_u32 v117, v118, v117
    s_add_u32 s36, s36, 1
    s_cmp_lt_u32 s36, 32
    s_nop 7
    s_cbranch_scc1 attn_slow_loop0
    v_subrev_u32 v116, 32768, v116
    v_lshlrev_b32 v3, 5, v118
    v_sub_u32 v117, v117, v3
    v_mov_b32 v121, 0xff800000
    s_mov_b32 s36, 0
attn_slow_loop1:
    ds_read_b128 v[92:95], v116
    ds_read_b128 v[100:103], v117
    ds_read_b128 v[104:107], v117 offset:512
    s_waitcnt lgkmcnt(0)
    v_mfma_f32_32x32x16_bf16 v[20:35], v[92:95], v[16:19], 0
    s_nop 11
    v_max3_f32 v96, v20, v21, v121
    v_max3_f32 v96, v22, v23, v96
    v_max3_f32 v96, v24, v25, v96
    v_max3_f32 v96, v26, v27, v96
    v_max3_f32 v96, v28, v29, v96
    v_max3_f32 v96, v30, v31, v96
    v_max3_f32 v96, v32, v33, v96
    v_max3_f32 v96, v34, v35, v96
    v_mov_b32 v97, v96
    s_nop 1
    v_permlane32_swap_b32 v96, v97
    v_max_f32 v96, v96, v97
    v_sub_f32 v97, v121, v96
    v_exp_f32 v97, v97
    v_mov_b32 v121, v96
    v_sub_f32 v20, v20, v96
    v_exp_f32 v20, v20
    v_sub_f32 v21, v21, v96
    v_exp_f32 v21, v21
    v_sub_f32 v22, v22, v96
    v_exp_f32 v22, v22
    v_sub_f32 v23, v23, v96
    v_exp_f32 v23, v23
    v_sub_f32 v24, v24, v96
    v_exp_f32 v24, v24
    v_sub_f32 v25, v25, v96
    v_exp_f32 v25, v25
    v_sub_f32 v26, v26, v96
    v_exp_f32 v26, v26
    v_sub_f32 v27, v27, v96
    v_exp_f32 v27, v27
    v_sub_f32 v28, v28, v96
    v_exp_f32 v28, v28
    v_sub_f32 v29, v29, v96
    v_exp_f32 v29, v29
    v_sub_f32 v30, v30, v96
    v_exp_f32 v30, v30
    v_sub_f32 v31, v31, v96
    v_exp_f32 v31, v31
    v_sub_f32 v32, v32, v96
    v_exp_f32 v32, v32
    v_sub_f32 v33, v33, v96
    v_exp_f32 v33, v33
    v_sub_f32 v34, v34, v96
    v_exp_f32 v34, v34
    v_sub_f32 v35, v35, v96
    v_exp_f32 v35, v35
    v_mul_f32 v76, v97, v76
    v_mul_f32 v77, v97, v77
    v_mul_f32 v78, v97, v78
    v_mul_f32 v79, v97, v79
    v_mul_f32 v80, v97, v80
    v_mul_f32 v81, v97, v81
    v_mul_f32 v82, v97, v82
    v_mul_f32 v83, v97, v83
    v_mul_f32 v84, v97, v84
    v_cvt_pk_bf16_f32 v52, v20, v21
    v_cvt_pk_bf16_f32 v53, v22, v23
    v_cvt_pk_bf16_f32 v54, v24, v25
    v_cvt_pk_bf16_f32 v55, v26, v27
    v_cvt_pk_bf16_f32 v56, v28, v29
    v_cvt_pk_bf16_f32 v57, v30, v31
    v_cvt_pk_bf16_f32 v58, v32, v33
    v_cvt_pk_bf16_f32 v59, v34, v35
    s_nop 1
    v_mfma_f32_32x32x16_bf16 v[76:91], v[100:103], v[52:55], v[76:91]
    v_mfma_f32_32x32x16_bf16 v[76:91], v[104:107], v[56:59], v[76:91]
    v_add_u32 v116, 1024, v116
    v_add_u32 v117, v118, v117
    s_add_u32 s36, s36, 1
    s_cmp_lt_u32 s36, 32
    s_nop 7
    s_cbranch_scc1 attn_slow_loop1
attn_comb:
    s_memtime s[40:41]
    s_waitcnt lgkmcnt(0)
    v_writelane_b32 v0, s40, 7
    s_nop 15
    s_mul_i32 s32, s3, 2560
    v_add_u32 v2, s32, v5
    v_add_u32 v2, 143360, v2
    v_lshlrev_b32 v3, 3, v1
    v_add_u32 v3, s32, v3
    v_add_u32 v3, 145408, v3
    s_cmp_ge_u32 s3, 4
    s_cbranch_scc1 attn_comb1
    v_mov_b32 v85, v121
    ds_write_b128 v2, v[76:79]
    ds_write_b128 v2, v[80:83] offset:1024
    ds_write_b64 v3, v[84:85]
    v_mov_b32 v36, v60
    v_mov_b32 v37, v61
    v_mov_b32 v38, v62
    v_mov_b32 v39, v63
    v_mov_b32 v40, v64
    v_mov_b32 v41, v65
    v_mov_b32 v42, v66
    v_mov_b32 v43, v67
    v_mov_b32 v44, v68
    v_mov_b32 v45, v120
    s_branch attn_comb2
attn_comb1:
    v_mov_b32 v69, v120
    ds_write_b128 v2, v[60:63]
    ds_write_b128 v2, v[64:67] offset:1024
    ds_write_b64 v3, v[68:69]
    v_mov_b32 v36, v76
    v_mov_b32 v37, v77
    v_mov_b32 v38, v78
    v_mov_b32 v39, v79
    v_mov_b32 v40, v80
    v_mov_b32 v41, v81
    v_mov_b32 v42, v82
    v_mov_b32 v43, v83
    v_mov_b32 v44, v84
    v_mov_b32 v45, v121
attn_comb2:
    s_xor_b32 s32, s3, 4
    s_sub_u32 s32, s32, s3
    s_mul_i32 s32, s32, 2560
    v_add_u32 v2, s32, v2
    v_add_u32 v3, s32, v3
    s_waitcnt lgkmcnt(0)
    s_barrier
    s_cmp_eq_u32 s68, 0
    s_cbranch_scc1 p2_wodone
    s_add_u32 m0, s66, 0
    s_add_u32 s98, s67, 0
    buffer_load_dwordx4 v5, s[44:47], s98 offen sc0 sc1 lds
    s_add_u32 m0, s66, 1024
    s_add_u32 s98, s67, 1024
    buffer_load_dwordx4 v5, s[44:47], s98 offen sc0 sc1 lds
    s_add_u32 m0, s66, 2048
    s_add_u32 s98, s67, 2048
    buffer_load_dwordx4 v5, s[44:47], s98 offen sc0 sc1 lds
    s_add_u32 m0, s66, 3072
    s_add_u32 s98, s67, 3072
    buffer_load_dwordx4 v5, s[44:47], s98 offen sc0 sc1 lds
    s_add_u32 m0, s66, 4096
    s_add_u32 s98, s67, 4096
    buffer_load_dwordx4 v5, s[44:47], s98 offen sc0 sc1 lds
    s_add_u32 m0, s66, 5120
    s_add_u32 s98, s67, 5120
    buffer_load_dwordx4 v5, s[44:47], s98 offen sc0 sc1 lds
    s_add_u32 m0, s66, 6144
    s_add_u32 s98, s67, 6144
    buffer_load_dwordx4 v5, s[44:47], s98 offen sc0 sc1 lds
    s_add_u32 m0, s66, 7168
    s_add_u32 s98, s67, 7168
    buffer_load_dwordx4 v5, s[44:47], s98 offen sc0 sc1 lds
p2_wodone:
    ds_read_b128 v[20:23], v2
    ds_read_b128 v[24:27], v2 offset:1024
    ds_read_b64 v[28:29], v3
    s_lshl_b32 s69, s30, 2
    s_add_u32 s69, s69, s38
    s_lshl_b32 s69, s69, 4
    s_lshl_b32 s33, s31, 1
    s_add_u32 s69, s69, s33
    s_add_u32 s69, s69, s39
    s_waitcnt lgkmcnt(0)
    v_max_f32 v4, v45, v29
    v_sub_f32 v45, v45, v4
    v_sub_f32 v29, v29, v4
    v_exp_f32 v45, v45
    v_exp_f32 v29, v29
    s_nop 0
    v_mul_f32 v36, v45, v36
    v_fmac_f32 v36, v29, v20
    v_mul_f32 v37, v45, v37
    v_fmac_f32 v37, v29, v21
    v_mul_f32 v38, v45, v38
    v_fmac_f32 v38, v29, v22
    v_mul_f32 v39, v45, v39
    v_fmac_f32 v39, v29, v23
    v_mul_f32 v40, v45, v40
    v_fmac_f32 v40, v29, v24
    v_mul_f32 v41, v45, v41
    v_fmac_f32 v41, v29, v25
    v_mul_f32 v42, v45, v42
    v_fmac_f32 v42, v29, v26
    v_mul_f32 v43, v45, v43
    v_fmac_f32 v43, v29, v27
    v_mul_f32 v44, v45, v44
    v_fmac_f32 v44, v29, v28
    v_mov_b32 v4, v44
    s_nop 1
    v_permlane32_swap_b32 v44, v4
    v_add_f32 v44, v44, v4
    v_rcp_f32 v4, v44
    s_nop 0
    v_mul_f32 v36, v4, v36
    v_mul_f32 v37, v4, v37
    v_mul_f32 v38, v4, v38
    v_mul_f32 v39, v4, v39
    v_mul_f32 v40, v4, v40
    v_mul_f32 v41, v4, v41
    v_mul_f32 v42, v4, v42
    v_mul_f32 v43, v4, v43
    v_cvt_pk_bf16_f32 v52, v36, v37
    v_cvt_pk_bf16_f32 v53, v38, v39
    v_cvt_pk_bf16_f32 v54, v40, v41
    v_cvt_pk_bf16_f32 v55, v42, v43
    s_mul_i32 s32, s69, 1280
    s_add_u32 s32, s32, 33554432
    v_xor_b32 v4, v52, v53
    v_xor_b32 v4, v4, v54
    v_xor_b32 v4, v4, v55
    v_xor_b32 v4, s37, v4
    buffer_store_dwordx4 v[52:55], v5, s[44:47], s32 offen sc0 sc1
    buffer_store_dword v4, v6, s[44:47], s32 offen offset:1024 sc0 sc1
    s_memtime s[40:41]
    s_waitcnt lgkmcnt(0)
    v_writelane_b32 v0, s40, 8
    s_lshr_b32 s33, s3, 1
    s_lshl_b32 s33, s33, 15
    s_and_b32 s32, s3, 1
    s_lshl_b32 s32, s32, 13
    s_add_u32 s33, s33, s32
    s_mul_i32 s32, s31, 114688
    s_lshl_b32 s34, s3, 13
    s_add_u32 s32, s32, s34
    s_add_u32 m0, s33, 16384
    s_add_u32 s98, s32, 23986176
    buffer_load_dwordx4 v5, s[44:47], s98 offen sc0 sc1 lds
    s_add_u32 m0, s33, 17408
    s_add_u32 s98, s32, 23987200
    buffer_load_dwordx4 v5, s[44:47], s98 offen sc0 sc1 lds
    s_add_u32 m0, s33, 18432
    s_add_u32 s98, s32, 23988224
    buffer_load_dwordx4 v5, s[44:47], s98 offen sc0 sc1 lds
    s_add_u32 m0, s33, 19456
    s_add_u32 s98, s32, 23989248
    buffer_load_dwordx4 v5, s[44:47], s98 offen sc0 sc1 lds
    s_add_u32 m0, s33, 20480
    s_add_u32 s98, s32, 23990272
    buffer_load_dwordx4 v5, s[44:47], s98 offen sc0 sc1 lds
    s_add_u32 m0, s33, 21504
    s_add_u32 s98, s32, 23991296
    buffer_load_dwordx4 v5, s[44:47], s98 offen sc0 sc1 lds
    s_add_u32 m0, s33, 22528
    s_add_u32 s98, s32, 23992320
    buffer_load_dwordx4 v5, s[44:47], s98 offen sc0 sc1 lds
    s_add_u32 m0, s33, 23552
    s_add_u32 s98, s32, 23993344
    buffer_load_dwordx4 v5, s[44:47], s98 offen sc0 sc1 lds
    v_and_b32 v7, 15, v1
    v_lshlrev_b32 v7, 10, v7
    v_lshrrev_b32 v3, 4, v1
    v_lshl_add_u32 v7, v3, 4, v7
    s_lshl_b32 s42, s30, 16
    s_lshl_b32 s33, s38, 14
    s_add_u32 s42, s42, s33
    s_lshl_b32 s33, s31, 7
    s_add_u32 s42, s42, s33
    s_lshl_b32 s33, s39, 6
    s_add_u32 s42, s42, s33
    buffer_load_dwordx4 v[12:15], v7, s[48:51], s42 offen
    s_lshl_b32 s43, s30, 2
    s_add_u32 s43, s43, s38
    s_lshl_b32 s43, s43, 4
    s_lshl_b32 s32, s39, 3
    s_add_u32 s43, s43, s32
    s_lshl_b32 s32, s39, 13
    v_add_u32 v56, s32, v5
    v_add_u32 v57, 65536, v56
    s_mul_i32 s32, s43, 1280
    s_add_u32 s32, s32, 33554432
    s_waitcnt vmcnt(0)
    s_mov_b32 s36, 0
p3_poll:
    s_mov_b32 s33, s32
    buffer_load_dwordx4 v[16:19], v5, s[44:47], s33 offen sc0 sc1
    buffer_load_dword v48, v6, s[44:47], s33 offen offset:1024 sc0 sc1
    s_add_u32 s33, s33, 1280
    buffer_load_dwordx4 v[20:23], v5, s[44:47], s33 offen sc0 sc1
    buffer_load_dword v49, v6, s[44:47], s33 offen offset:1024 sc0 sc1
    s_add_u32 s33, s33, 1280
    buffer_load_dwordx4 v[24:27], v5, s[44:47], s33 offen sc0 sc1
    buffer_load_dword v50, v6, s[44:47], s33 offen offset:1024 sc0 sc1
    s_add_u32 s33, s33, 1280
    buffer_load_dwordx4 v[28:31], v5, s[44:47], s33 offen sc0 sc1
    buffer_load_dword v51, v6, s[44:47], s33 offen offset:1024 sc0 sc1
    s_add_u32 s33, s33, 1280
    buffer_load_dwordx4 v[32:35], v5, s[44:47], s33 offen sc0 sc1
    buffer_load_dword v52, v6, s[44:47], s33 offen offset:1024 sc0 sc1
    s_add_u32 s33, s33, 1280
    buffer_load_dwordx4 v[36:39], v5, s[44:47], s33 offen sc0 sc1
    buffer_load_dword v53, v6, s[44:47], s33 offen offset:1024 sc0 sc1
    s_add_u32 s33, s33, 1280
    buffer_load_dwordx4 v[40:43], v5, s[44:47], s33 offen sc0 sc1
    buffer_load_dword v54, v6, s[44:47], s33 offen offset:1024 sc0 sc1
    s_add_u32 s33, s33, 1280
    buffer_load_dwordx4 v[44:47], v5, s[44:47], s33 offen sc0 sc1
    buffer_load_dword v55, v6, s[44:47], s33 offen offset:1024 sc0 sc1
    s_waitcnt vmcnt(0)
    v_xor_b32 v48, v48, v16
    v_xor_b32 v48, v48, v17
    v_xor_b32 v48, v48, v18
    v_xor_b32 v48, v48, v19
    v_xor_b32 v48, s37, v48
    v_xor_b32 v49, v49, v20
    v_xor_b32 v49, v49, v21
    v_xor_b32 v49, v49, v22
    v_xor_b32 v49, v49, v23
    v_xor_b32 v49, s37, v49
    v_xor_b32 v50, v50, v24
    v_xor_b32 v50, v50, v25
    v_xor_b32 v50, v50, v26
    v_xor_b32 v50, v50, v27
    v_xor_b32 v50, s37, v50
    v_xor_b32 v51, v51, v28
    v_xor_b32 v51, v51, v29
    v_xor_b32 v51, v51, v30
    v_xor_b32 v51, v51, v31
    v_xor_b32 v51, s37, v51
    v_xor_b32 v52, v52, v32
    v_xor_b32 v52, v52, v33
    v_xor_b32 v52, v52, v34
    v_xor_b32 v52, v52, v35
    v_xor_b32 v52, s37, v52
    v_xor_b32 v53, v53, v36
    v_xor_b32 v53, v53, v37
    v_xor_b32 v53, v53, v38
    v_xor_b32 v53, v53, v39
    v_xor_b32 v53, s37, v53
    v_xor_b32 v54, v54, v40
    v_xor_b32 v54, v54, v41
    v_xor_b32 v54, v54, v42
    v_xor_b32 v54, v54, v43
    v_xor_b32 v54, s37, v54
    v_xor_b32 v55, v55, v44
    v_xor_b32 v55, v55, v45
    v_xor_b32 v55, v55, v46
    v_xor_b32 v55, v55, v47
    v_xor_b32 v55, s37, v55
    v_or_b32 v48, v48, v49
    v_or_b32 v48, v48, v50
    v_or_b32 v48, v48, v51
    v_or_b32 v48, v48, v52
    v_or_b32 v48, v48, v53
    v_or_b32 v48, v48, v54
    v_or_b32 v48, v48, v55
    v_cmp_ne_u32 vcc, 0, v48
    s_add_u32 s36, s36, 1
    s_cbranch_vccz p3_poll_ok
    s_cmp_lt_u32 s36, 40000
    s_cbranch_scc1 p3_poll
p3_poll_ok:
    s_memtime s[40:41]
    s_waitcnt lgkmcnt(0)
    v_writelane_b32 v0, s40, 9
    s_barrier
    s_memtime s[40:41]
    s_waitcnt lgkmcnt(0)
    v_writelane_b32 v0, s40, 10
    ds_read_b128 v[76:79], v56 offset:0
    ds_read_b128 v[80:83], v56 offset:32768
    ds_read_b128 v[84:87], v57 offset:0
    ds_read_b128 v[88:91], v57 offset:32768
    v_lshlrev_b32 v108, 16, v12
    v_and_b32 v109, 0xffff0000, v12
    v_lshlrev_b32 v110, 16, v13
    v_and_b32 v111, 0xffff0000, v13
    v_lshlrev_b32 v112, 16, v14
    v_and_b32 v113, 0xffff0000, v14
    v_lshlrev_b32 v114, 16, v15
    v_and_b32 v115, 0xffff0000, v15
    ds_read_b128 v[92:95], v56 offset:1024
    ds_read_b128 v[96:99], v56 offset:33792
    ds_read_b128 v[100:103], v57 offset:1024
    ds_read_b128 v[104:107], v57 offset:33792
    s_waitcnt lgkmcnt(4)
    v_mfma_f32_16x16x32_bf16 v[60:63], v[76:79], v[16:19], 0
    v_mfma_f32_16x16x32_bf16 v[64:67], v[80:83], v[16:19], 0
    v_mfma_f32_16x16x32_bf16 v[68:71], v[84:87], v[16:19], 0
    v_mfma_f32_16x16x32_bf16 v[72:75], v[88:91], v[16:19], 0
    ds_read_b128 v[76:79], v56 offset:2048
    ds_read_b128 v[80:83], v56 offset:34816
    ds_read_b128 v[84:87], v57 offset:2048
    ds_read_b128 v[88:91], v57 offset:34816
    s_waitcnt lgkmcnt(4)
    v_mfma_f32_16x16x32_bf16 v[60:63], v[92:95], v[20:23], v[60:63]
    v_mfma_f32_16x16x32_bf16 v[64:67], v[96:99], v[20:23], v[64:67]
    v_mfma_f32_16x16x32_bf16 v[68:71], v[100:103], v[20:23], v[68:71]
    v_mfma_f32_16x16x32_bf16 v[72:75], v[104:107], v[20:23], v[72:75]
    ds_read_b128 v[92:95], v56 offset:3072
    ds_read_b128 v[96:99], v56 offset:35840
    ds_read_b128 v[100:103], v57 offset:3072
    ds_read_b128 v[104:107], v57 offset:35840
    s_waitcnt lgkmcnt(4)
    v_mfma_f32_16x16x32_bf16 v[60:63], v[76:79], v[24:27], v[60:63]
    v_mfma_f32_16x16x32_bf16 v[64:67], v[80:83], v[24:27], v[64:67]
    v_mfma_f32_16x16x32_bf16 v[68:71], v[84:87], v[24:27], v[68:71]
    v_mfma_f32_16x16x32_bf16 v[72:75], v[88:91], v[24:27], v[72:75]
    ds_read_b128 v[76:79], v56 offset:4096
    ds_read_b128 v[80:83], v56 offset:36864
    ds_read_b128 v[84:87], v57 offset:4096
    ds_read_b128 v[88:91], v57 offset:36864
    s_waitcnt lgkmcnt(4)
    v_mfma_f32_16x16x32_bf16 v[60:63], v[92:95], v[28:31], v[60:63]
    v_mfma_f32_16x16x32_bf16 v[64:67], v[96:99], v[28:31], v[64:67]
    v_mfma_f32_16x16x32_bf16 v[68:71], v[100:103], v[28:31], v[68:71]
    v_mfma_f32_16x16x32_bf16 v[72:75], v[104:107], v[28:31], v[72:75]
    ds_read_b128 v[92:95], v56 offset:5120
    ds_read_b128 v[96:99], v56 offset:37888
    ds_read_b128 v[100:103], v57 offset:5120
    ds_read_b128 v[104:107], v57 offset:37888
    s_waitcnt lgkmcnt(4)
    v_mfma_f32_16x16x32_bf16 v[60:63], v[76:79], v[32:35], v[60:63]
    v_mfma_f32_16x16x32_bf16 v[64:67], v[80:83], v[32:35], v[64:67]
    v_mfma_f32_16x16x32_bf16 v[68:71], v[84:87], v[32:35], v[68:71]
    v_mfma_f32_16x16x32_bf16 v[72:75], v[88:91], v[32:35], v[72:75]
    ds_read_b128 v[76:79], v56 offset:6144
    ds_read_b128 v[80:83], v56 offset:38912
    ds_read_b128 v[84:87], v57 offset:6144
    ds_read_b128 v[88:91], v57 offset:38912
    s_waitcnt lgkmcnt(4)
    v_mfma_f32_16x16x32_bf16 v[60:63], v[92:95], v[36:39], v[60:63]
    v_mfma_f32_16x16x32_bf16 v[64:67], v[96:99], v[36:39], v[64:67]
    v_mfma_f32_16x16x32_bf16 v[68:71], v[100:103], v[36:39], v[68:71]
    v_mfma_f32_16x16x32_bf16 v[72:75], v[104:107], v[36:39], v[72:75]
    ds_read_b128 v[92:95], v56 offset:7168
    ds_read_b128 v[96:99], v56 offset:39936
    ds_read_b128 v[100:103], v57 offset:7168
    ds_read_b128 v[104:107], v57 offset:39936
    s_waitcnt lgkmcnt(4)
    v_mfma_f32_16x16x32_bf16 v[60:63], v[76:79], v[40:43], v[60:63]
    v_mfma_f32_16x16x32_bf16 v[64:67], v[80:83], v[40:43], v[64:67]
    v_mfma_f32_16x16x32_bf16 v[68:71], v[84:87], v[40:43], v[68:71]
    v_mfma_f32_16x16x32_bf16 v[72:75], v[88:91], v[40:43], v[72:75]
    s_waitcnt lgkmcnt(0)
    v_mfma_f32_16x16x32_bf16 v[60:63], v[92:95], v[44:47], v[60:63]
    v_mfma_f32_16x16x32_bf16 v[64:67], v[96:99], v[44:47], v[64:67]
    v_mfma_f32_16x16x32_bf16 v[68:71], v[100:103], v[44:47], v[68:71]
    v_mfma_f32_16x16x32_bf16 v[72:75], v[104:107], v[44:47], v[72:75]
    s_nop 7
    s_lshl_b32 s32, s3, 11
    s_add_u32 s32, s32, 147456
    v_add_u32 v2, s32, v5
    s_cmp_eq_u32 s39, 0
    s_cbranch_scc0 p3_kh1
    ds_write_b128 v2, v[68:71] offset:0
    v_add_f32 v116, v60, v108
    v_add_f32 v117, v61, v109
    v_add_f32 v118, v62, v110
    v_add_f32 v119, v63, v111
    ds_write_b128 v2, v[72:75] offset:1024
    v_add_f32 v120, v64, v112
    v_add_f32 v121, v65, v113
    v_add_f32 v122, v66, v114
    v_add_f32 v123, v67, v115
    s_branch p3_x
p3_kh1:
    ds_write_b128 v2, v[60:63] offset:0
    v_add_f32 v116, v68, v108
    v_add_f32 v117, v69, v109
    v_add_f32 v118, v70, v110
    v_add_f32 v119, v71, v111
    ds_write_b128 v2, v[64:67] offset:1024
    v_add_f32 v120, v72, v112
    v_add_f32 v121, v73, v113
    v_add_f32 v122, v74, v114
    v_add_f32 v123, v75, v115
p3_x:
    s_xor_b32 s32, s3, 4
    s_lshl_b32 s32, s32, 11
    s_add_u32 s32, s32, 147456
    v_add_u32 v2, s32, v5
    s_waitcnt lgkmcnt(0)
    s_barrier
    ds_read_b128 v[60:63], v2
    ds_read_b128 v[64:67], v2 offset:1024
    s_waitcnt lgkmcnt(0)
    v_add_f32 v116, v116, v60
    v_add_f32 v117, v117, v61
    v_add_f32 v118, v118, v62
    v_add_f32 v119, v119, v63
    v_add_f32 v120, v120, v64
    v_add_f32 v121, v121, v65
    v_add_f32 v122, v122, v66
    v_add_f32 v123, v123, v67
    v_cvt_pk_bf16_f32 v8, v116, v117
    v_cvt_pk_bf16_f32 v9, v118, v119
    v_cvt_pk_bf16_f32 v10, v120, v121
    v_cvt_pk_bf16_f32 v11, v122, v123
    s_mul_i32 s32, s69, 1280
    s_add_u32 s32, s32, 36700160
    v_xor_b32 v4, v8, v9
    v_xor_b32 v4, v4, v10
    v_xor_b32 v4, v4, v11
    v_xor_b32 v4, s37, v4
    buffer_store_dwordx4 v[8:11], v5, s[44:47], s32 offen sc0 sc1
    buffer_store_dword v4, v6, s[44:47], s32 offen offset:1024 sc0 sc1
    v_mov_b32 v64, 0x3f803f80
    v_dot2_f32_bf16 v60, v8, v64, 0
    v_dot2_f32_bf16 v61, v8, v8, 0
    v_dot2_f32_bf16 v60, v9, v64, v60
    v_dot2_f32_bf16 v61, v9, v9, v61
    v_dot2_f32_bf16 v60, v10, v64, v60
    v_dot2_f32_bf16 v61, v10, v10, v61
    v_dot2_f32_bf16 v60, v11, v64, v60
    v_dot2_f32_bf16 v61, v11, v11, v61
    s_nop 2
    v_mov_b32 v3, v60
    s_nop 1
    v_permlane16_swap_b32 v60, v3
    v_add_f32 v60, v60, v3
    v_mov_b32 v3, v60
    s_nop 1
    v_permlane32_swap_b32 v60, v3
    v_add_f32 v60, v60, v3
    v_mov_b32 v3, v61
    s_nop 1
    v_permlane16_swap_b32 v61, v3
    v_add_f32 v61, v61, v3
    v_mov_b32 v3, v61
    s_nop 1
    v_permlane32_swap_b32 v61, v3
    v_add_f32 v61, v61, v3
    v_mov_b32 v62, s37
    v_mov_b32 v63, s37
    s_lshl_b32 s32, s69, 8
    s_add_u32 s32, s32, 46137344
    s_mov_b64 exec, 0xffff
    buffer_store_dwordx4 v[60:63], v5, s[44:47], s32 offen sc0 sc1
    s_mov_b64 exec, -1
    s_memtime s[40:41]
    s_waitcnt lgkmcnt(0)
    v_writelane_b32 v0, s40, 11
    s_mul_i32 s32, s31, 114688
    s_mul_i32 s34, s3, 6
    s_add_u32 s33, s34, 0
    s_lshr_b32 s35, s33, 4
    s_lshl_b32 s35, s35, 15
    s_and_b32 s98, s33, 15
    s_lshl_b32 s98, s98, 10
    s_add_u32 m0, s35, s98
    s_lshl_b32 s33, s33, 10
    s_add_u32 s33, s33, s32
    s_add_u32 s98, s33, 24051712
    buffer_load_dwordx4 v5, s[44:47], s98 offen sc0 sc1 lds
    s_add_u32 s33, s34, 1
    s_lshr_b32 s35, s33, 4
    s_lshl_b32 s35, s35, 15
    s_and_b32 s98, s33, 15
    s_lshl_b32 s98, s98, 10
    s_add_u32 m0, s35, s98
    s_lshl_b32 s33, s33, 10
    s_add_u32 s33, s33, s32
    s_add_u32 s98, s33, 24051712
    buffer_load_dwordx4 v5, s[44:47], s98 offen sc0 sc1 lds
    s_add_u32 s33, s34, 2
    s_lshr_b32 s35, s33, 4
    s_lshl_b32 s35, s35, 15
    s_and_b32 s98, s33, 15
    s_lshl_b32 s98, s98, 10
    s_add_u32 m0, s35, s98
    s_lshl_b32 s33, s33, 10
    s_add_u32 s33, s33, s32
    s_add_u32 s98, s33, 24051712
    buffer_load_dwordx4 v5, s[44:47], s98 offen sc0 sc1 lds
    s_add_u32 s33, s34, 3
    s_lshr_b32 s35, s33, 4
    s_lshl_b32 s35, s35, 15
    s_and_b32 s98, s33, 15
    s_lshl_b32 s98, s98, 10
    s_add_u32 m0, s35, s98
    s_lshl_b32 s33, s33, 10
    s_add_u32 s33, s33, s32
    s_add_u32 s98, s33, 24051712
    buffer_load_dwordx4 v5, s[44:47], s98 offen sc0 sc1 lds
    s_add_u32 s33, s34, 4
    s_lshr_b32 s35, s33, 4
    s_lshl_b32 s35, s35, 15
    s_and_b32 s98, s33, 15
    s_lshl_b32 s98, s98, 10
    s_add_u32 m0, s35, s98
    s_lshl_b32 s33, s33, 10
    s_add_u32 s33, s33, s32
    s_add_u32 s98, s33, 24051712
    buffer_load_dwordx4 v5, s[44:47], s98 offen sc0 sc1 lds
    s_add_u32 s33, s34, 5
    s_lshr_b32 s35, s33, 4
    s_lshl_b32 s35, s35, 15
    s_and_b32 s98, s33, 15
    s_lshl_b32 s98, s98, 10
    s_add_u32 m0, s35, s98
    s_lshl_b32 s33, s33, 10
    s_add_u32 s33, s33, s32
    s_add_u32 s98, s33, 24051712
    buffer_load_dwordx4 v5, s[44:47], s98 offen sc0 sc1 lds
    v_lshrrev_b32 v2, 2, v1
    v_mul_u32_u24 v2, 7168, v2
    v_and_b32 v3, 3, v1
    v_lshl_add_u32 v2, v3, 4, v2
    s_mul_i32 s32, s31, 7
    s_add_u32 s32, s32, s3
    s_min_u32 s32, s32, 55
    s_lshl_b32 s32, s32, 6
    s_add_u32 s32, s32, 48234496
    s_add_u32 s33, s32, 3584
    buffer_load_dwordx4 v[76:79], v2, s[44:47], s33 offen sc0 sc1
    buffer_load_dwordx4 v[80:83], v2, s[44:47], s32 offen sc0 sc1
    v_lshrrev_b32 v2, 4, v1
    v_lshlrev_b32 v2, 10, v2
    v_and_b32 v3, 15, v1
    v_lshl_add_u32 v2, v3, 4, v2
    s_and_b32 s34, s43, 0xfffffff0
    s_lshl_b32 s34, s34, 8
    s_add_u32 s34, s34, 46137344
    s_mul_i32 s32, s43, 1280
    s_add_u32 s32, s32, 36700160
    s_waitcnt vmcnt(0)
    v_add_f32_dpp v76, v76, v76 row_ror:4 row_mask:0xf bank_mask:0xf
    v_add_f32_dpp v77, v77, v77 row_ror:4 row_mask:0xf bank_mask:0xf
    v_add_f32_dpp v78, v78, v78 row_ror:4 row_mask:0xf bank_mask:0xf
    v_add_f32_dpp v79, v79, v79 row_ror:4 row_mask:0xf bank_mask:0xf
    v_add_f32_dpp v80, v80, v80 row_ror:4 row_mask:0xf bank_mask:0xf
    v_add_f32_dpp v81, v81, v81 row_ror:4 row_mask:0xf bank_mask:0xf
    v_add_f32_dpp v82, v82, v82 row_ror:4 row_mask:0xf bank_mask:0xf
    v_add_f32_dpp v83, v83, v83 row_ror:4 row_mask:0xf bank_mask:0xf
    v_add_f32_dpp v76, v76, v76 row_ror:8 row_mask:0xf bank_mask:0xf
    v_add_f32_dpp v77, v77, v77 row_ror:8 row_mask:0xf bank_mask:0xf
    v_add_f32_dpp v78, v78, v78 row_ror:8 row_mask:0xf bank_mask:0xf
    v_add_f32_dpp v79, v79, v79 row_ror:8 row_mask:0xf bank_mask:0xf
    v_add_f32_dpp v80, v80, v80 row_ror:8 row_mask:0xf bank_mask:0xf
    v_add_f32_dpp v81, v81, v81 row_ror:8 row_mask:0xf bank_mask:0xf
    v_add_f32_dpp v82, v82, v82 row_ror:8 row_mask:0xf bank_mask:0xf
    v_add_f32_dpp v83, v83, v83 row_ror:8 row_mask:0xf bank_mask:0xf
    v_mov_b32 v3, v76
    s_nop 1
    v_permlane16_swap_b32 v76, v3
    v_add_f32 v76, v76, v3
    v_mov_b32 v3, v76
    s_nop 1
    v_permlane32_swap_b32 v76, v3
    v_add_f32 v76, v76, v3
    v_mov_b32 v3, v77
    s_nop 1
    v_permlane16_swap_b32 v77, v3
    v_add_f32 v77, v77, v3
    v_mov_b32 v3, v77
    s_nop 1
    v_permlane32_swap_b32 v77, v3
    v_add_f32 v77, v77, v3
    v_mov_b32 v3, v78
    s_nop 1
    v_permlane16_swap_b32 v78, v3
    v_add_f32 v78, v78, v3
    v_mov_b32 v3, v78
    s_nop 1
    v_permlane32_swap_b32 v78, v3
    v_add_f32 v78, v78, v3
    v_mov_b32 v3, v79
    s_nop 1
    v_permlane16_swap_b32 v79, v3
    v_add_f32 v79, v79, v3
    v_mov_b32 v3, v79
    s_nop 1
    v_permlane32_swap_b32 v79, v3
    v_add_f32 v79, v79, v3
    v_mov_b32 v3, v80
    s_nop 1
    v_permlane16_swap_b32 v80, v3
    v_add_f32 v80, v80, v3
    v_mov_b32 v3, v80
    s_nop 1
    v_permlane32_swap_b32 v80, v3
    v_add_f32 v80, v80, v3
    v_mov_b32 v3, v81
    s_nop 1
    v_permlane16_swap_b32 v81, v3
    v_add_f32 v81, v81, v3
    v_mov_b32 v3, v81
    s_nop 1
    v_permlane32_swap_b32 v81, v3
    v_add_f32 v81, v81, v3
    v_mov_b32 v3, v82
    s_nop 1
    v_permlane16_swap_b32 v82, v3
    v_add_f32 v82, v82, v3
    v_mov_b32 v3, v82
    s_nop 1
    v_permlane32_swap_b32 v82, v3
    v_add_f32 v82, v82, v3
    v_mov_b32 v3, v83
    s_nop 1
    v_permlane16_swap_b32 v83, v3
    v_add_f32 v83, v83, v3
    v_mov_b32 v3, v83
    s_nop 1
    v_permlane32_swap_b32 v83, v3
    v_add_f32 v83, v83, v3
    s_lshl_b32 s32, s3, 6
    v_lshlrev_b32 v2, 4, v1
    v_add_u32 v2, s32, v2
    s_cmp_eq_u32 s3, 7
    s_cbranch_scc1 p4_csskip
    v_add_u32 v2, 101376, v2
    s_mov_b64 exec, 0xf
    ds_write_b128 v2, v[76:79]
    ds_write_b128 v2, v[80:83] offset:512
    s_mov_b64 exec, -1
p4_csskip:
    v_lshrrev_b32 v2, 4, v1
    v_lshlrev_b32 v2, 10, v2
    v_and_b32 v3, 15, v1
    v_lshl_add_u32 v2, v3, 4, v2
    s_mul_i32 s32, s43, 1280
    s_add_u32 s32, s32, 36700160
    s_mov_b32 s36, 0
p4_poll:
    s_mov_b32 s33, s32
    buffer_load_dwordx4 v[16:19], v5, s[44:47], s33 offen sc0 sc1
    buffer_load_dword v108, v6, s[44:47], s33 offen offset:1024 sc0 sc1
    s_add_u32 s33, s33, 1280
    buffer_load_dwordx4 v[20:23], v5, s[44:47], s33 offen sc0 sc1
    buffer_load_dword v109, v6, s[44:47], s33 offen offset:1024 sc0 sc1
    s_add_u32 s33, s33, 1280
    buffer_load_dwordx4 v[24:27], v5, s[44:47], s33 offen sc0 sc1
    buffer_load_dword v110, v6, s[44:47], s33 offen offset:1024 sc0 sc1
    s_add_u32 s33, s33, 1280
    buffer_load_dwordx4 v[28:31], v5, s[44:47], s33 offen sc0 sc1
    buffer_load_dword v111, v6, s[44:47], s33 offen offset:1024 sc0 sc1
    s_add_u32 s33, s33, 1280
    buffer_load_dwordx4 v[32:35], v5, s[44:47], s33 offen sc0 sc1
    buffer_load_dword v112, v6, s[44:47], s33 offen offset:1024 sc0 sc1
    s_add_u32 s33, s33, 1280
    buffer_load_dwordx4 v[36:39], v5, s[44:47], s33 offen sc0 sc1
    buffer_load_dword v113, v6, s[44:47], s33 offen offset:1024 sc0 sc1
    s_add_u32 s33, s33, 1280
    buffer_load_dwordx4 v[40:43], v5, s[44:47], s33 offen sc0 sc1
    buffer_load_dword v114, v6, s[44:47], s33 offen offset:1024 sc0 sc1
    s_add_u32 s33, s33, 1280
    buffer_load_dwordx4 v[44:47], v5, s[44:47], s33 offen sc0 sc1
    buffer_load_dword v115, v6, s[44:47], s33 offen offset:1024 sc0 sc1
    buffer_load_dwordx4 v[92:95], v2, s[44:47], s34 offen offset:0 sc0 sc1
    buffer_load_dwordx4 v[96:99], v2, s[44:47], s34 offen offset:256 sc0 sc1
    buffer_load_dwordx4 v[100:103], v2, s[44:47], s34 offen offset:512 sc0 sc1
    buffer_load_dwordx4 v[104:107], v2, s[44:47], s34 offen offset:768 sc0 sc1
    s_waitcnt vmcnt(0)
    v_xor_b32 v108, v108, v16
    v_xor_b32 v108, v108, v17
    v_xor_b32 v108, v108, v18
    v_xor_b32 v108, v108, v19
    v_xor_b32 v108, s37, v108
    v_xor_b32 v109, v109, v20
    v_xor_b32 v109, v109, v21
    v_xor_b32 v109, v109, v22
    v_xor_b32 v109, v109, v23
    v_xor_b32 v109, s37, v109
    v_xor_b32 v110, v110, v24
    v_xor_b32 v110, v110, v25
    v_xor_b32 v110, v110, v26
    v_xor_b32 v110, v110, v27
    v_xor_b32 v110, s37, v110
    v_xor_b32 v111, v111, v28
    v_xor_b32 v111, v111, v29
    v_xor_b32 v111, v111, v30
    v_xor_b32 v111, v111, v31
    v_xor_b32 v111, s37, v111
    v_xor_b32 v112, v112, v32
    v_xor_b32 v112, v112, v33
    v_xor_b32 v112, v112, v34
    v_xor_b32 v112, v112, v35
    v_xor_b32 v112, s37, v112
    v_xor_b32 v113, v113, v36
    v_xor_b32 v113, v113, v37
    v_xor_b32 v113, v113, v38
    v_xor_b32 v113, v113, v39
    v_xor_b32 v113, s37, v113
    v_xor_b32 v114, v114, v40
    v_xor_b32 v114, v114, v41
    v_xor_b32 v114, v114, v42
    v_xor_b32 v114, v114, v43
    v_xor_b32 v114, s37, v114
    v_xor_b32 v115, v115, v44
    v_xor_b32 v115, v115, v45
    v_xor_b32 v115, v115, v46
    v_xor_b32 v115, v115, v47
    v_xor_b32 v115, s37, v115
    v_or_b32 v108, v108, v109
    v_or_b32 v108, v108, v110
    v_or_b32 v108, v108, v111
    v_or_b32 v108, v108, v112
    v_or_b32 v108, v108, v113
    v_or_b32 v108, v108, v114
    v_or_b32 v108, v108, v115
    v_xor_b32 v3, s37, v94
    v_or_b32 v108, v108, v3
    v_xor_b32 v3, s37, v98
    v_or_b32 v108, v108, v3
    v_xor_b32 v3, s37, v102
    v_or_b32 v108, v108, v3
    v_xor_b32 v3, s37, v106
    v_or_b32 v108, v108, v3
    v_cmp_ne_u32 vcc, 0, v108
    s_add_u32 s36, s36, 1
    s_cbranch_vccz p4_poll_ok
    s_cmp_lt_u32 s36, 40000
    s_cbranch_scc1 p4_poll
p4_poll_ok:
    s_memtime s[40:41]
    s_waitcnt lgkmcnt(0)
    v_writelane_b32 v0, s40, 12
    s_waitcnt lgkmcnt(0)
    s_barrier
    s_memtime s[40:41]
    s_waitcnt lgkmcnt(0)
    v_writelane_b32 v0, s40, 13
    s_lshl_b32 s32, s39, 13
    v_add_u32 v12, s32, v5
    v_add_u32 v13, 65536, v12
    ds_read_b128 v[76:79], v12 offset:16384
    ds_read_b128 v[80:83], v12 offset:49152
    ds_read_b128 v[84:87], v13 offset:16384
    ds_read_b128 v[88:91], v13 offset:49152
    s_waitcnt lgkmcnt(3)
    v_mfma_f32_16x16x32_bf16 v[48:51], v[76:79], v[16:19], 0
    ds_read_b128 v[76:79], v12 offset:0
    s_waitcnt lgkmcnt(3)
    v_mfma_f32_16x16x32_bf16 v[52:55], v[80:83], v[16:19], 0
    ds_read_b128 v[80:83], v12 offset:32768
    s_waitcnt lgkmcnt(3)
    v_mfma_f32_16x16x32_bf16 v[56:59], v[84:87], v[16:19], 0
    ds_read_b128 v[84:87], v13 offset:0
    s_waitcnt lgkmcnt(3)
    v_mfma_f32_16x16x32_bf16 v[60:63], v[88:91], v[16:19], 0
    ds_read_b128 v[88:91], v12 offset:17408
    s_waitcnt lgkmcnt(3)
    v_mfma_f32_16x16x32_bf16 v[64:67], v[76:79], v[16:19], 0
    ds_read_b128 v[76:79], v12 offset:50176
    s_waitcnt lgkmcnt(3)
    v_mfma_f32_16x16x32_bf16 v[68:71], v[80:83], v[16:19], 0
    ds_read_b128 v[80:83], v13 offset:17408
    s_waitcnt lgkmcnt(3)
    v_mfma_f32_16x16x32_bf16 v[72:75], v[84:87], v[16:19], 0
    ds_read_b128 v[84:87], v13 offset:50176
    s_waitcnt lgkmcnt(3)
    v_mfma_f32_16x16x32_bf16 v[48:51], v[88:91], v[20:23], v[48:51]
    ds_read_b128 v[88:91], v12 offset:1024
    s_waitcnt lgkmcnt(3)
    v_mfma_f32_16x16x32_bf16 v[52:55], v[76:79], v[20:23], v[52:55]
    ds_read_b128 v[76:79], v12 offset:33792
    s_waitcnt lgkmcnt(3)
    v_mfma_f32_16x16x32_bf16 v[56:59], v[80:83], v[20:23], v[56:59]
    ds_read_b128 v[80:83], v13 offset:1024
    s_waitcnt lgkmcnt(3)
    v_mfma_f32_16x16x32_bf16 v[60:63], v[84:87], v[20:23], v[60:63]
    ds_read_b128 v[84:87], v12 offset:18432
    s_waitcnt lgkmcnt(3)
    v_mfma_f32_16x16x32_bf16 v[64:67], v[88:91], v[20:23], v[64:67]
    ds_read_b128 v[88:91], v12 offset:51200
    s_waitcnt lgkmcnt(3)
    v_mfma_f32_16x16x32_bf16 v[68:71], v[76:79], v[20:23], v[68:71]
    ds_read_b128 v[76:79], v13 offset:18432
    s_waitcnt lgkmcnt(3)
    v_mfma_f32_16x16x32_bf16 v[72:75], v[80:83], v[20:23], v[72:75]
    ds_read_b128 v[80:83], v13 offset:51200
    s_waitcnt lgkmcnt(3)
    v_mfma_f32_16x16x32_bf16 v[48:51], v[84:87], v[24:27], v[48:51]
    ds_read_b128 v[84:87], v12 offset:2048
    s_waitcnt lgkmcnt(3)
    v_mfma_f32_16x16x32_bf16 v[52:55], v[88:91], v[24:27], v[52:55]
    ds_read_b128 v[88:91], v12 offset:34816
    s_waitcnt lgkmcnt(3)
    v_mfma_f32_16x16x32_bf16 v[56:59], v[76:79], v[24:27], v[56:59]
    ds_read_b128 v[76:79], v13 offset:2048
    s_waitcnt lgkmcnt(3)
    v_mfma_f32_16x16x32_bf16 v[60:63], v[80:83], v[24:27], v[60:63]
    ds_read_b128 v[80:83], v12 offset:19456
    s_waitcnt lgkmcnt(3)
    v_mfma_f32_16x16x32_bf16 v[64:67], v[84:87], v[24:27], v[64:67]
    ds_read_b128 v[84:87], v12 offset:52224
    s_waitcnt lgkmcnt(3)
    v_mfma_f32_16x16x32_bf16 v[68:71], v[88:91], v[24:27], v[68:71]
    ds_read_b128 v[88:91], v13 offset:19456
    s_waitcnt lgkmcnt(3)
    v_mfma_f32_16x16x32_bf16 v[72:75], v[76:79], v[24:27], v[72:75]
    ds_read_b128 v[76:79], v13 offset:52224
    s_waitcnt lgkmcnt(3)
    v_mfma_f32_16x16x32_bf16 v[48:51], v[80:83], v[28:31], v[48:51]
    ds_read_b128 v[80:83], v12 offset:3072
    s_waitcnt lgkmcnt(3)
    v_mfma_f32_16x16x32_bf16 v[52:55], v[84:87], v[28:31], v[52:55]
    ds_read_b128 v[84:87], v12 offset:35840
    s_waitcnt lgkmcnt(3)
    v_mfma_f32_16x16x32_bf16 v[56:59], v[88:91], v[28:31], v[56:59]
    ds_read_b128 v[88:91], v13 offset:3072
    s_waitcnt lgkmcnt(3)
    v_mfma_f32_16x16x32_bf16 v[60:63], v[76:79], v[28:31], v[60:63]
    ds_read_b128 v[76:79], v12 offset:20480
    s_waitcnt lgkmcnt(3)
    v_mfma_f32_16x16x32_bf16 v[64:67], v[80:83], v[28:31], v[64:67]
    ds_read_b128 v[80:83], v12 offset:53248
    s_waitcnt lgkmcnt(3)
    v_mfma_f32_16x16x32_bf16 v[68:71], v[84:87], v[28:31], v[68:71]
    ds_read_b128 v[84:87], v13 offset:20480
    s_waitcnt lgkmcnt(3)
    v_mfma_f32_16x16x32_bf16 v[72:75], v[88:91], v[28:31], v[72:75]
    ds_read_b128 v[88:91], v13 offset:53248
    s_waitcnt lgkmcnt(3)
    v_mfma_f32_16x16x32_bf16 v[48:51], v[76:79], v[32:35], v[48:51]
    ds_read_b128 v[76:79], v12 offset:4096
    s_waitcnt lgkmcnt(3)
    v_mfma_f32_16x16x32_bf16 v[52:55], v[80:83], v[32:35], v[52:55]
    ds_read_b128 v[80:83], v12 offset:36864
    s_waitcnt lgkmcnt(3)
    v_mfma_f32_16x16x32_bf16 v[56:59], v[84:87], v[32:35], v[56:59]
    ds_read_b128 v[84:87], v13 offset:4096
    s_waitcnt lgkmcnt(3)
    v_mfma_f32_16x16x32_bf16 v[60:63], v[88:91], v[32:35], v[60:63]
    ds_read_b128 v[88:91], v12 offset:21504
    s_waitcnt lgkmcnt(3)
    v_mfma_f32_16x16x32_bf16 v[64:67], v[76:79], v[32:35], v[64:67]
    ds_read_b128 v[76:79], v12 offset:54272
    s_waitcnt lgkmcnt(3)
    v_mfma_f32_16x16x32_bf16 v[68:71], v[80:83], v[32:35], v[68:71]
    ds_read_b128 v[80:83], v13 offset:21504
    s_waitcnt lgkmcnt(3)
    v_mfma_f32_16x16x32_bf16 v[72:75], v[84:87], v[32:35], v[72:75]
    ds_read_b128 v[84:87], v13 offset:54272
    s_waitcnt lgkmcnt(3)
    v_mfma_f32_16x16x32_bf16 v[48:51], v[88:91], v[36:39], v[48:51]
    ds_read_b128 v[88:91], v12 offset:5120
    s_waitcnt lgkmcnt(3)
    v_mfma_f32_16x16x32_bf16 v[52:55], v[76:79], v[36:39], v[52:55]
    ds_read_b128 v[76:79], v12 offset:37888
    s_waitcnt lgkmcnt(3)
    v_mfma_f32_16x16x32_bf16 v[56:59], v[80:83], v[36:39], v[56:59]
    ds_read_b128 v[80:83], v13 offset:5120
    s_waitcnt lgkmcnt(3)
    v_mfma_f32_16x16x32_bf16 v[60:63], v[84:87], v[36:39], v[60:63]
    ds_read_b128 v[84:87], v12 offset:22528
    s_waitcnt lgkmcnt(3)
    v_mfma_f32_16x16x32_bf16 v[64:67], v[88:91], v[36:39], v[64:67]
    ds_read_b128 v[88:91], v12 offset:55296
    s_waitcnt lgkmcnt(3)
    v_mfma_f32_16x16x32_bf16 v[68:71], v[76:79], v[36:39], v[68:71]
    ds_read_b128 v[76:79], v13 offset:22528
    s_waitcnt lgkmcnt(3)
    v_mfma_f32_16x16x32_bf16 v[72:75], v[80:83], v[36:39], v[72:75]
    ds_read_b128 v[80:83], v13 offset:55296
    s_waitcnt lgkmcnt(3)
    v_mfma_f32_16x16x32_bf16 v[48:51], v[84:87], v[40:43], v[48:51]
    ds_read_b128 v[84:87], v12 offset:6144
    s_waitcnt lgkmcnt(3)
    v_mfma_f32_16x16x32_bf16 v[52:55], v[88:91], v[40:43], v[52:55]
    ds_read_b128 v[88:91], v12 offset:38912
    s_waitcnt lgkmcnt(3)
    v_mfma_f32_16x16x32_bf16 v[56:59], v[76:79], v[40:43], v[56:59]
    ds_read_b128 v[76:79], v13 offset:6144
    s_waitcnt lgkmcnt(3)
    v_mfma_f32_16x16x32_bf16 v[60:63], v[80:83], v[40:43], v[60:63]
    ds_read_b128 v[80:83], v12 offset:23552
    s_waitcnt lgkmcnt(3)
    v_mfma_f32_16x16x32_bf16 v[64:67], v[84:87], v[40:43], v[64:67]
    ds_read_b128 v[84:87], v12 offset:56320
    s_waitcnt lgkmcnt(3)
    v_mfma_f32_16x16x32_bf16 v[68:71], v[88:91], v[40:43], v[68:71]
    ds_read_b128 v[88:91], v13 offset:23552
    s_waitcnt lgkmcnt(3)
    v_mfma_f32_16x16x32_bf16 v[72:75], v[76:79], v[40:43], v[72:75]
    ds_read_b128 v[76:79], v13 offset:56320
    s_waitcnt lgkmcnt(3)
    v_mfma_f32_16x16x32_bf16 v[48:51], v[80:83], v[44:47], v[48:51]
    ds_read_b128 v[80:83], v12 offset:7168
    s_waitcnt lgkmcnt(3)
    v_mfma_f32_16x16x32_bf16 v[52:55], v[84:87], v[44:47], v[52:55]
    ds_read_b128 v[84:87], v12 offset:39936
    s_waitcnt lgkmcnt(3)
    v_mfma_f32_16x16x32_bf16 v[56:59], v[88:91], v[44:47], v[56:59]
    ds_read_b128 v[88:91], v13 offset:7168
    s_waitcnt lgkmcnt(3)
    v_mfma_f32_16x16x32_bf16 v[60:63], v[76:79], v[44:47], v[60:63]
    s_waitcnt lgkmcnt(2)
    v_mfma_f32_16x16x32_bf16 v[64:67], v[80:83], v[44:47], v[64:67]
    s_waitcnt lgkmcnt(1)
    v_mfma_f32_16x16x32_bf16 v[68:71], v[84:87], v[44:47], v[68:71]
    s_waitcnt lgkmcnt(0)
    v_mfma_f32_16x16x32_bf16 v[72:75], v[88:91], v[44:47], v[72:75]
    s_nop 7
    s_memtime s[40:41]
    s_waitcnt lgkmcnt(0)
    v_writelane_b32 v0, s40, 14
    v_add_f32 v92, v92, v96
    v_add_f32 v93, v93, v97
    v_add_f32 v92, v92, v100
    v_add_f32 v93, v93, v101
    v_add_f32 v92, v92, v104
    v_add_f32 v93, v93, v105
    v_mov_b32 v3, v92
    s_nop 1
    v_permlane16_swap_b32 v92, v3
    v_add_f32 v92, v92, v3
    v_mov_b32 v3, v92
    s_nop 1
    v_permlane32_swap_b32 v92, v3
    v_add_f32 v92, v92, v3
    v_mov_b32 v3, v93
    s_nop 1
    v_permlane16_swap_b32 v93, v3
    v_add_f32 v93, v93, v3
    v_mov_b32 v3, v93
    s_nop 1
    v_permlane32_swap_b32 v93, v3
    v_add_f32 v93, v93, v3
    v_mul_f32 v14, 0x3b000000, v92
    v_mul_f32 v93, 0x3b000000, v93
    v_fma_f32 v93, -v14, v14, v93
    v_max_f32 v93, 0, v93
    v_add_f32 v93, 0x3727c5ac, v93
    v_rsq_f32 v15, v93
    s_lshr_b32 s33, s3, 2
    s_lshl_b32 s33, s33, 15
    s_and_b32 s32, s3, 3
    s_lshl_b32 s32, s32, 12
    s_add_u32 s32, s32, s33
    s_add_u32 s32, s32, 98304
    v_add_u32 v2, s32, v5
    s_cmp_eq_u32 s39, 0
    s_cbranch_scc0 p4e2_kh1
    ds_write_b128 v2, v[64:67] offset:0
    ds_write_b128 v2, v[68:71] offset:1024
    ds_write_b128 v2, v[72:75] offset:2048
    v_mov_b32 v92, v48
    v_mov_b32 v93, v49
    v_mov_b32 v94, v50
    v_mov_b32 v95, v51
    v_mov_b32 v96, v52
    v_mov_b32 v97, v53
    v_mov_b32 v98, v54
    v_mov_b32 v99, v55
    v_mov_b32 v100, v56
    v_mov_b32 v101, v57
    v_mov_b32 v102, v58
    v_mov_b32 v103, v59
    v_mov_b32 v104, v60
    v_mov_b32 v105, v61
    v_mov_b32 v106, v62
    v_mov_b32 v107, v63
    s_branch p4e2_x
p4e2_kh1:
    ds_write_b128 v2, v[48:51] offset:0
    ds_write_b128 v2, v[52:55] offset:1024
    ds_write_b128 v2, v[56:59] offset:2048
    ds_write_b128 v2, v[60:63] offset:3072
    v_mov_b32 v92, v64
    v_mov_b32 v93, v65
    v_mov_b32 v94, v66
    v_mov_b32 v95, v67
    v_mov_b32 v96, v68
    v_mov_b32 v97, v69
    v_mov_b32 v98, v70
    v_mov_b32 v99, v71
    v_mov_b32 v100, v72
    v_mov_b32 v101, v73
    v_mov_b32 v102, v74
    v_mov_b32 v103, v75
    v_mov_b32 v104, 0
    v_mov_b32 v105, 0
    v_mov_b32 v106, 0
    v_mov_b32 v107, 0
p4e2_x:
    s_waitcnt lgkmcnt(0)
    s_barrier
    s_xor_b32 s34, s3, 4
    s_lshr_b32 s33, s34, 2
    s_lshl_b32 s33, s33, 15
    s_and_b32 s32, s34, 3
    s_lshl_b32 s32, s32, 12
    s_add_u32 s32, s32, s33
    s_add_u32 s32, s32, 98304
    v_add_u32 v2, s32, v5
    ds_read_b128 v[48:51], v2 offset:0
    ds_read_b128 v[52:55], v2 offset:1024
    ds_read_b128 v[56:59], v2 offset:2048
    ds_read_b128 v[60:63], v2 offset:3072
    s_lshl_b32 s32, s39, 8
    s_add_u32 s32, s32, 101376
    v_lshrrev_b32 v2, 4, v1
    v_lshlrev_b32 v2, 4, v2
    v_add_u32 v2, s32, v2
    ds_read_b128 v[76:79], v2 offset:0
    ds_read_b128 v[80:83], v2 offset:64
    ds_read_b128 v[84:87], v2 offset:128
    ds_read_b128 v[88:91], v2 offset:192
    s_waitcnt lgkmcnt(0)
    v_add_f32 v92, v92, v48
    v_fma_f32 v92, -v14, v76, v92
    v_mul_f32 v92, v15, v92
    v_add_f32 v93, v93, v49
    v_fma_f32 v93, -v14, v77, v93
    v_mul_f32 v93, v15, v93
    v_add_f32 v94, v94, v50
    v_fma_f32 v94, -v14, v78, v94
    v_mul_f32 v94, v15, v94
    v_add_f32 v95, v95, v51
    v_fma_f32 v95, -v14, v79, v95
    v_mul_f32 v95, v15, v95
    v_add_f32 v96, v96, v52
    v_fma_f32 v96, -v14, v80, v96
    v_mul_f32 v96, v15, v96
    v_add_f32 v97, v97, v53
    v_fma_f32 v97, -v14, v81, v97
    v_mul_f32 v97, v15, v97
    v_add_f32 v98, v98, v54
    v_fma_f32 v98, -v14, v82, v98
    v_mul_f32 v98, v15, v98
    v_add_f32 v99, v99, v55
    v_fma_f32 v99, -v14, v83, v99
    v_mul_f32 v99, v15, v99
    v_add_f32 v100, v100, v56
    v_fma_f32 v100, -v14, v84, v100
    v_mul_f32 v100, v15, v100
    v_add_f32 v101, v101, v57
    v_fma_f32 v101, -v14, v85, v101
    v_mul_f32 v101, v15, v101
    v_add_f32 v102, v102, v58
    v_fma_f32 v102, -v14, v86, v102
    v_mul_f32 v102, v15, v102
    v_add_f32 v103, v103, v59
    v_fma_f32 v103, -v14, v87, v103
    v_mul_f32 v103, v15, v103
    v_add_f32 v104, v104, v60
    v_fma_f32 v104, -v14, v88, v104
    v_mul_f32 v104, v15, v104
    v_add_f32 v105, v105, v61
    v_fma_f32 v105, -v14, v89, v105
    v_mul_f32 v105, v15, v105
    v_add_f32 v106, v106, v62
    v_fma_f32 v106, -v14, v90, v106
    v_mul_f32 v106, v15, v106
    v_add_f32 v107, v107, v63
    v_fma_f32 v107, -v14, v91, v107
    v_mul_f32 v107, v15, v107
    v_mov_b32 v108, 0xc0135761
    v_mul_f32 v48, v92, v92
    v_mul_f32 v49, v93, v93
    v_mul_f32 v50, v94, v94
    v_mul_f32 v51, v95, v95
    v_mul_f32 v52, v96, v96
    v_mul_f32 v53, v97, v97
    v_mul_f32 v54, v98, v98
    v_mul_f32 v55, v99, v99
    v_mul_f32 v56, v100, v100
    v_mul_f32 v57, v101, v101
    v_mul_f32 v58, v102, v102
    v_mul_f32 v59, v103, v103
    v_mul_f32 v60, v104, v104
    v_mul_f32 v61, v105, v105
    v_mul_f32 v62, v106, v106
    v_mul_f32 v63, v107, v107
    v_fmamk_f32 v48, v48, 0xbdd2d3e8, v108
    v_fmamk_f32 v49, v49, 0xbdd2d3e8, v108
    v_fmamk_f32 v50, v50, 0xbdd2d3e8, v108
    v_fmamk_f32 v51, v51, 0xbdd2d3e8, v108
    v_fmamk_f32 v52, v52, 0xbdd2d3e8, v108
    v_fmamk_f32 v53, v53, 0xbdd2d3e8, v108
    v_fmamk_f32 v54, v54, 0xbdd2d3e8, v108
    v_fmamk_f32 v55, v55, 0xbdd2d3e8, v108
    v_fmamk_f32 v56, v56, 0xbdd2d3e8, v108
    v_fmamk_f32 v57, v57, 0xbdd2d3e8, v108
    v_fmamk_f32 v58, v58, 0xbdd2d3e8, v108
    v_fmamk_f32 v59, v59, 0xbdd2d3e8, v108
    v_fmamk_f32 v60, v60, 0xbdd2d3e8, v108
    v_fmamk_f32 v61, v61, 0xbdd2d3e8, v108
    v_fmamk_f32 v62, v62, 0xbdd2d3e8, v108
    v_fmamk_f32 v63, v63, 0xbdd2d3e8, v108
    v_mul_f32 v48, v48, v92
    v_mul_f32 v49, v49, v93
    v_mul_f32 v50, v50, v94
    v_mul_f32 v51, v51, v95
    v_mul_f32 v52, v52, v96
    v_mul_f32 v53, v53, v97
    v_mul_f32 v54, v54, v98
    v_mul_f32 v55, v55, v99
    v_mul_f32 v56, v56, v100
    v_mul_f32 v57, v57, v101
    v_mul_f32 v58, v58, v102
    v_mul_f32 v59, v59, v103
    v_mul_f32 v60, v60, v104
    v_mul_f32 v61, v61, v105
    v_mul_f32 v62, v62, v106
    v_mul_f32 v63, v63, v107
    v_exp_f32 v48, v48
    v_exp_f32 v49, v49
    v_exp_f32 v50, v50
    v_exp_f32 v51, v51
    v_exp_f32 v52, v52
    v_exp_f32 v53, v53
    v_exp_f32 v54, v54
    v_exp_f32 v55, v55
    v_exp_f32 v56, v56
    v_exp_f32 v57, v57
    v_exp_f32 v58, v58
    v_exp_f32 v59, v59
    v_exp_f32 v60, v60
    v_exp_f32 v61, v61
    v_exp_f32 v62, v62
    v_exp_f32 v63, v63
    v_add_f32 v48, 1.0, v48
    v_add_f32 v49, 1.0, v49
    v_add_f32 v50, 1.0, v50
    v_add_f32 v51, 1.0, v51
    v_add_f32 v52, 1.0, v52
    v_add_f32 v53, 1.0, v53
    v_add_f32 v54, 1.0, v54
    v_add_f32 v55, 1.0, v55
    v_add_f32 v56, 1.0, v56
    v_add_f32 v57, 1.0, v57
    v_add_f32 v58, 1.0, v58
    v_add_f32 v59, 1.0, v59
    v_add_f32 v60, 1.0, v60
    v_add_f32 v61, 1.0, v61
    v_add_f32 v62, 1.0, v62
    v_add_f32 v63, 1.0, v63
    v_rcp_f32 v48, v48
    v_rcp_f32 v49, v49
    v_rcp_f32 v50, v50
    v_rcp_f32 v51, v51
    v_rcp_f32 v52, v52
    v_rcp_f32 v53, v53
    v_rcp_f32 v54, v54
    v_rcp_f32 v55, v55
    v_rcp_f32 v56, v56
    v_rcp_f32 v57, v57
    v_rcp_f32 v58, v58
    v_rcp_f32 v59, v59
    v_rcp_f32 v60, v60
    v_rcp_f32 v61, v61
    v_rcp_f32 v62, v62
    v_rcp_f32 v63, v63
    s_nop 0
    v_mul_f32 v92, v92, v48
    v_mul_f32 v93, v93, v49
    v_mul_f32 v94, v94, v50
    v_mul_f32 v95, v95, v51
    v_mul_f32 v96, v96, v52
    v_mul_f32 v97, v97, v53
    v_mul_f32 v98, v98, v54
    v_mul_f32 v99, v99, v55
    v_mul_f32 v100, v100, v56
    v_mul_f32 v101, v101, v57
    v_mul_f32 v102, v102, v58
    v_mul_f32 v103, v103, v59
    v_mul_f32 v104, v104, v60
    v_mul_f32 v105, v105, v61
    v_mul_f32 v106, v106, v62
    v_mul_f32 v107, v107, v63
    s_cmp_eq_u32 s39, 0
    s_cbranch_scc1 p4_nz
    v_mov_b32 v104, 0
    v_mov_b32 v105, 0
    v_mov_b32 v106, 0
    v_mov_b32 v107, 0
p4_nz:
    v_add_f32 v76, v92, v93
    v_mul_f32 v77, v92, v92
    v_fmac_f32 v77, v93, v93
    v_add_f32 v76, v76, v94
    v_fmac_f32 v77, v94, v94
    v_add_f32 v76, v76, v95
    v_fmac_f32 v77, v95, v95
    v_add_f32 v76, v76, v96
    v_fmac_f32 v77, v96, v96
    v_add_f32 v76, v76, v97
    v_fmac_f32 v77, v97, v97
    v_add_f32 v76, v76, v98
    v_fmac_f32 v77, v98, v98
    v_add_f32 v76, v76, v99
    v_fmac_f32 v77, v99, v99
    v_add_f32 v76, v76, v100
    v_fmac_f32 v77, v100, v100
    v_add_f32 v76, v76, v101
    v_fmac_f32 v77, v101, v101
    v_add_f32 v76, v76, v102
    v_fmac_f32 v77, v102, v102
    v_add_f32 v76, v76, v103
    v_fmac_f32 v77, v103, v103
    v_add_f32 v76, v76, v104
    v_fmac_f32 v77, v104, v104
    v_add_f32 v76, v76, v105
    v_fmac_f32 v77, v105, v105
    v_add_f32 v76, v76, v106
    v_fmac_f32 v77, v106, v106
    v_add_f32 v76, v76, v107
    v_fmac_f32 v77, v107, v107
    v_mov_b32 v3, v76
    s_nop 1
    v_permlane16_swap_b32 v76, v3
    v_add_f32 v76, v76, v3
    v_mov_b32 v3, v76
    s_nop 1
    v_permlane32_swap_b32 v76, v3
    v_add_f32 v76, v76, v3
    v_mov_b32 v3, v77
    s_nop 1
    v_permlane16_swap_b32 v77, v3
    v_add_f32 v77, v77, v3
    v_mov_b32 v3, v77
    s_nop 1
    v_permlane32_swap_b32 v77, v3
    v_add_f32 v77, v77, v3
    v_mov_b32 v78, s37
    v_mov_b32 v79, s37
    s_lshl_b32 s32, s69, 8
    s_add_u32 s32, s32, 16777216
    s_mov_b64 exec, 0xffff
    buffer_store_dwordx4 v[76:79], v5, s[44:47], s32 offen sc0 sc1
    s_mov_b64 exec, -1
    v_cvt_pk_bf16_f32 v112, v92, v93
    v_cvt_pk_bf16_f32 v113, v94, v95
    v_cvt_pk_bf16_f32 v114, v96, v97
    v_cvt_pk_bf16_f32 v115, v98, v99
    v_cvt_pk_bf16_f32 v116, v100, v101
    v_cvt_pk_bf16_f32 v117, v102, v103
    v_cvt_pk_bf16_f32 v118, v104, v105
    v_cvt_pk_bf16_f32 v119, v106, v107
    s_memtime s[40:41]
    s_waitcnt lgkmcnt(0)
    v_writelane_b32 v0, s40, 15
    s_cmp_eq_u32 s3, 7
    s_cbranch_scc1 p4_g7
    s_lshl_b32 s32, s3, 15
    s_add_u32 s33, s32, 16384
    s_sub_u32 s34, s32, 131072
    s_cmp_lt_u32 s3, 4
    s_cselect_b32 s33, s33, s34
    s_lshl_b32 s32, s3, 14
    s_mul_i32 s34, s31, 114688
    s_add_u32 s32, s32, s34
    s_add_u32 m0, s33, 0
    s_add_u32 s98, s32, 23068672
    buffer_load_dwordx4 v5, s[44:47], s98 offen sc0 sc1 lds
    s_add_u32 m0, s33, 1024
    s_add_u32 s98, s32, 23069696
    buffer_load_dwordx4 v5, s[44:47], s98 offen sc0 sc1 lds
    s_add_u32 m0, s33, 2048
    s_add_u32 s98, s32, 23070720
    buffer_load_dwordx4 v5, s[44:47], s98 offen sc0 sc1 lds
    s_add_u32 m0, s33, 3072
    s_add_u32 s98, s32, 23071744
    buffer_load_dwordx4 v5, s[44:47], s98 offen sc0 sc1 lds
    s_add_u32 m0, s33, 4096
    s_add_u32 s98, s32, 23072768
    buffer_load_dwordx4 v5, s[44:47], s98 offen sc0 sc1 lds
    s_add_u32 m0, s33, 5120
    s_add_u32 s98, s32, 23073792
    buffer_load_dwordx4 v5, s[44:47], s98 offen sc0 sc1 lds
    s_add_u32 m0, s33, 6144
    s_add_u32 s98, s32, 23074816
    buffer_load_dwordx4 v5, s[44:47], s98 offen sc0 sc1 lds
    s_add_u32 m0, s33, 7168
    s_add_u32 s98, s32, 23075840
    buffer_load_dwordx4 v5, s[44:47], s98 offen sc0 sc1 lds
    s_add_u32 m0, s33, 8192
    s_add_u32 s98, s32, 23076864
    buffer_load_dwordx4 v5, s[44:47], s98 offen sc0 sc1 lds
    s_add_u32 m0, s33, 9216
    s_add_u32 s98, s32, 23077888
    buffer_load_dwordx4 v5, s[44:47], s98 offen sc0 sc1 lds
    s_add_u32 m0, s33, 10240
    s_add_u32 s98, s32, 23078912
    buffer_load_dwordx4 v5, s[44:47], s98 offen sc0 sc1 lds
    s_add_u32 m0, s33, 11264
    s_add_u32 s98, s32, 23079936
    buffer_load_dwordx4 v5, s[44:47], s98 offen sc0 sc1 lds
    s_add_u32 m0, s33, 12288
    s_add_u32 s98, s32, 23080960
    buffer_load_dwordx4 v5, s[44:47], s98 offen sc0 sc1 lds
    s_add_u32 m0, s33, 13312
    s_add_u32 s98, s32, 23081984
    buffer_load_dwordx4 v5, s[44:47], s98 offen sc0 sc1 lds
    s_add_u32 m0, s33, 14336
    s_add_u32 s98, s32, 23083008
    buffer_load_dwordx4 v5, s[44:47], s98 offen sc0 sc1 lds
    s_add_u32 m0, s33, 15360
    s_add_u32 s98, s32, 23084032
    buffer_load_dwordx4 v5, s[44:47], s98 offen sc0 sc1 lds
    s_branch p4_gdone
p4_g7:
    v_lshrrev_b32 v2, 4, v1
    v_lshlrev_b32 v2, 12, v2
    v_and_b32 v3, 15, v1
    v_lshl_add_u32 v2, v3, 4, v2
    s_lshl_b32 s52, s30, 14
    s_add_u32 s52, s52, 16777216
    s_mov_b32 s36, 0
p4_gpoll:
    buffer_load_dwordx4 v[48:51], v2, s[44:47], s52 offen offset:0 sc0 sc1
    buffer_load_dwordx4 v[52:55], v2, s[44:47], s52 offen offset:256 sc0 sc1
    buffer_load_dwordx4 v[56:59], v2, s[44:47], s52 offen offset:512 sc0 sc1
    buffer_load_dwordx4 v[60:63], v2, s[44:47], s52 offen offset:768 sc0 sc1
    buffer_load_dwordx4 v[64:67], v2, s[44:47], s52 offen offset:1024 sc0 sc1
    buffer_load_dwordx4 v[68:71], v2, s[44:47], s52 offen offset:1280 sc0 sc1
    buffer_load_dwordx4 v[72:75], v2, s[44:47], s52 offen offset:1536 sc0 sc1
    buffer_load_dwordx4 v[92:95], v2, s[44:47], s52 offen offset:1792 sc0 sc1
    buffer_load_dwordx4 v[96:99], v2, s[44:47], s52 offen offset:2048 sc0 sc1
    buffer_load_dwordx4 v[100:103], v2, s[44:47], s52 offen offset:2304 sc0 sc1
    buffer_load_dwordx4 v[104:107], v2, s[44:47], s52 offen offset:2560 sc0 sc1
    buffer_load_dwordx4 v[76:79], v2, s[44:47], s52 offen offset:2816 sc0 sc1
    buffer_load_dwordx4 v[80:83], v2, s[44:47], s52 offen offset:3072 sc0 sc1
    buffer_load_dwordx4 v[84:87], v2, s[44:47], s52 offen offset:3328 sc0 sc1
    buffer_load_dwordx4 v[88:91], v2, s[44:47], s52 offen offset:3584 sc0 sc1
    buffer_load_dwordx4 v[120:123], v2, s[44:47], s52 offen offset:3840 sc0 sc1
    s_waitcnt vmcnt(0)
    v_xor_b32 v3, s37, v50
    v_xor_b32 v4, s37, v54
    v_or_b32 v3, v3, v4
    v_xor_b32 v4, s37, v58
    v_or_b32 v3, v3, v4
    v_xor_b32 v4, s37, v62
    v_or_b32 v3, v3, v4
    v_xor_b32 v4, s37, v66
    v_or_b32 v3, v3, v4
    v_xor_b32 v4, s37, v70
    v_or_b32 v3, v3, v4
    v_xor_b32 v4, s37, v74
    v_or_b32 v3, v3, v4
    v_xor_b32 v4, s37, v94
    v_or_b32 v3, v3, v4
    v_xor_b32 v4, s37, v98
    v_or_b32 v3, v3, v4
    v_xor_b32 v4, s37, v102
    v_or_b32 v3, v3, v4
    v_xor_b32 v4, s37, v106
    v_or_b32 v3, v3, v4
    v_xor_b32 v4, s37, v78
    v_or_b32 v3, v3, v4
    v_xor_b32 v4, s37, v82
    v_or_b32 v3, v3, v4
    v_xor_b32 v4, s37, v86
    v_or_b32 v3, v3, v4
    v_xor_b32 v4, s37, v90
    v_or_b32 v3, v3, v4
    v_xor_b32 v4, s37, v122
    v_or_b32 v3, v3, v4
    v_cmp_ne_u32 vcc, 0, v3
    s_add_u32 s36, s36, 1
    s_cbranch_vccz p4_gok
    s_cmp_lt_u32 s36, 40000
    s_cbranch_scc1 p4_gpoll
p4_gok:
    v_add_f32 v48, v48, v52
    v_add_f32 v49, v49, v53
    v_add_f32 v48, v48, v56
    v_add_f32 v49, v49, v57
    v_add_f32 v48, v48, v60
    v_add_f32 v49, v49, v61
    v_add_f32 v48, v48, v64
    v_add_f32 v49, v49, v65
    v_add_f32 v48, v48, v68
    v_add_f32 v49, v49, v69
    v_add_f32 v48, v48, v72
    v_add_f32 v49, v49, v73
    v_add_f32 v48, v48, v92
    v_add_f32 v49, v49, v93
    v_add_f32 v48, v48, v96
    v_add_f32 v49, v49, v97
    v_add_f32 v48, v48, v100
    v_add_f32 v49, v49, v101
    v_add_f32 v48, v48, v104
    v_add_f32 v49, v49, v105
    v_add_f32 v48, v48, v76
    v_add_f32 v49, v49, v77
    v_add_f32 v48, v48, v80
    v_add_f32 v49, v49, v81
    v_add_f32 v48, v48, v84
    v_add_f32 v49, v49, v85
    v_add_f32 v48, v48, v88
    v_add_f32 v49, v49, v89
    v_add_f32 v48, v48, v120
    v_add_f32 v49, v49, v121
    v_mul_f32 v48, 0x3a924925, v48
    v_mul_f32 v49, 0x3a924925, v49
    v_fma_f32 v49, -v48, v48, v49
    v_max_f32 v49, 0, v49
    v_add_f32 v49, 0x3727c5ac, v49
    v_rsq_f32 v49, v49
    v_lshlrev_b32 v2, 3, v1
    v_add_u32 v2, 162816, v2
    ds_write_b64 v2, v[48:49]
p4_gdone:
    s_waitcnt lgkmcnt(0)
    s_barrier
    s_memtime s[40:41]
    s_waitcnt lgkmcnt(0)
    v_writelane_b32 v0, s40, 16
    v_and_b32 v2, 15, v1
    v_lshlrev_b32 v2, 3, v2
    s_lshl_b32 s32, s38, 7
    s_add_u32 s32, s32, 162816
    v_add_u32 v2, s32, v2
    ds_read_b64 v[76:77], v2
    v_and_b32 v2, 15, v1
    v_lshlrev_b32 v2, 5, v2
    v_lshrrev_b32 v3, 4, v1
    v_lshl_add_u32 v2, v3, 3, v2
    s_lshl_b32 s32, s38, 9
    s_lshl_b32 s33, s39, 13
    s_add_u32 s32, s32, s33
    s_add_u32 s32, s32, 148480
    v_add_u32 v2, s32, v2
    s_waitcnt lgkmcnt(0)
    v_lshlrev_b32 v78, 16, v112
    v_and_b32 v79, 0xffff0000, v112
    v_sub_f32 v78, v78, v76
    v_sub_f32 v79, v79, v76
    v_mul_f32 v78, v77, v78
    v_mul_f32 v79, v77, v79
    v_cvt_pk_bf16_f32 v112, v78, v79
    v_lshlrev_b32 v78, 16, v113
    v_and_b32 v79, 0xffff0000, v113
    v_sub_f32 v78, v78, v76
    v_sub_f32 v79, v79, v76
    v_mul_f32 v78, v77, v78
    v_mul_f32 v79, v77, v79
    v_cvt_pk_bf16_f32 v113, v78, v79
    v_lshlrev_b32 v78, 16, v114
    v_and_b32 v79, 0xffff0000, v114
    v_sub_f32 v78, v78, v76
    v_sub_f32 v79, v79, v76
    v_mul_f32 v78, v77, v78
    v_mul_f32 v79, v77, v79
    v_cvt_pk_bf16_f32 v114, v78, v79
    v_lshlrev_b32 v78, 16, v115
    v_and_b32 v79, 0xffff0000, v115
    v_sub_f32 v78, v78, v76
    v_sub_f32 v79, v79, v76
    v_mul_f32 v78, v77, v78
    v_mul_f32 v79, v77, v79
    v_cvt_pk_bf16_f32 v115, v78, v79
    v_lshlrev_b32 v78, 16, v116
    v_and_b32 v79, 0xffff0000, v116
    v_sub_f32 v78, v78, v76
    v_sub_f32 v79, v79, v76
    v_mul_f32 v78, v77, v78
    v_mul_f32 v79, v77, v79
    v_cvt_pk_bf16_f32 v116, v78, v79
    v_lshlrev_b32 v78, 16, v117
    v_and_b32 v79, 0xffff0000, v117
    v_sub_f32 v78, v78, v76
    v_sub_f32 v79, v79, v76
    v_mul_f32 v78, v77, v78
    v_mul_f32 v79, v77, v79
    v_cvt_pk_bf16_f32 v117, v78, v79
    v_lshlrev_b32 v78, 16, v118
    v_and_b32 v79, 0xffff0000, v118
    v_sub_f32 v78, v78, v76
    v_sub_f32 v79, v79, v76
    v_mul_f32 v78, v77, v78
    v_mul_f32 v79, v77, v79
    v_cvt_pk_bf16_f32 v118, v78, v79
    v_lshlrev_b32 v78, 16, v119
    v_and_b32 v79, 0xffff0000, v119
    v_sub_f32 v78, v78, v76
    v_sub_f32 v79, v79, v76
    v_mul_f32 v78, v77, v78
    v_mul_f32 v79, v77, v79
    v_cvt_pk_bf16_f32 v119, v78, v79
    ds_write_b64 v2, v[112:113] offset:0
    ds_write_b64 v2, v[114:115] offset:2048
    ds_write_b64 v2, v[116:117] offset:4096
    s_cmp_eq_u32 s39, 0
    s_cbranch_scc0 p4_no4
    ds_write_b64 v2, v[118:119] offset:6144
p4_no4:
    s_waitcnt lgkmcnt(0)
    s_barrier
    v_lshrrev_b32 v2, 4, v1
    v_lshlrev_b32 v2, 3, v2
    v_lshrrev_b32 v3, 2, v1
    v_and_b32 v3, 3, v3
    v_add_u32 v2, v2, v3
    v_lshlrev_b32 v2, 5, v2
    v_and_b32 v3, 3, v1
    v_lshl_add_u32 v2, v3, 3, v2
    v_add_u32 v2, 148480, v2
    s_lshl_b32 s52, s31, 6
    s_lshl_b32 s33, s30, 1
    s_add_u32 s52, s52, s33
    s_mul_i32 s52, s52, 7
    s_add_u32 s34, s3, 0
    s_cmp_ge_u32 s34, 7
    s_cselect_b32 s32, 1, 0
    s_mul_i32 s33, s32, 7
    s_sub_u32 s33, s34, s33
    s_lshl_b32 s33, s33, 11
    s_lshl_b32 s32, s32, 10
    s_add_u32 s32, s32, s33
    v_add_u32 v3, s32, v2
    ds_read_b64_tr_b16 v[92:93], v3
    ds_read_b64_tr_b16 v[94:95], v3 offset:128
    s_add_u32 s34, s34, s52
    s_lshl_b32 s34, s34, 10
    s_add_u32 s34, s34, 12582912
    s_waitcnt lgkmcnt(0)
    buffer_store_dwordx4 v[92:95], v5, s[44:47], s34 offen sc0 sc1
    s_cmp_ge_u32 s3, 6
    s_cbranch_scc1 p4_trdone
    s_add_u32 s34, s3, 8
    s_cmp_ge_u32 s34, 7
    s_cselect_b32 s32, 1, 0
    s_mul_i32 s33, s32, 7
    s_sub_u32 s33, s34, s33
    s_lshl_b32 s33, s33, 11
    s_lshl_b32 s32, s32, 10
    s_add_u32 s32, s32, s33
    v_add_u32 v3, s32, v2
    ds_read_b64_tr_b16 v[96:97], v3
    ds_read_b64_tr_b16 v[98:99], v3 offset:128
    s_add_u32 s34, s34, s52
    s_lshl_b32 s34, s34, 10
    s_add_u32 s34, s34, 12582912
    s_waitcnt lgkmcnt(0)
    buffer_store_dwordx4 v[96:99], v5, s[44:47], s34 offen sc0 sc1
p4_trdone:
    s_waitcnt vmcnt(0)
    s_barrier
    s_cmp_eq_u32 s3, 0
    s_cbranch_scc0 p4_nf2
    s_lshl_b32 s32, s31, 5
    s_add_u32 s32, s32, s30
    s_lshl_b32 s32, s32, 2
    s_add_u32 s32, s32, 159744
    v_mov_b32 v3, s37
    s_mov_b64 exec, 1
    buffer_store_dword v3, v6, s[44:47], s32 offen sc0 sc1
    s_mov_b64 exec, -1
p4_nf2:
    s_memtime s[40:41]
    s_waitcnt lgkmcnt(0)
    v_writelane_b32 v0, s40, 17
    ds_read_b128 v[76:79], v12 offset:16384
    ds_read_b128 v[80:83], v12 offset:49152
    ds_read_b128 v[84:87], v13 offset:16384
    ds_read_b128 v[88:91], v13 offset:49152
    s_waitcnt lgkmcnt(3)
    v_mfma_f32_16x16x32_bf16 v[48:51], v[76:79], v[16:19], 0
    ds_read_b128 v[76:79], v12 offset:0
    s_waitcnt lgkmcnt(3)
    v_mfma_f32_16x16x32_bf16 v[52:55], v[80:83], v[16:19], 0
    ds_read_b128 v[80:83], v12 offset:32768
    s_waitcnt lgkmcnt(3)
    v_mfma_f32_16x16x32_bf16 v[56:59], v[84:87], v[16:19], 0
    ds_read_b128 v[84:87], v13 offset:0
    s_waitcnt lgkmcnt(3)
    v_mfma_f32_16x16x32_bf16 v[60:63], v[88:91], v[16:19], 0
    ds_read_b128 v[88:91], v12 offset:17408
    s_waitcnt lgkmcnt(3)
    v_mfma_f32_16x16x32_bf16 v[64:67], v[76:79], v[16:19], 0
    ds_read_b128 v[76:79], v12 offset:50176
    s_waitcnt lgkmcnt(3)
    v_mfma_f32_16x16x32_bf16 v[68:71], v[80:83], v[16:19], 0
    ds_read_b128 v[80:83], v13 offset:17408
    s_waitcnt lgkmcnt(3)
    v_mfma_f32_16x16x32_bf16 v[72:75], v[84:87], v[16:19], 0
    ds_read_b128 v[84:87], v13 offset:50176
    s_waitcnt lgkmcnt(3)
    v_mfma_f32_16x16x32_bf16 v[48:51], v[88:91], v[20:23], v[48:51]
    ds_read_b128 v[88:91], v12 offset:1024
    s_waitcnt lgkmcnt(3)
    v_mfma_f32_16x16x32_bf16 v[52:55], v[76:79], v[20:23], v[52:55]
    ds_read_b128 v[76:79], v12 offset:33792
    s_waitcnt lgkmcnt(3)
    v_mfma_f32_16x16x32_bf16 v[56:59], v[80:83], v[20:23], v[56:59]
    ds_read_b128 v[80:83], v13 offset:1024
    s_waitcnt lgkmcnt(3)
    v_mfma_f32_16x16x32_bf16 v[60:63], v[84:87], v[20:23], v[60:63]
    ds_read_b128 v[84:87], v12 offset:18432
    s_waitcnt lgkmcnt(3)
    v_mfma_f32_16x16x32_bf16 v[64:67], v[88:91], v[20:23], v[64:67]
    ds_read_b128 v[88:91], v12 offset:51200
    s_waitcnt lgkmcnt(3)
    v_mfma_f32_16x16x32_bf16 v[68:71], v[76:79], v[20:23], v[68:71]
    ds_read_b128 v[76:79], v13 offset:18432
    s_waitcnt lgkmcnt(3)
    v_mfma_f32_16x16x32_bf16 v[72:75], v[80:83], v[20:23], v[72:75]
    ds_read_b128 v[80:83], v13 offset:51200
    s_waitcnt lgkmcnt(3)
    v_mfma_f32_16x16x32_bf16 v[48:51], v[84:87], v[24:27], v[48:51]
    ds_read_b128 v[84:87], v12 offset:2048
    s_waitcnt lgkmcnt(3)
    v_mfma_f32_16x16x32_bf16 v[52:55], v[88:91], v[24:27], v[52:55]
    ds_read_b128 v[88:91], v12 offset:34816
    s_waitcnt lgkmcnt(3)
    v_mfma_f32_16x16x32_bf16 v[56:59], v[76:79], v[24:27], v[56:59]
    ds_read_b128 v[76:79], v13 offset:2048
    s_waitcnt lgkmcnt(3)
    v_mfma_f32_16x16x32_bf16 v[60:63], v[80:83], v[24:27], v[60:63]
    ds_read_b128 v[80:83], v12 offset:19456
    s_waitcnt lgkmcnt(3)
    v_mfma_f32_16x16x32_bf16 v[64:67], v[84:87], v[24:27], v[64:67]
    ds_read_b128 v[84:87], v12 offset:52224
    s_waitcnt lgkmcnt(3)
    v_mfma_f32_16x16x32_bf16 v[68:71], v[88:91], v[24:27], v[68:71]
    ds_read_b128 v[88:91], v13 offset:19456
    s_waitcnt lgkmcnt(3)
    v_mfma_f32_16x16x32_bf16 v[72:75], v[76:79], v[24:27], v[72:75]
    ds_read_b128 v[76:79], v13 offset:52224
    s_waitcnt lgkmcnt(3)
    v_mfma_f32_16x16x32_bf16 v[48:51], v[80:83], v[28:31], v[48:51]
    ds_read_b128 v[80:83], v12 offset:3072
    s_waitcnt lgkmcnt(3)
    v_mfma_f32_16x16x32_bf16 v[52:55], v[84:87], v[28:31], v[52:55]
    ds_read_b128 v[84:87], v12 offset:35840
    s_waitcnt lgkmcnt(3)
    v_mfma_f32_16x16x32_bf16 v[56:59], v[88:91], v[28:31], v[56:59]
    ds_read_b128 v[88:91], v13 offset:3072
    s_waitcnt lgkmcnt(3)
    v_mfma_f32_16x16x32_bf16 v[60:63], v[76:79], v[28:31], v[60:63]
    ds_read_b128 v[76:79], v12 offset:20480
    s_waitcnt lgkmcnt(3)
    v_mfma_f32_16x16x32_bf16 v[64:67], v[80:83], v[28:31], v[64:67]
    ds_read_b128 v[80:83], v12 offset:53248
    s_waitcnt lgkmcnt(3)
    v_mfma_f32_16x16x32_bf16 v[68:71], v[84:87], v[28:31], v[68:71]
    ds_read_b128 v[84:87], v13 offset:20480
    s_waitcnt lgkmcnt(3)
    v_mfma_f32_16x16x32_bf16 v[72:75], v[88:91], v[28:31], v[72:75]
    ds_read_b128 v[88:91], v13 offset:53248
    s_waitcnt lgkmcnt(3)
    v_mfma_f32_16x16x32_bf16 v[48:51], v[76:79], v[32:35], v[48:51]
    ds_read_b128 v[76:79], v12 offset:4096
    s_waitcnt lgkmcnt(3)
    v_mfma_f32_16x16x32_bf16 v[52:55], v[80:83], v[32:35], v[52:55]
    ds_read_b128 v[80:83], v12 offset:36864
    s_waitcnt lgkmcnt(3)
    v_mfma_f32_16x16x32_bf16 v[56:59], v[84:87], v[32:35], v[56:59]
    ds_read_b128 v[84:87], v13 offset:4096
    s_waitcnt lgkmcnt(3)
    v_mfma_f32_16x16x32_bf16 v[60:63], v[88:91], v[32:35], v[60:63]
    ds_read_b128 v[88:91], v12 offset:21504
    s_waitcnt lgkmcnt(3)
    v_mfma_f32_16x16x32_bf16 v[64:67], v[76:79], v[32:35], v[64:67]
    ds_read_b128 v[76:79], v12 offset:54272
    s_waitcnt lgkmcnt(3)
    v_mfma_f32_16x16x32_bf16 v[68:71], v[80:83], v[32:35], v[68:71]
    ds_read_b128 v[80:83], v13 offset:21504
    s_waitcnt lgkmcnt(3)
    v_mfma_f32_16x16x32_bf16 v[72:75], v[84:87], v[32:35], v[72:75]
    ds_read_b128 v[84:87], v13 offset:54272
    s_waitcnt lgkmcnt(3)
    v_mfma_f32_16x16x32_bf16 v[48:51], v[88:91], v[36:39], v[48:51]
    ds_read_b128 v[88:91], v12 offset:5120
    s_waitcnt lgkmcnt(3)
    v_mfma_f32_16x16x32_bf16 v[52:55], v[76:79], v[36:39], v[52:55]
    ds_read_b128 v[76:79], v12 offset:37888
    s_waitcnt lgkmcnt(3)
    v_mfma_f32_16x16x32_bf16 v[56:59], v[80:83], v[36:39], v[56:59]
    ds_read_b128 v[80:83], v13 offset:5120
    s_waitcnt lgkmcnt(3)
    v_mfma_f32_16x16x32_bf16 v[60:63], v[84:87], v[36:39], v[60:63]
    ds_read_b128 v[84:87], v12 offset:22528
    s_waitcnt lgkmcnt(3)
    v_mfma_f32_16x16x32_bf16 v[64:67], v[88:91], v[36:39], v[64:67]
    ds_read_b128 v[88:91], v12 offset:55296
    s_waitcnt lgkmcnt(3)
    v_mfma_f32_16x16x32_bf16 v[68:71], v[76:79], v[36:39], v[68:71]
    ds_read_b128 v[76:79], v13 offset:22528
    s_waitcnt lgkmcnt(3)
    v_mfma_f32_16x16x32_bf16 v[72:75], v[80:83], v[36:39], v[72:75]
    ds_read_b128 v[80:83], v13 offset:55296
    s_waitcnt lgkmcnt(3)
    v_mfma_f32_16x16x32_bf16 v[48:51], v[84:87], v[40:43], v[48:51]
    ds_read_b128 v[84:87], v12 offset:6144
    s_waitcnt lgkmcnt(3)
    v_mfma_f32_16x16x32_bf16 v[52:55], v[88:91], v[40:43], v[52:55]
    ds_read_b128 v[88:91], v12 offset:38912
    s_waitcnt lgkmcnt(3)
    v_mfma_f32_16x16x32_bf16 v[56:59], v[76:79], v[40:43], v[56:59]
    ds_read_b128 v[76:79], v13 offset:6144
    s_waitcnt lgkmcnt(3)
    v_mfma_f32_16x16x32_bf16 v[60:63], v[80:83], v[40:43], v[60:63]
    ds_read_b128 v[80:83], v12 offset:23552
    s_waitcnt lgkmcnt(3)
    v_mfma_f32_16x16x32_bf16 v[64:67], v[84:87], v[40:43], v[64:67]
    ds_read_b128 v[84:87], v12 offset:56320
    s_waitcnt lgkmcnt(3)
    v_mfma_f32_16x16x32_bf16 v[68:71], v[88:91], v[40:43], v[68:71]
    ds_read_b128 v[88:91], v13 offset:23552
    s_waitcnt lgkmcnt(3)
    v_mfma_f32_16x16x32_bf16 v[72:75], v[76:79], v[40:43], v[72:75]
    ds_read_b128 v[76:79], v13 offset:56320
    s_waitcnt lgkmcnt(3)
    v_mfma_f32_16x16x32_bf16 v[48:51], v[80:83], v[44:47], v[48:51]
    ds_read_b128 v[80:83], v12 offset:7168
    s_waitcnt lgkmcnt(3)
    v_mfma_f32_16x16x32_bf16 v[52:55], v[84:87], v[44:47], v[52:55]
    ds_read_b128 v[84:87], v12 offset:39936
    s_waitcnt lgkmcnt(3)
    v_mfma_f32_16x16x32_bf16 v[56:59], v[88:91], v[44:47], v[56:59]
    ds_read_b128 v[88:91], v13 offset:7168
    s_waitcnt lgkmcnt(3)
    v_mfma_f32_16x16x32_bf16 v[60:63], v[76:79], v[44:47], v[60:63]
    s_waitcnt lgkmcnt(2)
    v_mfma_f32_16x16x32_bf16 v[64:67], v[80:83], v[44:47], v[64:67]
    s_waitcnt lgkmcnt(1)
    v_mfma_f32_16x16x32_bf16 v[68:71], v[84:87], v[44:47], v[68:71]
    s_waitcnt lgkmcnt(0)
    v_mfma_f32_16x16x32_bf16 v[72:75], v[88:91], v[44:47], v[72:75]
    s_nop 7
    s_lshr_b32 s33, s3, 2
    s_lshl_b32 s33, s33, 15
    s_and_b32 s32, s3, 3
    s_lshl_b32 s32, s32, 12
    s_add_u32 s32, s32, s33
    s_add_u32 s32, s32, 98304
    v_add_u32 v2, s32, v5
    s_cmp_eq_u32 s39, 0
    s_cbranch_scc0 p4e1_kh1
    ds_write_b128 v2, v[64:67] offset:0
    ds_write_b128 v2, v[68:71] offset:1024
    ds_write_b128 v2, v[72:75] offset:2048
    v_mov_b32 v92, v48
    v_mov_b32 v93, v49
    v_mov_b32 v94, v50
    v_mov_b32 v95, v51
    v_mov_b32 v96, v52
    v_mov_b32 v97, v53
    v_mov_b32 v98, v54
    v_mov_b32 v99, v55
    v_mov_b32 v100, v56
    v_mov_b32 v101, v57
    v_mov_b32 v102, v58
    v_mov_b32 v103, v59
    v_mov_b32 v104, v60
    v_mov_b32 v105, v61
    v_mov_b32 v106, v62
    v_mov_b32 v107, v63
    s_branch p4e1_x
p4e1_kh1:
    ds_write_b128 v2, v[48:51] offset:0
    ds_write_b128 v2, v[52:55] offset:1024
    ds_write_b128 v2, v[56:59] offset:2048
    ds_write_b128 v2, v[60:63] offset:3072
    v_mov_b32 v92, v64
    v_mov_b32 v93, v65
    v_mov_b32 v94, v66
    v_mov_b32 v95, v67
    v_mov_b32 v96, v68
    v_mov_b32 v97, v69
    v_mov_b32 v98, v70
    v_mov_b32 v99, v71
    v_mov_b32 v100, v72
    v_mov_b32 v101, v73
    v_mov_b32 v102, v74
    v_mov_b32 v103, v75
    v_mov_b32 v104, 0
    v_mov_b32 v105, 0
    v_mov_b32 v106, 0
    v_mov_b32 v107, 0
p4e1_x:
    s_cmp_eq_u32 s3, 7
    s_cbranch_scc0 p4_nopoll5
    s_and_b32 s32, s2, 7
    s_lshl_b32 s32, s32, 7
    s_add_u32 s32, s32, 159744
    v_lshlrev_b32 v2, 2, v1
    s_mov_b32 exec_hi, 0
    s_mov_b32 s36, 0
p5_poll:
    buffer_load_dword v3, v2, s[44:47], s32 offen sc0 sc1
    s_waitcnt vmcnt(0)
    v_xor_b32 v3, s37, v3
    v_cmp_ne_u32 vcc, 0, v3
    s_add_u32 s36, s36, 1
    s_cbranch_vccz p5_poll_ok
    s_cmp_lt_u32 s36, 40000
    s_cbranch_scc1 p5_poll
p5_poll_ok:
    s_mov_b64 exec, -1
p4_nopoll5:
    s_waitcnt lgkmcnt(0)
    s_barrier
    s_memtime s[40:41]
    s_waitcnt lgkmcnt(0)
    v_writelane_b32 v0, s40, 18
    s_and_b32 s53, s2, 7
    s_lshr_b32 s54, s2, 3
    s_mul_i32 s55, s53, 458752
    s_mul_i32 s32, s3, 57344
    s_add_u32 s55, s55, s32
    s_add_u32 s55, s55, 12582912
    s_add_u32 s35, s63, 0
    s_and_b32 s35, s35, 7
    s_mul_i32 s35, s35, 7168
    s_add_u32 s60, s35, s55
    buffer_load_dwordx4 v[16:19], v5, s[44:47], s60 offen offset:0 sc0 sc1
    buffer_load_dwordx4 v[20:23], v5, s[44:47], s60 offen offset:1024 sc0 sc1
    buffer_load_dwordx4 v[24:27], v5, s[44:47], s60 offen offset:2048 sc0 sc1
    buffer_load_dwordx4 v[28:31], v5, s[44:47], s60 offen offset:3072 sc0 sc1
    s_add_u32 s35, s63, 1
    s_and_b32 s35, s35, 7
    s_mul_i32 s35, s35, 7168
    s_add_u32 s60, s35, s55
    buffer_load_dwordx4 v[32:35], v5, s[44:47], s60 offen offset:0 sc0 sc1
    buffer_load_dwordx4 v[36:39], v5, s[44:47], s60 offen offset:1024 sc0 sc1
    buffer_load_dwordx4 v[40:43], v5, s[44:47], s60 offen offset:2048 sc0 sc1
    buffer_load_dwordx4 v[44:47], v5, s[44:47], s60 offen offset:3072 sc0 sc1
    s_xor_b32 s34, s3, 4
    s_lshr_b32 s33, s34, 2
    s_lshl_b32 s33, s33, 15
    s_and_b32 s32, s34, 3
    s_lshl_b32 s32, s32, 12
    s_add_u32 s32, s32, s33
    s_add_u32 s32, s32, 98304
    v_add_u32 v2, s32, v5
    ds_read_b128 v[48:51], v2 offset:0
    ds_read_b128 v[52:55], v2 offset:1024
    ds_read_b128 v[56:59], v2 offset:2048
    ds_read_b128 v[60:63], v2 offset:3072
    s_lshl_b32 s32, s39, 8
    s_add_u32 s32, s32, 101888
    v_lshrrev_b32 v2, 4, v1
    v_lshlrev_b32 v2, 4, v2
    v_add_u32 v2, s32, v2
    ds_read_b128 v[76:79], v2 offset:0
    ds_read_b128 v[80:83], v2 offset:64
    ds_read_b128 v[84:87], v2 offset:128
    ds_read_b128 v[88:91], v2 offset:192
    s_waitcnt lgkmcnt(0)
    v_add_f32 v92, v92, v48
    v_fma_f32 v92, -v14, v76, v92
    v_mul_f32 v92, v15, v92
    v_add_f32 v93, v93, v49
    v_fma_f32 v93, -v14, v77, v93
    v_mul_f32 v93, v15, v93
    v_add_f32 v94, v94, v50
    v_fma_f32 v94, -v14, v78, v94
    v_mul_f32 v94, v15, v94
    v_add_f32 v95, v95, v51
    v_fma_f32 v95, -v14, v79, v95
    v_mul_f32 v95, v15, v95
    v_add_f32 v96, v96, v52
    v_fma_f32 v96, -v14, v80, v96
    v_mul_f32 v96, v15, v96
    v_add_f32 v97, v97, v53
    v_fma_f32 v97, -v14, v81, v97
    v_mul_f32 v97, v15, v97
    v_add_f32 v98, v98, v54
    v_fma_f32 v98, -v14, v82, v98
    v_mul_f32 v98, v15, v98
    v_add_f32 v99, v99, v55
    v_fma_f32 v99, -v14, v83, v99
    v_mul_f32 v99, v15, v99
    v_add_f32 v100, v100, v56
    v_fma_f32 v100, -v14, v84, v100
    v_mul_f32 v100, v15, v100
    v_add_f32 v101, v101, v57
    v_fma_f32 v101, -v14, v85, v101
    v_mul_f32 v101, v15, v101
    v_add_f32 v102, v102, v58
    v_fma_f32 v102, -v14, v86, v102
    v_mul_f32 v102, v15, v102
    v_add_f32 v103, v103, v59
    v_fma_f32 v103, -v14, v87, v103
    v_mul_f32 v103, v15, v103
    v_add_f32 v104, v104, v60
    v_fma_f32 v104, -v14, v88, v104
    v_mul_f32 v104, v15, v104
    v_add_f32 v105, v105, v61
    v_fma_f32 v105, -v14, v89, v105
    v_mul_f32 v105, v15, v105
    v_add_f32 v106, v106, v62
    v_fma_f32 v106, -v14, v90, v106
    v_mul_f32 v106, v15, v106
    v_add_f32 v107, v107, v63
    v_fma_f32 v107, -v14, v91, v107
    v_mul_f32 v107, v15, v107
    v_mul_f32 v48, v92, v92
    v_mul_f32 v49, v93, v93
    v_mul_f32 v50, v94, v94
    v_mul_f32 v51, v95, v95
    v_mul_f32 v52, v96, v96
    v_mul_f32 v53, v97, v97
    v_mul_f32 v54, v98, v98
    v_mul_f32 v55, v99, v99
    v_mul_f32 v56, v100, v100
    v_mul_f32 v57, v101, v101
    v_mul_f32 v58, v102, v102
    v_mul_f32 v59, v103, v103
    v_mul_f32 v60, v104, v104
    v_mul_f32 v61, v105, v105
    v_mul_f32 v62, v106, v106
    v_mul_f32 v63, v107, v107
    v_fmamk_f32 v48, v48, 0xbdd2d3e8, v108
    v_fmamk_f32 v49, v49, 0xbdd2d3e8, v108
    v_fmamk_f32 v50, v50, 0xbdd2d3e8, v108
    v_fmamk_f32 v51, v51, 0xbdd2d3e8, v108
    v_fmamk_f32 v52, v52, 0xbdd2d3e8, v108
    v_fmamk_f32 v53, v53, 0xbdd2d3e8, v108
    v_fmamk_f32 v54, v54, 0xbdd2d3e8, v108
    v_fmamk_f32 v55, v55, 0xbdd2d3e8, v108
    v_fmamk_f32 v56, v56, 0xbdd2d3e8, v108
    v_fmamk_f32 v57, v57, 0xbdd2d3e8, v108
    v_fmamk_f32 v58, v58, 0xbdd2d3e8, v108
    v_fmamk_f32 v59, v59, 0xbdd2d3e8, v108
    v_fmamk_f32 v60, v60, 0xbdd2d3e8, v108
    v_fmamk_f32 v61, v61, 0xbdd2d3e8, v108
    v_fmamk_f32 v62, v62, 0xbdd2d3e8, v108
    v_fmamk_f32 v63, v63, 0xbdd2d3e8, v108
    v_mul_f32 v48, v48, v92
    v_mul_f32 v49, v49, v93
    v_mul_f32 v50, v50, v94
    v_mul_f32 v51, v51, v95
    v_mul_f32 v52, v52, v96
    v_mul_f32 v53, v53, v97
    v_mul_f32 v54, v54, v98
    v_mul_f32 v55, v55, v99
    v_mul_f32 v56, v56, v100
    v_mul_f32 v57, v57, v101
    v_mul_f32 v58, v58, v102
    v_mul_f32 v59, v59, v103
    v_mul_f32 v60, v60, v104
    v_mul_f32 v61, v61, v105
    v_mul_f32 v62, v62, v106
    v_mul_f32 v63, v63, v107
    v_exp_f32 v48, v48
    v_exp_f32 v49, v49
    v_exp_f32 v50, v50
    v_exp_f32 v51, v51
    v_exp_f32 v52, v52
    v_exp_f32 v53, v53
    v_exp_f32 v54, v54
    v_exp_f32 v55, v55
    v_exp_f32 v56, v56
    v_exp_f32 v57, v57
    v_exp_f32 v58, v58
    v_exp_f32 v59, v59
    v_exp_f32 v60, v60
    v_exp_f32 v61, v61
    v_exp_f32 v62, v62
    v_exp_f32 v63, v63
    v_add_f32 v48, 1.0, v48
    v_add_f32 v49, 1.0, v49
    v_add_f32 v50, 1.0, v50
    v_add_f32 v51, 1.0, v51
    v_add_f32 v52, 1.0, v52
    v_add_f32 v53, 1.0, v53
    v_add_f32 v54, 1.0, v54
    v_add_f32 v55, 1.0, v55
    v_add_f32 v56, 1.0, v56
    v_add_f32 v57, 1.0, v57
    v_add_f32 v58, 1.0, v58
    v_add_f32 v59, 1.0, v59
    v_add_f32 v60, 1.0, v60
    v_add_f32 v61, 1.0, v61
    v_add_f32 v62, 1.0, v62
    v_add_f32 v63, 1.0, v63
    v_rcp_f32 v48, v48
    v_rcp_f32 v49, v49
    v_rcp_f32 v50, v50
    v_rcp_f32 v51, v51
    v_rcp_f32 v52, v52
    v_rcp_f32 v53, v53
    v_rcp_f32 v54, v54
    v_rcp_f32 v55, v55
    v_rcp_f32 v56, v56
    v_rcp_f32 v57, v57
    v_rcp_f32 v58, v58
    v_rcp_f32 v59, v59
    v_rcp_f32 v60, v60
    v_rcp_f32 v61, v61
    v_rcp_f32 v62, v62
    v_rcp_f32 v63, v63
    s_nop 0
    v_mul_f32 v92, v92, v48
    v_mul_f32 v93, v93, v49
    v_mul_f32 v94, v94, v50
    v_mul_f32 v95, v95, v51
    v_mul_f32 v96, v96, v52
    v_mul_f32 v97, v97, v53
    v_mul_f32 v98, v98, v54
    v_mul_f32 v99, v99, v55
    v_mul_f32 v100, v100, v56
    v_mul_f32 v101, v101, v57
    v_mul_f32 v102, v102, v58
    v_mul_f32 v103, v103, v59
    v_mul_f32 v104, v104, v60
    v_mul_f32 v105, v105, v61
    v_mul_f32 v106, v106, v62
    v_mul_f32 v107, v107, v63
    v_cvt_pk_bf16_f32 v112, v92, v93
    v_cvt_pk_bf16_f32 v113, v94, v95
    v_cvt_pk_bf16_f32 v114, v96, v97
    v_cvt_pk_bf16_f32 v115, v98, v99
    v_cvt_pk_bf16_f32 v116, v100, v101
    v_cvt_pk_bf16_f32 v117, v102, v103
    v_cvt_pk_bf16_f32 v118, v104, v105
    v_cvt_pk_bf16_f32 v119, v106, v107
    v_lshlrev_b32 v2, 3, v1
    s_lshr_b32 s32, s43, 4
    s_mul_i32 s32, s32, 56
    s_mul_i32 s33, s31, 7
    s_add_u32 s32, s32, s33
    s_lshl_b32 s33, s39, 2
    s_add_u32 s32, s32, s33
    s_lshl_b32 s32, s32, 9
    s_add_u32 s32, s32, 8388608
    buffer_store_dwordx2 v[112:113], v2, s[44:47], s32 offen offset:0 sc0 sc1
    buffer_store_dwordx2 v[114:115], v2, s[44:47], s32 offen offset:512 sc0 sc1
    buffer_store_dwordx2 v[116:117], v2, s[44:47], s32 offen offset:1024 sc0 sc1
    s_cmp_eq_u32 s39, 0
    s_cbranch_scc0 p4_no4b
    buffer_store_dwordx2 v[118:119], v2, s[44:47], s32 offen offset:1536 sc0 sc1
p4_no4b:
    s_memtime s[40:41]
    s_waitcnt lgkmcnt(0)
    v_writelane_b32 v0, s40, 19
    s_add_u32 s35, s63, 2
    s_and_b32 s35, s35, 7
    s_mul_i32 s35, s35, 7168
    s_add_u32 s60, s35, s55
    buffer_load_dwordx4 v[48:51], v5, s[44:47], s60 offen offset:0 sc0 sc1
    buffer_load_dwordx4 v[52:55], v5, s[44:47], s60 offen offset:1024 sc0 sc1
    buffer_load_dwordx4 v[56:59], v5, s[44:47], s60 offen offset:2048 sc0 sc1
    buffer_load_dwordx4 v[60:63], v5, s[44:47], s60 offen offset:3072 sc0 sc1
    s_waitcnt vmcnt(11)
    v_mfma_f32_16x16x32_bf16 v[64:67], v[16:19], v[128:131], 0
    v_mfma_f32_16x16x32_bf16 v[80:83], v[16:19], v[160:163], 0
    v_mfma_f32_16x16x32_bf16 v[96:99], v[16:19], v[192:195], 0
    v_mfma_f32_16x16x32_bf16 v[112:115], v[16:19], v[224:227], 0
    s_add_u32 s35, s63, 3
    s_and_b32 s35, s35, 7
    s_mul_i32 s35, s35, 7168
    s_add_u32 s60, s35, s55
    buffer_load_dwordx4 v[16:19], v5, s[44:47], s60 offen offset:0 sc0 sc1
    s_waitcnt vmcnt(11)
    v_mfma_f32_16x16x32_bf16 v[68:71], v[20:23], v[128:131], 0
    v_mfma_f32_16x16x32_bf16 v[84:87], v[20:23], v[160:163], 0
    v_mfma_f32_16x16x32_bf16 v[100:103], v[20:23], v[192:195], 0
    v_mfma_f32_16x16x32_bf16 v[116:119], v[20:23], v[224:227], 0
    buffer_load_dwordx4 v[20:23], v5, s[44:47], s60 offen offset:1024 sc0 sc1
    s_waitcnt vmcnt(11)
    v_mfma_f32_16x16x32_bf16 v[72:75], v[24:27], v[128:131], 0
    v_mfma_f32_16x16x32_bf16 v[88:91], v[24:27], v[160:163], 0
    v_mfma_f32_16x16x32_bf16 v[104:107], v[24:27], v[192:195], 0
    v_mfma_f32_16x16x32_bf16 v[120:123], v[24:27], v[224:227], 0
    buffer_load_dwordx4 v[24:27], v5, s[44:47], s60 offen offset:2048 sc0 sc1
    s_waitcnt vmcnt(11)
    v_mfma_f32_16x16x32_bf16 v[76:79], v[28:31], v[128:131], 0
    v_mfma_f32_16x16x32_bf16 v[92:95], v[28:31], v[160:163], 0
    v_mfma_f32_16x16x32_bf16 v[108:111], v[28:31], v[192:195], 0
    v_mfma_f32_16x16x32_bf16 v[124:127], v[28:31], v[224:227], 0
    buffer_load_dwordx4 v[28:31], v5, s[44:47], s60 offen offset:3072 sc0 sc1
    s_waitcnt vmcnt(11)
    v_mfma_f32_16x16x32_bf16 v[64:67], v[32:35], v[132:135], v[64:67]
    v_mfma_f32_16x16x32_bf16 v[80:83], v[32:35], v[164:167], v[80:83]
    v_mfma_f32_16x16x32_bf16 v[96:99], v[32:35], v[196:199], v[96:99]
    v_mfma_f32_16x16x32_bf16 v[112:115], v[32:35], v[228:231], v[112:115]
    s_add_u32 s35, s63, 4
    s_and_b32 s35, s35, 7
    s_mul_i32 s35, s35, 7168
    s_add_u32 s60, s35, s55
    buffer_load_dwordx4 v[32:35], v5, s[44:47], s60 offen offset:0 sc0 sc1
    s_waitcnt vmcnt(11)
    v_mfma_f32_16x16x32_bf16 v[68:71], v[36:39], v[132:135], v[68:71]
    v_mfma_f32_16x16x32_bf16 v[84:87], v[36:39], v[164:167], v[84:87]
    v_mfma_f32_16x16x32_bf16 v[100:103], v[36:39], v[196:199], v[100:103]
    v_mfma_f32_16x16x32_bf16 v[116:119], v[36:39], v[228:231], v[116:119]
    buffer_load_dwordx4 v[36:39], v5, s[44:47], s60 offen offset:1024 sc0 sc1
    s_waitcnt vmcnt(11)
    v_mfma_f32_16x16x32_bf16 v[72:75], v[40:43], v[132:135], v[72:75]
    v_mfma_f32_16x16x32_bf16 v[88:91], v[40:43], v[164:167], v[88:91]
    v_mfma_f32_16x16x32_bf16 v[104:107], v[40:43], v[196:199], v[104:107]
    v_mfma_f32_16x16x32_bf16 v[120:123], v[40:43], v[228:231], v[120:123]
    buffer_load_dwordx4 v[40:43], v5, s[44:47], s60 offen offset:2048 sc0 sc1
    s_waitcnt vmcnt(11)
    v_mfma_f32_16x16x32_bf16 v[76:79], v[44:47], v[132:135], v[76:79]
    v_mfma_f32_16x16x32_bf16 v[92:95], v[44:47], v[164:167], v[92:95]
    v_mfma_f32_16x16x32_bf16 v[108:111], v[44:47], v[196:199], v[108:111]
    v_mfma_f32_16x16x32_bf16 v[124:127], v[44:47], v[228:231], v[124:127]
    buffer_load_dwordx4 v[44:47], v5, s[44:47], s60 offen offset:3072 sc0 sc1
    s_waitcnt vmcnt(11)
    v_mfma_f32_16x16x32_bf16 v[64:67], v[48:51], v[136:139], v[64:67]
    v_mfma_f32_16x16x32_bf16 v[80:83], v[48:51], v[168:171], v[80:83]
    v_mfma_f32_16x16x32_bf16 v[96:99], v[48:51], v[200:203], v[96:99]
    v_mfma_f32_16x16x32_bf16 v[112:115], v[48:51], v[232:235], v[112:115]
    s_add_u32 s35, s63, 5
    s_and_b32 s35, s35, 7
    s_mul_i32 s35, s35, 7168
    s_add_u32 s60, s35, s55
    buffer_load_dwordx4 v[48:51], v5, s[44:47], s60 offen offset:0 sc0 sc1
    s_waitcnt vmcnt(11)
    v_mfma_f32_16x16x32_bf16 v[68:71], v[52:55], v[136:139], v[68:71]
    v_mfma_f32_16x16x32_bf16 v[84:87], v[52:55], v[168:171], v[84:87]
    v_mfma_f32_16x16x32_bf16 v[100:103], v[52:55], v[200:203], v[100:103]
    v_mfma_f32_16x16x32_bf16 v[116:119], v[52:55], v[232:235], v[116:119]
    buffer_load_dwordx4 v[52:55], v5, s[44:47], s60 offen offset:1024 sc0 sc1
    s_waitcnt vmcnt(11)
    v_mfma_f32_16x16x32_bf16 v[72:75], v[56:59], v[136:139], v[72:75]
    v_mfma_f32_16x16x32_bf16 v[88:91], v[56:59], v[168:171], v[88:91]
    v_mfma_f32_16x16x32_bf16 v[104:107], v[56:59], v[200:203], v[104:107]
    v_mfma_f32_16x16x32_bf16 v[120:123], v[56:59], v[232:235], v[120:123]
    buffer_load_dwordx4 v[56:59], v5, s[44:47], s60 offen offset:2048 sc0 sc1
    s_waitcnt vmcnt(11)
    v_mfma_f32_16x16x32_bf16 v[76:79], v[60:63], v[136:139], v[76:79]
    v_mfma_f32_16x16x32_bf16 v[92:95], v[60:63], v[168:171], v[92:95]
    v_mfma_f32_16x16x32_bf16 v[108:111], v[60:63], v[200:203], v[108:111]
    v_mfma_f32_16x16x32_bf16 v[124:127], v[60:63], v[232:235], v[124:127]
    buffer_load_dwordx4 v[60:63], v5, s[44:47], s60 offen offset:3072 sc0 sc1
    s_waitcnt vmcnt(11)
    v_mfma_f32_16x16x32_bf16 v[64:67], v[16:19], v[140:143], v[64:67]
    v_mfma_f32_16x16x32_bf16 v[80:83], v[16:19], v[172:175], v[80:83]
    v_mfma_f32_16x16x32_bf16 v[96:99], v[16:19], v[204:207], v[96:99]
    v_mfma_f32_16x16x32_bf16 v[112:115], v[16:19], v[236:239], v[112:115]
    s_add_u32 s35, s63, 6
    s_and_b32 s35, s35, 7
    s_mul_i32 s35, s35, 7168
    s_add_u32 s60, s35, s55
    buffer_load_dwordx4 v[16:19], v5, s[44:47], s60 offen offset:0 sc0 sc1
    s_barrier
    s_cmp_eq_u32 s3, 4
    s_cbranch_scc0 p5_nf1
    s_lshl_b32 s32, s30, 3
    s_add_u32 s32, s32, s31
    s_lshl_b32 s32, s32, 2
    s_add_u32 s32, s32, 160768
    v_mov_b32 v3, s37
    s_mov_b64 exec, 1
    buffer_store_dword v3, v6, s[44:47], s32 offen sc0 sc1
    s_mov_b64 exec, -1
p5_nf1:
    s_waitcnt vmcnt(11)
    v_mfma_f32_16x16x32_bf16 v[68:71], v[20:23], v[140:143], v[68:71]
    v_mfma_f32_16x16x32_bf16 v[84:87], v[20:23], v[172:175], v[84:87]
    v_mfma_f32_16x16x32_bf16 v[100:103], v[20:23], v[204:207], v[100:103]
    v_mfma_f32_16x16x32_bf16 v[116:119], v[20:23], v[236:239], v[116:119]
    buffer_load_dwordx4 v[20:23], v5, s[44:47], s60 offen offset:1024 sc0 sc1
    s_waitcnt vmcnt(11)
    v_mfma_f32_16x16x32_bf16 v[72:75], v[24:27], v[140:143], v[72:75]
    v_mfma_f32_16x16x32_bf16 v[88:91], v[24:27], v[172:175], v[88:91]
    v_mfma_f32_16x16x32_bf16 v[104:107], v[24:27], v[204:207], v[104:107]
    v_mfma_f32_16x16x32_bf16 v[120:123], v[24:27], v[236:239], v[120:123]
    buffer_load_dwordx4 v[24:27], v5, s[44:47], s60 offen offset:2048 sc0 sc1
    s_waitcnt vmcnt(11)
    v_mfma_f32_16x16x32_bf16 v[76:79], v[28:31], v[140:143], v[76:79]
    v_mfma_f32_16x16x32_bf16 v[92:95], v[28:31], v[172:175], v[92:95]
    v_mfma_f32_16x16x32_bf16 v[108:111], v[28:31], v[204:207], v[108:111]
    v_mfma_f32_16x16x32_bf16 v[124:127], v[28:31], v[236:239], v[124:127]
    buffer_load_dwordx4 v[28:31], v5, s[44:47], s60 offen offset:3072 sc0 sc1
    s_waitcnt vmcnt(11)
    v_mfma_f32_16x16x32_bf16 v[64:67], v[32:35], v[144:147], v[64:67]
    v_mfma_f32_16x16x32_bf16 v[80:83], v[32:35], v[176:179], v[80:83]
    v_mfma_f32_16x16x32_bf16 v[96:99], v[32:35], v[208:211], v[96:99]
    v_mfma_f32_16x16x32_bf16 v[112:115], v[32:35], v[240:243], v[112:115]
    s_add_u32 s35, s63, 7
    s_and_b32 s35, s35, 7
    s_mul_i32 s35, s35, 7168
    s_add_u32 s60, s35, s55
    buffer_load_dwordx4 v[32:35], v5, s[44:47], s60 offen offset:0 sc0 sc1
    s_waitcnt vmcnt(11)
    v_mfma_f32_16x16x32_bf16 v[68:71], v[36:39], v[144:147], v[68:71]
    v_mfma_f32_16x16x32_bf16 v[84:87], v[36:39], v[176:179], v[84:87]
    v_mfma_f32_16x16x32_bf16 v[100:103], v[36:39], v[208:211], v[100:103]
    v_mfma_f32_16x16x32_bf16 v[116:119], v[36:39], v[240:243], v[116:119]
    buffer_load_dwordx4 v[36:39], v5, s[44:47], s60 offen offset:1024 sc0 sc1
    s_waitcnt vmcnt(11)
    v_mfma_f32_16x16x32_bf16 v[72:75], v[40:43], v[144:147], v[72:75]
    v_mfma_f32_16x16x32_bf16 v[88:91], v[40:43], v[176:179], v[88:91]
    v_mfma_f32_16x16x32_bf16 v[104:107], v[40:43], v[208:211], v[104:107]
    v_mfma_f32_16x16x32_bf16 v[120:123], v[40:43], v[240:243], v[120:123]
    buffer_load_dwordx4 v[40:43], v5, s[44:47], s60 offen offset:2048 sc0 sc1
    s_waitcnt vmcnt(11)
    v_mfma_f32_16x16x32_bf16 v[76:79], v[44:47], v[144:147], v[76:79]
    v_mfma_f32_16x16x32_bf16 v[92:95], v[44:47], v[176:179], v[92:95]
    v_mfma_f32_16x16x32_bf16 v[108:111], v[44:47], v[208:211], v[108:111]
    v_mfma_f32_16x16x32_bf16 v[124:127], v[44:47], v[240:243], v[124:127]
    buffer_load_dwordx4 v[44:47], v5, s[44:47], s60 offen offset:3072 sc0 sc1
    s_waitcnt vmcnt(11)
    v_mfma_f32_16x16x32_bf16 v[64:67], v[48:51], v[148:151], v[64:67]
    v_mfma_f32_16x16x32_bf16 v[80:83], v[48:51], v[180:183], v[80:83]
    v_mfma_f32_16x16x32_bf16 v[96:99], v[48:51], v[212:215], v[96:99]
    v_mfma_f32_16x16x32_bf16 v[112:115], v[48:51], v[244:247], v[112:115]
    s_add_u32 s35, s63, 0
    s_and_b32 s35, s35, 7
    s_mul_i32 s35, s35, 7168
    s_add_u32 s60, s35, s55
    s_add_u32 s60, s60, 4096
    buffer_load_dwordx4 v[48:51], v5, s[44:47], s60 offen offset:0 sc0 sc1
    s_waitcnt vmcnt(11)
    v_mfma_f32_16x16x32_bf16 v[68:71], v[52:55], v[148:151], v[68:71]
    v_mfma_f32_16x16x32_bf16 v[84:87], v[52:55], v[180:183], v[84:87]
    v_mfma_f32_16x16x32_bf16 v[100:103], v[52:55], v[212:215], v[100:103]
    v_mfma_f32_16x16x32_bf16 v[116:119], v[52:55], v[244:247], v[116:119]
    buffer_load_dwordx4 v[52:55], v5, s[44:47], s60 offen offset:1024 sc0 sc1
    s_waitcnt vmcnt(11)
    v_mfma_f32_16x16x32_bf16 v[72:75], v[56:59], v[148:151], v[72:75]
    v_mfma_f32_16x16x32_bf16 v[88:91], v[56:59], v[180:183], v[88:91]
    v_mfma_f32_16x16x32_bf16 v[104:107], v[56:59], v[212:215], v[104:107]
    v_mfma_f32_16x16x32_bf16 v[120:123], v[56:59], v[244:247], v[120:123]
    buffer_load_dwordx4 v[56:59], v5, s[44:47], s60 offen offset:2048 sc0 sc1
    s_waitcnt vmcnt(11)
    v_mfma_f32_16x16x32_bf16 v[76:79], v[60:63], v[148:151], v[76:79]
    v_mfma_f32_16x16x32_bf16 v[92:95], v[60:63], v[180:183], v[92:95]
    v_mfma_f32_16x16x32_bf16 v[108:111], v[60:63], v[212:215], v[108:111]
    v_mfma_f32_16x16x32_bf16 v[124:127], v[60:63], v[244:247], v[124:127]
    s_add_u32 s35, s63, 1
    s_and_b32 s35, s35, 7
    s_mul_i32 s35, s35, 7168
    s_add_u32 s60, s35, s55
    s_add_u32 s60, s60, 4096
    buffer_load_dwordx4 v[60:63], v5, s[44:47], s60 offen offset:0 sc0 sc1
    s_waitcnt vmcnt(11)
    v_mfma_f32_16x16x32_bf16 v[64:67], v[16:19], v[152:155], v[64:67]
    v_mfma_f32_16x16x32_bf16 v[80:83], v[16:19], v[184:187], v[80:83]
    v_mfma_f32_16x16x32_bf16 v[96:99], v[16:19], v[216:219], v[96:99]
    v_mfma_f32_16x16x32_bf16 v[112:115], v[16:19], v[248:251], v[112:115]
    buffer_load_dwordx4 v[16:19], v5, s[44:47], s60 offen offset:1024 sc0 sc1
    s_waitcnt vmcnt(11)
    v_mfma_f32_16x16x32_bf16 v[68:71], v[20:23], v[152:155], v[68:71]
    v_mfma_f32_16x16x32_bf16 v[84:87], v[20:23], v[184:187], v[84:87]
    v_mfma_f32_16x16x32_bf16 v[100:103], v[20:23], v[216:219], v[100:103]
    v_mfma_f32_16x16x32_bf16 v[116:119], v[20:23], v[248:251], v[116:119]
    buffer_load_dwordx4 v[20:23], v5, s[44:47], s60 offen offset:2048 sc0 sc1
    s_waitcnt vmcnt(11)
    v_mfma_f32_16x16x32_bf16 v[72:75], v[24:27], v[152:155], v[72:75]
    v_mfma_f32_16x16x32_bf16 v[88:91], v[24:27], v[184:187], v[88:91]
    v_mfma_f32_16x16x32_bf16 v[104:107], v[24:27], v[216:219], v[104:107]
    v_mfma_f32_16x16x32_bf16 v[120:123], v[24:27], v[248:251], v[120:123]
    s_add_u32 s35, s63, 2
    s_and_b32 s35, s35, 7
    s_mul_i32 s35, s35, 7168
    s_add_u32 s60, s35, s55
    s_add_u32 s60, s60, 4096
    buffer_load_dwordx4 v[24:27], v5, s[44:47], s60 offen offset:0 sc0 sc1
    s_waitcnt vmcnt(11)
    v_mfma_f32_16x16x32_bf16 v[76:79], v[28:31], v[152:155], v[76:79]
    v_mfma_f32_16x16x32_bf16 v[92:95], v[28:31], v[184:187], v[92:95]
    v_mfma_f32_16x16x32_bf16 v[108:111], v[28:31], v[216:219], v[108:111]
    v_mfma_f32_16x16x32_bf16 v[124:127], v[28:31], v[248:251], v[124:127]
    buffer_load_dwordx4 v[28:31], v5, s[44:47], s60 offen offset:1024 sc0 sc1
    s_waitcnt vmcnt(11)
    v_mfma_f32_16x16x32_bf16 v[64:67], v[32:35], v[156:159], v[64:67]
    v_mfma_f32_16x16x32_bf16 v[80:83], v[32:35], v[188:191], v[80:83]
    v_mfma_f32_16x16x32_bf16 v[96:99], v[32:35], v[220:223], v[96:99]
    v_mfma_f32_16x16x32_bf16 v[112:115], v[32:35], v[252:255], v[112:115]
    buffer_load_dwordx4 v[32:35], v5, s[44:47], s60 offen offset:2048 sc0 sc1
    s_waitcnt vmcnt(11)
    v_mfma_f32_16x16x32_bf16 v[68:71], v[36:39], v[156:159], v[68:71]
    v_mfma_f32_16x16x32_bf16 v[84:87], v[36:39], v[188:191], v[84:87]
    v_mfma_f32_16x16x32_bf16 v[100:103], v[36:39], v[220:223], v[100:103]
    v_mfma_f32_16x16x32_bf16 v[116:119], v[36:39], v[252:255], v[116:119]
    s_add_u32 s35, s63, 3
    s_and_b32 s35, s35, 7
    s_mul_i32 s35, s35, 7168
    s_add_u32 s60, s35, s55
    s_add_u32 s60, s60, 4096
    buffer_load_dwordx4 v[36:39], v5, s[44:47], s60 offen offset:0 sc0 sc1
    s_waitcnt vmcnt(11)
    v_mfma_f32_16x16x32_bf16 v[72:75], v[40:43], v[156:159], v[72:75]
    v_mfma_f32_16x16x32_bf16 v[88:91], v[40:43], v[188:191], v[88:91]
    v_mfma_f32_16x16x32_bf16 v[104:107], v[40:43], v[220:223], v[104:107]
    v_mfma_f32_16x16x32_bf16 v[120:123], v[40:43], v[252:255], v[120:123]
    buffer_load_dwordx4 v[40:43], v5, s[44:47], s60 offen offset:1024 sc0 sc1
    s_lshl_b32 s32, s54, 3
    s_add_u32 s32, s32, s53
    s_lshl_b32 s32, s32, 2
    s_add_u32 s32, s32, 160768
    buffer_load_dword v4, v6, s[44:47], s32 offen sc0 sc1
    s_waitcnt vmcnt(11)
    v_mfma_f32_16x16x32_bf16 v[76:79], v[44:47], v[156:159], v[76:79]
    v_mfma_f32_16x16x32_bf16 v[92:95], v[44:47], v[188:191], v[92:95]
    v_mfma_f32_16x16x32_bf16 v[108:111], v[44:47], v[220:223], v[108:111]
    v_mfma_f32_16x16x32_bf16 v[124:127], v[44:47], v[252:255], v[124:127]
    buffer_load_dwordx4 v[44:47], v5, s[44:47], s60 offen offset:2048 sc0 sc1
    s_nop 7
    s_lshl_b32 s32, s3, 14
    s_add_u32 s32, s32, 0
    v_add_u32 v2, s32, v5
    v_cvt_pk_bf16_f32 v64, v64, v65
    v_cvt_pk_bf16_f32 v65, v66, v67
    v_cvt_pk_bf16_f32 v66, v68, v69
    v_cvt_pk_bf16_f32 v67, v70, v71
    ds_write_b128 v2, v[64:67] offset:0
    v_cvt_pk_bf16_f32 v72, v72, v73
    v_cvt_pk_bf16_f32 v73, v74, v75
    v_cvt_pk_bf16_f32 v74, v76, v77
    v_cvt_pk_bf16_f32 v75, v78, v79
    ds_write_b128 v2, v[72:75] offset:1024
    v_cvt_pk_bf16_f32 v80, v80, v81
    v_cvt_pk_bf16_f32 v81, v82, v83
    v_cvt_pk_bf16_f32 v82, v84, v85
    v_cvt_pk_bf16_f32 v83, v86, v87
    ds_write_b128 v2, v[80:83] offset:2048
    v_cvt_pk_bf16_f32 v88, v88, v89
    v_cvt_pk_bf16_f32 v89, v90, v91
    v_cvt_pk_bf16_f32 v90, v92, v93
    v_cvt_pk_bf16_f32 v91, v94, v95
    ds_write_b128 v2, v[88:91] offset:3072
    v_cvt_pk_bf16_f32 v96, v96, v97
    v_cvt_pk_bf16_f32 v97, v98, v99
    v_cvt_pk_bf16_f32 v98, v100, v101
    v_cvt_pk_bf16_f32 v99, v102, v103
    ds_write_b128 v2, v[96:99] offset:4096
    v_cvt_pk_bf16_f32 v104, v104, v105
    v_cvt_pk_bf16_f32 v105, v106, v107
    v_cvt_pk_bf16_f32 v106, v108, v109
    v_cvt_pk_bf16_f32 v107, v110, v111
    ds_write_b128 v2, v[104:107] offset:5120
    v_cvt_pk_bf16_f32 v112, v112, v113
    v_cvt_pk_bf16_f32 v113, v114, v115
    v_cvt_pk_bf16_f32 v114, v116, v117
    v_cvt_pk_bf16_f32 v115, v118, v119
    ds_write_b128 v2, v[112:115] offset:6144
    v_cvt_pk_bf16_f32 v120, v120, v121
    v_cvt_pk_bf16_f32 v121, v122, v123
    v_cvt_pk_bf16_f32 v122, v124, v125
    v_cvt_pk_bf16_f32 v123, v126, v127
    ds_write_b128 v2, v[120:123] offset:7168
    s_waitcnt vmcnt(11)
    v_mfma_f32_16x16x32_bf16 v[64:67], v[48:51], v[128:131], 0
    v_mfma_f32_16x16x32_bf16 v[80:83], v[48:51], v[160:163], 0
    v_mfma_f32_16x16x32_bf16 v[96:99], v[48:51], v[192:195], 0
    v_mfma_f32_16x16x32_bf16 v[112:115], v[48:51], v[224:227], 0
    s_add_u32 s35, s63, 4
    s_and_b32 s35, s35, 7
    s_mul_i32 s35, s35, 7168
    s_add_u32 s60, s35, s55
    s_add_u32 s60, s60, 4096
    buffer_load_dwordx4 v[48:51], v5, s[44:47], s60 offen offset:0 sc0 sc1
    s_waitcnt vmcnt(11)
    v_mfma_f32_16x16x32_bf16 v[68:71], v[52:55], v[128:131], 0
    v_mfma_f32_16x16x32_bf16 v[84:87], v[52:55], v[160:163], 0
    v_mfma_f32_16x16x32_bf16 v[100:103], v[52:55], v[192:195], 0
    v_mfma_f32_16x16x32_bf16 v[116:119], v[52:55], v[224:227], 0
    buffer_load_dwordx4 v[52:55], v5, s[44:47], s60 offen offset:1024 sc0 sc1
    s_waitcnt vmcnt(11)
    v_mfma_f32_16x16x32_bf16 v[72:75], v[56:59], v[128:131], 0
    v_mfma_f32_16x16x32_bf16 v[88:91], v[56:59], v[160:163], 0
    v_mfma_f32_16x16x32_bf16 v[104:107], v[56:59], v[192:195], 0
    v_mfma_f32_16x16x32_bf16 v[120:123], v[56:59], v[224:227], 0
    buffer_load_dwordx4 v[56:59], v5, s[44:47], s60 offen offset:2048 sc0 sc1
    s_waitcnt vmcnt(11)
    v_mfma_f32_16x16x32_bf16 v[64:67], v[60:63], v[132:135], v[64:67]
    v_mfma_f32_16x16x32_bf16 v[80:83], v[60:63], v[164:167], v[80:83]
    v_mfma_f32_16x16x32_bf16 v[96:99], v[60:63], v[196:199], v[96:99]
    v_mfma_f32_16x16x32_bf16 v[112:115], v[60:63], v[228:231], v[112:115]
    s_add_u32 s35, s63, 5
    s_and_b32 s35, s35, 7
    s_mul_i32 s35, s35, 7168
    s_add_u32 s60, s35, s55
    s_add_u32 s60, s60, 4096
    buffer_load_dwordx4 v[60:63], v5, s[44:47], s60 offen offset:0 sc0 sc1
    s_waitcnt vmcnt(11)
    v_mfma_f32_16x16x32_bf16 v[68:71], v[16:19], v[132:135], v[68:71]
    v_mfma_f32_16x16x32_bf16 v[84:87], v[16:19], v[164:167], v[84:87]
    v_mfma_f32_16x16x32_bf16 v[100:103], v[16:19], v[196:199], v[100:103]
    v_mfma_f32_16x16x32_bf16 v[116:119], v[16:19], v[228:231], v[116:119]
    buffer_load_dwordx4 v[16:19], v5, s[44:47], s60 offen offset:1024 sc0 sc1
    s_waitcnt vmcnt(11)
    v_mfma_f32_16x16x32_bf16 v[72:75], v[20:23], v[132:135], v[72:75]
    v_mfma_f32_16x16x32_bf16 v[88:91], v[20:23], v[164:167], v[88:91]
    v_mfma_f32_16x16x32_bf16 v[104:107], v[20:23], v[196:199], v[104:107]
    v_mfma_f32_16x16x32_bf16 v[120:123], v[20:23], v[228:231], v[120:123]
    buffer_load_dwordx4 v[20:23], v5, s[44:47], s60 offen offset:2048 sc0 sc1
    s_waitcnt vmcnt(11)
    v_mfma_f32_16x16x32_bf16 v[64:67], v[24:27], v[136:139], v[64:67]
    v_mfma_f32_16x16x32_bf16 v[80:83], v[24:27], v[168:171], v[80:83]
    v_mfma_f32_16x16x32_bf16 v[96:99], v[24:27], v[200:203], v[96:99]
    v_mfma_f32_16x16x32_bf16 v[112:115], v[24:27], v[232:235], v[112:115]
    s_add_u32 s35, s63, 6
    s_and_b32 s35, s35, 7
    s_mul_i32 s35, s35, 7168
    s_add_u32 s60, s35, s55
    s_add_u32 s60, s60, 4096
    buffer_load_dwordx4 v[24:27], v5, s[44:47], s60 offen offset:0 sc0 sc1
    s_waitcnt vmcnt(11)
    v_mfma_f32_16x16x32_bf16 v[68:71], v[28:31], v[136:139], v[68:71]
    v_mfma_f32_16x16x32_bf16 v[84:87], v[28:31], v[168:171], v[84:87]
    v_mfma_f32_16x16x32_bf16 v[100:103], v[28:31], v[200:203], v[100:103]
    v_mfma_f32_16x16x32_bf16 v[116:119], v[28:31], v[232:235], v[116:119]
    buffer_load_dwordx4 v[28:31], v5, s[44:47], s60 offen offset:1024 sc0 sc1
    s_waitcnt vmcnt(11)
    v_mfma_f32_16x16x32_bf16 v[72:75], v[32:35], v[136:139], v[72:75]
    v_mfma_f32_16x16x32_bf16 v[88:91], v[32:35], v[168:171], v[88:91]
    v_mfma_f32_16x16x32_bf16 v[104:107], v[32:35], v[200:203], v[104:107]
    v_mfma_f32_16x16x32_bf16 v[120:123], v[32:35], v[232:235], v[120:123]
    buffer_load_dwordx4 v[32:35], v5, s[44:47], s60 offen offset:2048 sc0 sc1
    s_waitcnt vmcnt(11)
    v_mfma_f32_16x16x32_bf16 v[64:67], v[36:39], v[140:143], v[64:67]
    v_mfma_f32_16x16x32_bf16 v[80:83], v[36:39], v[172:175], v[80:83]
    v_mfma_f32_16x16x32_bf16 v[96:99], v[36:39], v[204:207], v[96:99]
    v_mfma_f32_16x16x32_bf16 v[112:115], v[36:39], v[236:239], v[112:115]
    s_add_u32 s35, s63, 7
    s_and_b32 s35, s35, 7
    s_mul_i32 s35, s35, 7168
    s_add_u32 s60, s35, s55
    s_add_u32 s60, s60, 4096
    buffer_load_dwordx4 v[36:39], v5, s[44:47], s60 offen offset:0 sc0 sc1
    s_waitcnt vmcnt(11)
    v_mfma_f32_16x16x32_bf16 v[68:71], v[40:43], v[140:143], v[68:71]
    v_mfma_f32_16x16x32_bf16 v[84:87], v[40:43], v[172:175], v[84:87]
    v_mfma_f32_16x16x32_bf16 v[100:103], v[40:43], v[204:207], v[100:103]
    v_mfma_f32_16x16x32_bf16 v[116:119], v[40:43], v[236:239], v[116:119]
    buffer_load_dwordx4 v[40:43], v5, s[44:47], s60 offen offset:1024 sc0 sc1
    s_waitcnt vmcnt(11)
    v_mfma_f32_16x16x32_bf16 v[72:75], v[44:47], v[140:143], v[72:75]
    v_mfma_f32_16x16x32_bf16 v[88:91], v[44:47], v[172:175], v[88:91]
    v_mfma_f32_16x16x32_bf16 v[104:107], v[44:47], v[204:207], v[104:107]
    v_mfma_f32_16x16x32_bf16 v[120:123], v[44:47], v[236:239], v[120:123]
    buffer_load_dwordx4 v[44:47], v5, s[44:47], s60 offen offset:2048 sc0 sc1
    s_waitcnt vmcnt(11)
    v_mfma_f32_16x16x32_bf16 v[64:67], v[48:51], v[144:147], v[64:67]
    v_mfma_f32_16x16x32_bf16 v[80:83], v[48:51], v[176:179], v[80:83]
    v_mfma_f32_16x16x32_bf16 v[96:99], v[48:51], v[208:211], v[96:99]
    v_mfma_f32_16x16x32_bf16 v[112:115], v[48:51], v[240:243], v[112:115]
    s_waitcnt vmcnt(10)
    v_mfma_f32_16x16x32_bf16 v[68:71], v[52:55], v[144:147], v[68:71]
    v_mfma_f32_16x16x32_bf16 v[84:87], v[52:55], v[176:179], v[84:87]
    v_mfma_f32_16x16x32_bf16 v[100:103], v[52:55], v[208:211], v[100:103]
    v_mfma_f32_16x16x32_bf16 v[116:119], v[52:55], v[240:243], v[116:119]
    s_waitcnt vmcnt(9)
    v_mfma_f32_16x16x32_bf16 v[72:75], v[56:59], v[144:147], v[72:75]
    v_mfma_f32_16x16x32_bf16 v[88:91], v[56:59], v[176:179], v[88:91]
    v_mfma_f32_16x16x32_bf16 v[104:107], v[56:59], v[208:211], v[104:107]
    v_mfma_f32_16x16x32_bf16 v[120:123], v[56:59], v[240:243], v[120:123]
    s_waitcnt vmcnt(8)
    v_mfma_f32_16x16x32_bf16 v[64:67], v[60:63], v[148:151], v[64:67]
    v_mfma_f32_16x16x32_bf16 v[80:83], v[60:63], v[180:183], v[80:83]
    v_mfma_f32_16x16x32_bf16 v[96:99], v[60:63], v[212:215], v[96:99]
    v_mfma_f32_16x16x32_bf16 v[112:115], v[60:63], v[244:247], v[112:115]
    v_readfirstlane_b32 s32, v4
    s_cmp_eq_u32 s32, s37
    s_cbranch_scc1 p5_z1ok
    s_lshl_b32 s32, s54, 3
    s_add_u32 s32, s32, s53
    s_lshl_b32 s32, s32, 2
    s_add_u32 s32, s32, 160768
    s_mov_b32 s36, 0
    s_mov_b64 exec, 1
p5_z1poll:
    buffer_load_dword v3, v6, s[44:47], s32 offen sc0 sc1
    s_waitcnt vmcnt(0)
    v_xor_b32 v3, s37, v3
    v_cmp_ne_u32 vcc, 0, v3
    s_add_u32 s36, s36, 1
    s_cbranch_vccz p5_z1poll_ok
    s_cmp_lt_u32 s36, 40000
    s_cbranch_scc1 p5_z1poll
p5_z1poll_ok:
    s_mov_b64 exec, -1
p5_z1ok:
    s_lshr_b32 s52, s3, 1
    s_and_b32 s61, s3, 1
    s_lshl_b32 s32, s54, 2
    s_add_u32 s32, s32, s52
    s_mul_i32 s32, s32, 56
    s_mul_i32 s33, s53, 7
    s_add_u32 s32, s32, s33
    s_lshl_b32 s33, s61, 2
    s_add_u32 s32, s32, s33
    s_lshl_b32 s32, s32, 9
    s_add_u32 s32, s32, 8388608
    v_lshlrev_b32 v4, 3, v1
    buffer_load_dwordx2 v[48:49], v4, s[44:47], s32 offen offset:0 sc0 sc1
    buffer_load_dwordx2 v[50:51], v4, s[44:47], s32 offen offset:512 sc0 sc1
    buffer_load_dwordx2 v[52:53], v4, s[44:47], s32 offen offset:1024 sc0 sc1
    buffer_load_dwordx2 v[54:55], v4, s[44:47], s32 offen offset:1536 sc0 sc1
    s_mov_b32 s64, s20
    s_and_b32 s65, s21, 0xffff
    s_mov_b32 s66, 4096
    s_mov_b32 s67, 0x20000
    v_and_b32 v2, 15, v1
    v_lshlrev_b32 v2, 1, v2
    s_lshl_b32 s32, s54, 7
    s_lshl_b32 s33, s52, 5
    s_add_u32 s32, s32, s33
    buffer_load_ushort v56, v2, s[64:67], s32 offen
    s_waitcnt vmcnt(7)
    v_mfma_f32_16x16x32_bf16 v[68:71], v[16:19], v[148:151], v[68:71]
    v_mfma_f32_16x16x32_bf16 v[84:87], v[16:19], v[180:183], v[84:87]
    v_mfma_f32_16x16x32_bf16 v[100:103], v[16:19], v[212:215], v[100:103]
    v_mfma_f32_16x16x32_bf16 v[116:119], v[16:19], v[244:247], v[116:119]
    s_waitcnt vmcnt(6)
    v_mfma_f32_16x16x32_bf16 v[72:75], v[20:23], v[148:151], v[72:75]
    v_mfma_f32_16x16x32_bf16 v[88:91], v[20:23], v[180:183], v[88:91]
    v_mfma_f32_16x16x32_bf16 v[104:107], v[20:23], v[212:215], v[104:107]
    v_mfma_f32_16x16x32_bf16 v[120:123], v[20:23], v[244:247], v[120:123]
    s_waitcnt vmcnt(5)
    v_mfma_f32_16x16x32_bf16 v[64:67], v[24:27], v[152:155], v[64:67]
    v_mfma_f32_16x16x32_bf16 v[80:83], v[24:27], v[184:187], v[80:83]
    v_mfma_f32_16x16x32_bf16 v[96:99], v[24:27], v[216:219], v[96:99]
    v_mfma_f32_16x16x32_bf16 v[112:115], v[24:27], v[248:251], v[112:115]
    s_waitcnt vmcnt(4)
    v_mfma_f32_16x16x32_bf16 v[68:71], v[28:31], v[152:155], v[68:71]
    v_mfma_f32_16x16x32_bf16 v[84:87], v[28:31], v[184:187], v[84:87]
    v_mfma_f32_16x16x32_bf16 v[100:103], v[28:31], v[216:219], v[100:103]
    v_mfma_f32_16x16x32_bf16 v[116:119], v[28:31], v[248:251], v[116:119]
    s_waitcnt vmcnt(3)
    v_mfma_f32_16x16x32_bf16 v[72:75], v[32:35], v[152:155], v[72:75]
    v_mfma_f32_16x16x32_bf16 v[88:91], v[32:35], v[184:187], v[88:91]
    v_mfma_f32_16x16x32_bf16 v[104:107], v[32:35], v[216:219], v[104:107]
    v_mfma_f32_16x16x32_bf16 v[120:123], v[32:35], v[248:251], v[120:123]
    s_waitcnt vmcnt(2)
    v_mfma_f32_16x16x32_bf16 v[64:67], v[36:39], v[156:159], v[64:67]
    v_mfma_f32_16x16x32_bf16 v[80:83], v[36:39], v[188:191], v[80:83]
    v_mfma_f32_16x16x32_bf16 v[96:99], v[36:39], v[220:223], v[96:99]
    v_mfma_f32_16x16x32_bf16 v[112:115], v[36:39], v[252:255], v[112:115]
    s_waitcnt vmcnt(1)
    v_mfma_f32_16x16x32_bf16 v[68:71], v[40:43], v[156:159], v[68:71]
    v_mfma_f32_16x16x32_bf16 v[84:87], v[40:43], v[188:191], v[84:87]
    v_mfma_f32_16x16x32_bf16 v[100:103], v[40:43], v[220:223], v[100:103]
    v_mfma_f32_16x16x32_bf16 v[116:119], v[40:43], v[252:255], v[116:119]
    s_waitcnt vmcnt(0)
    v_mfma_f32_16x16x32_bf16 v[72:75], v[44:47], v[156:159], v[72:75]
    v_mfma_f32_16x16x32_bf16 v[88:91], v[44:47], v[188:191], v[88:91]
    v_mfma_f32_16x16x32_bf16 v[104:107], v[44:47], v[220:223], v[104:107]
    v_mfma_f32_16x16x32_bf16 v[120:123], v[44:47], v[252:255], v[120:123]
    s_memtime s[40:41]
    s_waitcnt lgkmcnt(0)
    v_writelane_b32 v0, s40, 20
    s_nop 7
    s_lshl_b32 s32, s3, 14
    s_add_u32 s32, s32, 8192
    v_add_u32 v2, s32, v5
    v_cvt_pk_bf16_f32 v64, v64, v65
    v_cvt_pk_bf16_f32 v65, v66, v67
    v_cvt_pk_bf16_f32 v66, v68, v69
    v_cvt_pk_bf16_f32 v67, v70, v71
    ds_write_b128 v2, v[64:67] offset:0
    v_cvt_pk_bf16_f32 v72, v72, v73
    v_cvt_pk_bf16_f32 v73, v74, v75
    v_cvt_pk_bf16_f32 v74, v76, v77
    v_cvt_pk_bf16_f32 v75, v78, v79
    ds_write_b128 v2, v[72:75] offset:1024
    v_cvt_pk_bf16_f32 v80, v80, v81
    v_cvt_pk_bf16_f32 v81, v82, v83
    v_cvt_pk_bf16_f32 v82, v84, v85
    v_cvt_pk_bf16_f32 v83, v86, v87
    ds_write_b128 v2, v[80:83] offset:2048
    v_cvt_pk_bf16_f32 v88, v88, v89
    v_cvt_pk_bf16_f32 v89, v90, v91
    v_cvt_pk_bf16_f32 v90, v92, v93
    v_cvt_pk_bf16_f32 v91, v94, v95
    ds_write_b128 v2, v[88:91] offset:3072
    v_cvt_pk_bf16_f32 v96, v96, v97
    v_cvt_pk_bf16_f32 v97, v98, v99
    v_cvt_pk_bf16_f32 v98, v100, v101
    v_cvt_pk_bf16_f32 v99, v102, v103
    ds_write_b128 v2, v[96:99] offset:4096
    v_cvt_pk_bf16_f32 v104, v104, v105
    v_cvt_pk_bf16_f32 v105, v106, v107
    v_cvt_pk_bf16_f32 v106, v108, v109
    v_cvt_pk_bf16_f32 v107, v110, v111
    ds_write_b128 v2, v[104:107] offset:5120
    v_cvt_pk_bf16_f32 v112, v112, v113
    v_cvt_pk_bf16_f32 v113, v114, v115
    v_cvt_pk_bf16_f32 v114, v116, v117
    v_cvt_pk_bf16_f32 v115, v118, v119
    ds_write_b128 v2, v[112:115] offset:6144
    v_cvt_pk_bf16_f32 v120, v120, v121
    v_cvt_pk_bf16_f32 v121, v122, v123
    v_cvt_pk_bf16_f32 v122, v124, v125
    v_cvt_pk_bf16_f32 v123, v126, v127
    ds_write_b128 v2, v[120:123] offset:7168
    s_waitcnt lgkmcnt(0)
    s_barrier
    s_lshl_b32 s32, s61, 13
    s_lshl_b32 s33, s52, 11
    s_add_u32 s32, s32, s33
    v_add_u32 v2, s32, v5
    v_add_u32 v3, 65536, v2
    ds_read_b128 v[128:131], v2 offset:0
    ds_read_b128 v[132:135], v2 offset:1024
    ds_read_b128 v[136:139], v2 offset:16384
    ds_read_b128 v[140:143], v2 offset:17408
    ds_read_b128 v[144:147], v2 offset:32768
    ds_read_b128 v[148:151], v2 offset:33792
    ds_read_b128 v[152:155], v2 offset:49152
    ds_read_b128 v[156:159], v2 offset:50176
    ds_read_b128 v[160:163], v3 offset:0
    ds_read_b128 v[164:167], v3 offset:1024
    ds_read_b128 v[168:171], v3 offset:16384
    ds_read_b128 v[172:175], v3 offset:17408
    ds_read_b128 v[176:179], v3 offset:32768
    ds_read_b128 v[180:183], v3 offset:33792
    ds_read_b128 v[184:187], v3 offset:49152
    ds_read_b128 v[188:191], v3 offset:50176
    v_mov_b32 v80, 0x00003f80
    v_mov_b32 v81, 0x3f800000
    s_waitcnt lgkmcnt(0)
    s_barrier
    v_dot2_f32_bf16 v64, v128, v80, 0
    v_dot2_f32_bf16 v65, v128, v81, 0
    v_dot2_f32_bf16 v66, v129, v80, 0
    v_dot2_f32_bf16 v67, v129, v81, 0
    v_dot2_f32_bf16 v68, v130, v80, 0
    v_dot2_f32_bf16 v69, v130, v81, 0
    v_dot2_f32_bf16 v70, v131, v80, 0
    v_dot2_f32_bf16 v71, v131, v81, 0
    v_dot2_f32_bf16 v72, v132, v80, 0
    v_dot2_f32_bf16 v73, v132, v81, 0
    v_dot2_f32_bf16 v74, v133, v80, 0
    v_dot2_f32_bf16 v75, v133, v81, 0
    v_dot2_f32_bf16 v76, v134, v80, 0
    v_dot2_f32_bf16 v77, v134, v81, 0
    v_dot2_f32_bf16 v78, v135, v80, 0
    v_dot2_f32_bf16 v79, v135, v81, 0
    v_dot2_f32_bf16 v64, v136, v80, v64
    v_dot2_f32_bf16 v65, v136, v81, v65
    v_dot2_f32_bf16 v66, v137, v80, v66
    v_dot2_f32_bf16 v67, v137, v81, v67
    v_dot2_f32_bf16 v68, v138, v80, v68
    v_dot2_f32_bf16 v69, v138, v81, v69
    v_dot2_f32_bf16 v70, v139, v80, v70
    v_dot2_f32_bf16 v71, v139, v81, v71
    v_dot2_f32_bf16 v72, v140, v80, v72
    v_dot2_f32_bf16 v73, v140, v81, v73
    v_dot2_f32_bf16 v74, v141, v80, v74
    v_dot2_f32_bf16 v75, v141, v81, v75
    v_dot2_f32_bf16 v76, v142, v80, v76
    v_dot2_f32_bf16 v77, v142, v81, v77
    v_dot2_f32_bf16 v78, v143, v80, v78
    v_dot2_f32_bf16 v79, v143, v81, v79
    v_dot2_f32_bf16 v64, v144, v80, v64
    v_dot2_f32_bf16 v65, v144, v81, v65
    v_dot2_f32_bf16 v66, v145, v80, v66
    v_dot2_f32_bf16 v67, v145, v81, v67
    v_dot2_f32_bf16 v68, v146, v80, v68
    v_dot2_f32_bf16 v69, v146, v81, v69
    v_dot2_f32_bf16 v70, v147, v80, v70
    v_dot2_f32_bf16 v71, v147, v81, v71
    v_dot2_f32_bf16 v72, v148, v80, v72
    v_dot2_f32_bf16 v73, v148, v81, v73
    v_dot2_f32_bf16 v74, v149, v80, v74
    v_dot2_f32_bf16 v75, v149, v81, v75
    v_dot2_f32_bf16 v76, v150, v80, v76
    v_dot2_f32_bf16 v77, v150, v81, v77
    v_dot2_f32_bf16 v78, v151, v80, v78
    v_dot2_f32_bf16 v79, v151, v81, v79
    v_dot2_f32_bf16 v64, v152, v80, v64
    v_dot2_f32_bf16 v65, v152, v81, v65
    v_dot2_f32_bf16 v66, v153, v80, v66
    v_dot2_f32_bf16 v67, v153, v81, v67
    v_dot2_f32_bf16 v68, v154, v80, v68
    v_dot2_f32_bf16 v69, v154, v81, v69
    v_dot2_f32_bf16 v70, v155, v80, v70
    v_dot2_f32_bf16 v71, v155, v81, v71
    v_dot2_f32_bf16 v72, v156, v80, v72
    v_dot2_f32_bf16 v73, v156, v81, v73
    v_dot2_f32_bf16 v74, v157, v80, v74
    v_dot2_f32_bf16 v75, v157, v81, v75
    v_dot2_f32_bf16 v76, v158, v80, v76
    v_dot2_f32_bf16 v77, v158, v81, v77
    v_dot2_f32_bf16 v78, v159, v80, v78
    v_dot2_f32_bf16 v79, v159, v81, v79
    v_dot2_f32_bf16 v64, v160, v80, v64
    v_dot2_f32_bf16 v65, v160, v81, v65
    v_dot2_f32_bf16 v66, v161, v80, v66
    v_dot2_f32_bf16 v67, v161, v81, v67
    v_dot2_f32_bf16 v68, v162, v80, v68
    v_dot2_f32_bf16 v69, v162, v81, v69
    v_dot2_f32_bf16 v70, v163, v80, v70
    v_dot2_f32_bf16 v71, v163, v81, v71
    v_dot2_f32_bf16 v72, v164, v80, v72
    v_dot2_f32_bf16 v73, v164, v81, v73
    v_dot2_f32_bf16 v74, v165, v80, v74
    v_dot2_f32_bf16 v75, v165, v81, v75
    v_dot2_f32_bf16 v76, v166, v80, v76
    v_dot2_f32_bf16 v77, v166, v81, v77
    v_dot2_f32_bf16 v78, v167, v80, v78
    v_dot2_f32_bf16 v79, v167, v81, v79
    v_dot2_f32_bf16 v64, v168, v80, v64
    v_dot2_f32_bf16 v65, v168, v81, v65
    v_dot2_f32_bf16 v66, v169, v80, v66
    v_dot2_f32_bf16 v67, v169, v81, v67
    v_dot2_f32_bf16 v68, v170, v80, v68
    v_dot2_f32_bf16 v69, v170, v81, v69
    v_dot2_f32_bf16 v70, v171, v80, v70
    v_dot2_f32_bf16 v71, v171, v81, v71
    v_dot2_f32_bf16 v72, v172, v80, v72
    v_dot2_f32_bf16 v73, v172, v81, v73
    v_dot2_f32_bf16 v74, v173, v80, v74
    v_dot2_f32_bf16 v75, v173, v81, v75
    v_dot2_f32_bf16 v76, v174, v80, v76
    v_dot2_f32_bf16 v77, v174, v81, v77
    v_dot2_f32_bf16 v78, v175, v80, v78
    v_dot2_f32_bf16 v79, v175, v81, v79
    v_dot2_f32_bf16 v64, v176, v80, v64
    v_dot2_f32_bf16 v65, v176, v81, v65
    v_dot2_f32_bf16 v66, v177, v80, v66
    v_dot2_f32_bf16 v67, v177, v81, v67
    v_dot2_f32_bf16 v68, v178, v80, v68
    v_dot2_f32_bf16 v69, v178, v81, v69
    v_dot2_f32_bf16 v70, v179, v80, v70
    v_dot2_f32_bf16 v71, v179, v81, v71
    v_dot2_f32_bf16 v72, v180, v80, v72
    v_dot2_f32_bf16 v73, v180, v81, v73
    v_dot2_f32_bf16 v74, v181, v80, v74
    v_dot2_f32_bf16 v75, v181, v81, v75
    v_dot2_f32_bf16 v76, v182, v80, v76
    v_dot2_f32_bf16 v77, v182, v81, v77
    v_dot2_f32_bf16 v78, v183, v80, v78
    v_dot2_f32_bf16 v79, v183, v81, v79
    v_dot2_f32_bf16 v64, v184, v80, v64
    v_dot2_f32_bf16 v65, v184, v81, v65
    v_dot2_f32_bf16 v66, v185, v80, v66
    v_dot2_f32_bf16 v67, v185, v81, v67
    v_dot2_f32_bf16 v68, v186, v80, v68
    v_dot2_f32_bf16 v69, v186, v81, v69
    v_dot2_f32_bf16 v70, v187, v80, v70
    v_dot2_f32_bf16 v71, v187, v81, v71
    v_dot2_f32_bf16 v72, v188, v80, v72
    v_dot2_f32_bf16 v73, v188, v81, v73
    v_dot2_f32_bf16 v74, v189, v80, v74
    v_dot2_f32_bf16 v75, v189, v81, v75
    v_dot2_f32_bf16 v76, v190, v80, v76
    v_dot2_f32_bf16 v77, v190, v81, v77
    v_dot2_f32_bf16 v78, v191, v80, v78
    v_dot2_f32_bf16 v79, v191, v81, v79
    s_waitcnt vmcnt(0)
    v_lshlrev_b32 v56, 16, v56
    v_lshlrev_b32 v84, 16, v48
    v_and_b32 v85, 0xffff0000, v48
    v_lshlrev_b32 v86, 16, v49
    v_and_b32 v87, 0xffff0000, v49
    v_add_f32 v64, v64, v56
    v_mul_f32 v64, v64, v84
    v_add_f32 v65, v65, v56
    v_mul_f32 v65, v65, v85
    v_add_f32 v66, v66, v56
    v_mul_f32 v66, v66, v86
    v_add_f32 v67, v67, v56
    v_mul_f32 v67, v67, v87
    v_cvt_pk_bf16_f32 v48, v64, v65
    v_cvt_pk_bf16_f32 v49, v66, v67
    v_lshlrev_b32 v84, 16, v50
    v_and_b32 v85, 0xffff0000, v50
    v_lshlrev_b32 v86, 16, v51
    v_and_b32 v87, 0xffff0000, v51
    v_add_f32 v68, v68, v56
    v_mul_f32 v68, v68, v84
    v_add_f32 v69, v69, v56
    v_mul_f32 v69, v69, v85
    v_add_f32 v70, v70, v56
    v_mul_f32 v70, v70, v86
    v_add_f32 v71, v71, v56
    v_mul_f32 v71, v71, v87
    v_cvt_pk_bf16_f32 v50, v68, v69
    v_cvt_pk_bf16_f32 v51, v70, v71
    v_lshlrev_b32 v84, 16, v52
    v_and_b32 v85, 0xffff0000, v52
    v_lshlrev_b32 v86, 16, v53
    v_and_b32 v87, 0xffff0000, v53
    v_add_f32 v72, v72, v56
    v_mul_f32 v72, v72, v84
    v_add_f32 v73, v73, v56
    v_mul_f32 v73, v73, v85
    v_add_f32 v74, v74, v56
    v_mul_f32 v74, v74, v86
    v_add_f32 v75, v75, v56
    v_mul_f32 v75, v75, v87
    v_cvt_pk_bf16_f32 v52, v72, v73
    v_cvt_pk_bf16_f32 v53, v74, v75
    v_lshlrev_b32 v84, 16, v54
    v_and_b32 v85, 0xffff0000, v54
    v_lshlrev_b32 v86, 16, v55
    v_and_b32 v87, 0xffff0000, v55
    v_add_f32 v76, v76, v56
    v_mul_f32 v76, v76, v84
    v_add_f32 v77, v77, v56
    v_mul_f32 v77, v77, v85
    v_add_f32 v78, v78, v56
    v_mul_f32 v78, v78, v86
    v_add_f32 v79, v79, v56
    v_mul_f32 v79, v79, v87
    v_cvt_pk_bf16_f32 v54, v76, v77
    v_cvt_pk_bf16_f32 v55, v78, v79
    s_cmp_eq_u32 s61, 0
    s_cbranch_scc1 p5_nopad
    v_mov_b32 v54, 0
    v_mov_b32 v55, 0
p5_nopad:
    s_lshl_b32 s32, s54, 2
    s_add_u32 s32, s32, s52
    s_lshl_b32 s32, s32, 5
    s_lshl_b32 s33, s53, 2
    s_add_u32 s32, s32, s33
    s_lshl_b32 s33, s61, 1
    s_add_u32 s32, s32, s33
    s_mul_i32 s32, s32, 1280
    s_add_u32 s32, s32, 39845888
    v_xor_b32 v3, v48, v49
    v_xor_b32 v3, v3, v50
    v_xor_b32 v3, v3, v51
    v_xor_b32 v3, s37, v3
    buffer_store_dwordx4 v[48:51], v5, s[44:47], s32 offen sc0 sc1
    buffer_store_dword v3, v6, s[44:47], s32 offen offset:1024 sc0 sc1
    s_add_u32 s32, s32, 1280
    v_xor_b32 v2, v52, v53
    v_xor_b32 v2, v2, v54
    v_xor_b32 v2, v2, v55
    v_xor_b32 v2, s37, v2
    buffer_store_dwordx4 v[52:55], v5, s[44:47], s32 offen sc0 sc1
    buffer_store_dword v2, v6, s[44:47], s32 offen offset:1024 sc0 sc1
    s_lshl_b32 s32, s54, 2
    s_add_u32 s32, s32, s52
    s_lshl_b32 s32, s32, 4
    s_lshl_b32 s33, s53, 1
    s_add_u32 s32, s32, s33
    s_add_u32 s32, s32, s61
    s_lshl_b32 s32, s32, 2
    s_add_u32 s32, s32, 163840
    v_mov_b32 v3, s37
    s_mov_b64 exec, 1
    buffer_store_dword v3, v6, s[44:47], s32 offen sc0 sc1
    s_mov_b64 exec, -1
    s_memtime s[40:41]
    s_waitcnt lgkmcnt(0)
    v_writelane_b32 v0, s40, 21
    s_mov_b32 s52, s24
    s_and_b32 s53, s25, 0xffff
    s_mov_b32 s54, 2097152
    s_mov_b32 s55, 0x20000
    s_lshl_b32 s33, s3, 14
    s_lshl_b32 s32, s31, 17
    s_add_u32 s32, s32, s33
    s_add_u32 m0, s33, 0
    s_add_u32 s98, s32, 47185920
    buffer_load_dwordx4 v5, s[44:47], s98 offen sc0 sc1 lds
    s_add_u32 m0, s33, 1024
    s_add_u32 s98, s32, 47186944
    buffer_load_dwordx4 v5, s[44:47], s98 offen sc0 sc1 lds
    s_add_u32 m0, s33, 2048
    s_add_u32 s98, s32, 47187968
    buffer_load_dwordx4 v5, s[44:47], s98 offen sc0 sc1 lds
    s_add_u32 m0, s33, 3072
    s_add_u32 s98, s32, 47188992
    buffer_load_dwordx4 v5, s[44:47], s98 offen sc0 sc1 lds
    s_add_u32 m0, s33, 4096
    s_add_u32 s98, s32, 47190016
    buffer_load_dwordx4 v5, s[44:47], s98 offen sc0 sc1 lds
    s_add_u32 m0, s33, 5120
    s_add_u32 s98, s32, 47191040
    buffer_load_dwordx4 v5, s[44:47], s98 offen sc0 sc1 lds
    s_add_u32 m0, s33, 6144
    s_add_u32 s98, s32, 47192064
    buffer_load_dwordx4 v5, s[44:47], s98 offen sc0 sc1 lds
    s_add_u32 m0, s33, 7168
    s_add_u32 s98, s32, 47193088
    buffer_load_dwordx4 v5, s[44:47], s98 offen sc0 sc1 lds
    s_add_u32 m0, s33, 8192
    s_add_u32 s98, s32, 47194112
    buffer_load_dwordx4 v5, s[44:47], s98 offen sc0 sc1 lds
    s_add_u32 m0, s33, 9216
    s_add_u32 s98, s32, 47195136
    buffer_load_dwordx4 v5, s[44:47], s98 offen sc0 sc1 lds
    s_add_u32 m0, s33, 10240
    s_add_u32 s98, s32, 47196160
    buffer_load_dwordx4 v5, s[44:47], s98 offen sc0 sc1 lds
    s_add_u32 m0, s33, 11264
    s_add_u32 s98, s32, 47197184
    buffer_load_dwordx4 v5, s[44:47], s98 offen sc0 sc1 lds
    s_add_u32 m0, s33, 12288
    s_add_u32 s98, s32, 47198208
    buffer_load_dwordx4 v5, s[44:47], s98 offen sc0 sc1 lds
    s_add_u32 m0, s33, 13312
    s_add_u32 s98, s32, 47199232
    buffer_load_dwordx4 v5, s[44:47], s98 offen sc0 sc1 lds
    s_add_u32 m0, s33, 14336
    s_add_u32 s98, s32, 47200256
    buffer_load_dwordx4 v5, s[44:47], s98 offen sc0 sc1 lds
    s_add_u32 m0, s33, 15360
    s_add_u32 s98, s32, 47201280
    buffer_load_dwordx4 v5, s[44:47], s98 offen sc0 sc1 lds
    s_lshl_b32 s32, s39, 14
    v_add_u32 v12, s32, v5
    v_add_u32 v13, 65536, v12
    v_lshlrev_b32 v56, 16, v8
    v_and_b32 v57, 0xffff0000, v8
    v_lshlrev_b32 v58, 16, v9
    v_and_b32 v59, 0xffff0000, v9
    v_lshlrev_b32 v60, 16, v10
    v_and_b32 v61, 0xffff0000, v10
    v_lshlrev_b32 v62, 16, v11
    v_and_b32 v63, 0xffff0000, v11
    s_lshl_b32 s32, s30, 2
    s_add_u32 s32, s32, s38
    s_lshl_b32 s32, s32, 5
    s_lshl_b32 s33, s39, 4
    s_add_u32 s32, s32, s33
    s_mul_i32 s32, s32, 1280
    s_add_u32 s32, s32, 39845888
    s_lshl_b32 s34, s30, 2
    s_add_u32 s34, s34, s38
    s_lshl_b32 s34, s34, 4
    s_lshl_b32 s33, s39, 3
    s_add_u32 s34, s34, s33
    s_lshl_b32 s34, s34, 2
    s_add_u32 s34, s34, 163840
    s_mov_b32 s36, 0
    s_mov_b64 exec, 0xff
p6_hint:
    buffer_load_dword v3, v6, s[44:47], s34 offen sc0 sc1
    s_waitcnt vmcnt(0)
    v_xor_b32 v3, s37, v3
    v_cmp_ne_u32 vcc, 0, v3
    s_add_u32 s36, s36, 1
    s_cbranch_vccz p6_hint_ok
    s_cmp_lt_u32 s36, 40000
    s_cbranch_scc1 p6_hint
p6_hint_ok:
    s_mov_b64 exec, -1
    s_waitcnt vmcnt(0)
    s_mov_b32 s36, 0
p6_poll:
    s_mov_b32 s33, s32
    buffer_load_dwordx4 v[128:131], v5, s[44:47], s33 offen sc0 sc1
    buffer_load_dword v192, v6, s[44:47], s33 offen offset:1024 sc0 sc1
    s_add_u32 s33, s33, 1280
    buffer_load_dwordx4 v[132:135], v5, s[44:47], s33 offen sc0 sc1
    buffer_load_dword v193, v6, s[44:47], s33 offen offset:1024 sc0 sc1
    s_add_u32 s33, s33, 1280
    buffer_load_dwordx4 v[136:139], v5, s[44:47], s33 offen sc0 sc1
    buffer_load_dword v194, v6, s[44:47], s33 offen offset:1024 sc0 sc1
    s_add_u32 s33, s33, 1280
    buffer_load_dwordx4 v[140:143], v5, s[44:47], s33 offen sc0 sc1
    buffer_load_dword v195, v6, s[44:47], s33 offen offset:1024 sc0 sc1
    s_add_u32 s33, s33, 1280
    buffer_load_dwordx4 v[144:147], v5, s[44:47], s33 offen sc0 sc1
    buffer_load_dword v196, v6, s[44:47], s33 offen offset:1024 sc0 sc1
    s_add_u32 s33, s33, 1280
    buffer_load_dwordx4 v[148:151], v5, s[44:47], s33 offen sc0 sc1
    buffer_load_dword v197, v6, s[44:47], s33 offen offset:1024 sc0 sc1
    s_add_u32 s33, s33, 1280
    buffer_load_dwordx4 v[152:155], v5, s[44:47], s33 offen sc0 sc1
    buffer_load_dword v198, v6, s[44:47], s33 offen offset:1024 sc0 sc1
    s_add_u32 s33, s33, 1280
    buffer_load_dwordx4 v[156:159], v5, s[44:47], s33 offen sc0 sc1
    buffer_load_dword v199, v6, s[44:47], s33 offen offset:1024 sc0 sc1
    s_add_u32 s33, s33, 1280
    buffer_load_dwordx4 v[160:163], v5, s[44:47], s33 offen sc0 sc1
    buffer_load_dword v200, v6, s[44:47], s33 offen offset:1024 sc0 sc1
    s_add_u32 s33, s33, 1280
    buffer_load_dwordx4 v[164:167], v5, s[44:47], s33 offen sc0 sc1
    buffer_load_dword v201, v6, s[44:47], s33 offen offset:1024 sc0 sc1
    s_add_u32 s33, s33, 1280
    buffer_load_dwordx4 v[168:171], v5, s[44:47], s33 offen sc0 sc1
    buffer_load_dword v202, v6, s[44:47], s33 offen offset:1024 sc0 sc1
    s_add_u32 s33, s33, 1280
    buffer_load_dwordx4 v[172:175], v5, s[44:47], s33 offen sc0 sc1
    buffer_load_dword v203, v6, s[44:47], s33 offen offset:1024 sc0 sc1
    s_add_u32 s33, s33, 1280
    buffer_load_dwordx4 v[176:179], v5, s[44:47], s33 offen sc0 sc1
    buffer_load_dword v204, v6, s[44:47], s33 offen offset:1024 sc0 sc1
    s_add_u32 s33, s33, 1280
    buffer_load_dwordx4 v[180:183], v5, s[44:47], s33 offen sc0 sc1
    buffer_load_dword v205, v6, s[44:47], s33 offen offset:1024 sc0 sc1
    s_add_u32 s33, s33, 1280
    buffer_load_dwordx4 v[184:187], v5, s[44:47], s33 offen sc0 sc1
    buffer_load_dword v206, v6, s[44:47], s33 offen offset:1024 sc0 sc1
    s_add_u32 s33, s33, 1280
    buffer_load_dwordx4 v[188:191], v5, s[44:47], s33 offen sc0 sc1
    buffer_load_dword v207, v6, s[44:47], s33 offen offset:1024 sc0 sc1
    s_waitcnt vmcnt(0)
    v_xor_b32 v192, v192, v128
    v_xor_b32 v192, v192, v129
    v_xor_b32 v192, v192, v130
    v_xor_b32 v192, v192, v131
    v_xor_b32 v192, s37, v192
    v_xor_b32 v193, v193, v132
    v_xor_b32 v193, v193, v133
    v_xor_b32 v193, v193, v134
    v_xor_b32 v193, v193, v135
    v_xor_b32 v193, s37, v193
    v_xor_b32 v194, v194, v136
    v_xor_b32 v194, v194, v137
    v_xor_b32 v194, v194, v138
    v_xor_b32 v194, v194, v139
    v_xor_b32 v194, s37, v194
    v_xor_b32 v195, v195, v140
    v_xor_b32 v195, v195, v141
    v_xor_b32 v195, v195, v142
    v_xor_b32 v195, v195, v143
    v_xor_b32 v195, s37, v195
    v_xor_b32 v196, v196, v144
    v_xor_b32 v196, v196, v145
    v_xor_b32 v196, v196, v146
    v_xor_b32 v196, v196, v147
    v_xor_b32 v196, s37, v196
    v_xor_b32 v197, v197, v148
    v_xor_b32 v197, v197, v149
    v_xor_b32 v197, v197, v150
    v_xor_b32 v197, v197, v151
    v_xor_b32 v197, s37, v197
    v_xor_b32 v198, v198, v152
    v_xor_b32 v198, v198, v153
    v_xor_b32 v198, v198, v154
    v_xor_b32 v198, v198, v155
    v_xor_b32 v198, s37, v198
    v_xor_b32 v199, v199, v156
    v_xor_b32 v199, v199, v157
    v_xor_b32 v199, v199, v158
    v_xor_b32 v199, v199, v159
    v_xor_b32 v199, s37, v199
    v_xor_b32 v200, v200, v160
    v_xor_b32 v200, v200, v161
    v_xor_b32 v200, v200, v162
    v_xor_b32 v200, v200, v163
    v_xor_b32 v200, s37, v200
    v_xor_b32 v201, v201, v164
    v_xor_b32 v201, v201, v165
    v_xor_b32 v201, v201, v166
    v_xor_b32 v201, v201, v167
    v_xor_b32 v201, s37, v201
    v_xor_b32 v202, v202, v168
    v_xor_b32 v202, v202, v169
    v_xor_b32 v202, v202, v170
    v_xor_b32 v202, v202, v171
    v_xor_b32 v202, s37, v202
    v_xor_b32 v203, v203, v172
    v_xor_b32 v203, v203, v173
    v_xor_b32 v203, v203, v174
    v_xor_b32 v203, v203, v175
    v_xor_b32 v203, s37, v203
    v_xor_b32 v204, v204, v176
    v_xor_b32 v204, v204, v177
    v_xor_b32 v204, v204, v178
    v_xor_b32 v204, v204, v179
    v_xor_b32 v204, s37, v204
    v_xor_b32 v205, v205, v180
    v_xor_b32 v205, v205, v181
    v_xor_b32 v205, v205, v182
    v_xor_b32 v205, v205, v183
    v_xor_b32 v205, s37, v205
    v_xor_b32 v206, v206, v184
    v_xor_b32 v206, v206, v185
    v_xor_b32 v206, v206, v186
    v_xor_b32 v206, v206, v187
    v_xor_b32 v206, s37, v206
    v_xor_b32 v207, v207, v188
    v_xor_b32 v207, v207, v189
    v_xor_b32 v207, v207, v190
    v_xor_b32 v207, v207, v191
    v_xor_b32 v207, s37, v207
    v_or_b32 v192, v192, v193
    v_or_b32 v192, v192, v194
    v_or_b32 v192, v192, v195
    v_or_b32 v192, v192, v196
    v_or_b32 v192, v192, v197
    v_or_b32 v192, v192, v198
    v_or_b32 v192, v192, v199
    v_or_b32 v192, v192, v200
    v_or_b32 v192, v192, v201
    v_or_b32 v192, v192, v202
    v_or_b32 v192, v192, v203
    v_or_b32 v192, v192, v204
    v_or_b32 v192, v192, v205
    v_or_b32 v192, v192, v206
    v_or_b32 v192, v192, v207
    v_cmp_ne_u32 vcc, 0, v192
    s_add_u32 s36, s36, 1
    s_cbranch_vccz p6_poll_ok
    s_cmp_lt_u32 s36, 40000
    s_cbranch_scc1 p6_poll
p6_poll_ok:
    s_memtime s[40:41]
    s_waitcnt lgkmcnt(0)
    v_writelane_b32 v0, s40, 22
    s_barrier
    s_memtime s[40:41]
    s_waitcnt lgkmcnt(0)
    v_writelane_b32 v0, s40, 23
    ds_read_b128 v[32:35], v12 offset:0
    ds_read_b128 v[36:39], v12 offset:32768
    ds_read_b128 v[40:43], v13 offset:0
    ds_read_b128 v[44:47], v13 offset:32768
    ds_read_b128 v[48:51], v12 offset:1024
    ds_read_b128 v[52:55], v12 offset:33792
    s_waitcnt lgkmcnt(5)
    v_mfma_f32_16x16x32_bf16 v[16:19], v[32:35], v[128:131], 0
    ds_read_b128 v[32:35], v13 offset:1024
    s_waitcnt lgkmcnt(5)
    v_mfma_f32_16x16x32_bf16 v[20:23], v[36:39], v[128:131], 0
    ds_read_b128 v[36:39], v13 offset:33792
    s_waitcnt lgkmcnt(5)
    v_mfma_f32_16x16x32_bf16 v[24:27], v[40:43], v[128:131], 0
    ds_read_b128 v[40:43], v12 offset:2048
    s_waitcnt lgkmcnt(5)
    v_mfma_f32_16x16x32_bf16 v[28:31], v[44:47], v[128:131], 0
    ds_read_b128 v[44:47], v12 offset:34816
    s_waitcnt lgkmcnt(5)
    v_mfma_f32_16x16x32_bf16 v[16:19], v[48:51], v[132:135], v[16:19]
    ds_read_b128 v[48:51], v13 offset:2048
    s_waitcnt lgkmcnt(5)
    v_mfma_f32_16x16x32_bf16 v[20:23], v[52:55], v[132:135], v[20:23]
    ds_read_b128 v[52:55], v13 offset:34816
    s_waitcnt lgkmcnt(5)
    v_mfma_f32_16x16x32_bf16 v[24:27], v[32:35], v[132:135], v[24:27]
    ds_read_b128 v[32:35], v12 offset:3072
    s_waitcnt lgkmcnt(5)
    v_mfma_f32_16x16x32_bf16 v[28:31], v[36:39], v[132:135], v[28:31]
    ds_read_b128 v[36:39], v12 offset:35840
    s_waitcnt lgkmcnt(5)
    v_mfma_f32_16x16x32_bf16 v[16:19], v[40:43], v[136:139], v[16:19]
    ds_read_b128 v[40:43], v13 offset:3072
    s_waitcnt lgkmcnt(5)
    v_mfma_f32_16x16x32_bf16 v[20:23], v[44:47], v[136:139], v[20:23]
    ds_read_b128 v[44:47], v13 offset:35840
    s_waitcnt lgkmcnt(5)
    v_mfma_f32_16x16x32_bf16 v[24:27], v[48:51], v[136:139], v[24:27]
    ds_read_b128 v[48:51], v12 offset:4096
    s_waitcnt lgkmcnt(5)
    v_mfma_f32_16x16x32_bf16 v[28:31], v[52:55], v[136:139], v[28:31]
    ds_read_b128 v[52:55], v12 offset:36864
    s_waitcnt lgkmcnt(5)
    v_mfma_f32_16x16x32_bf16 v[16:19], v[32:35], v[140:143], v[16:19]
    ds_read_b128 v[32:35], v13 offset:4096
    s_waitcnt lgkmcnt(5)
    v_mfma_f32_16x16x32_bf16 v[20:23], v[36:39], v[140:143], v[20:23]
    ds_read_b128 v[36:39], v13 offset:36864
    s_waitcnt lgkmcnt(5)
    v_mfma_f32_16x16x32_bf16 v[24:27], v[40:43], v[140:143], v[24:27]
    ds_read_b128 v[40:43], v12 offset:5120
    s_waitcnt lgkmcnt(5)
    v_mfma_f32_16x16x32_bf16 v[28:31], v[44:47], v[140:143], v[28:31]
    ds_read_b128 v[44:47], v12 offset:37888
    s_waitcnt lgkmcnt(5)
    v_mfma_f32_16x16x32_bf16 v[16:19], v[48:51], v[144:147], v[16:19]
    ds_read_b128 v[48:51], v13 offset:5120
    s_waitcnt lgkmcnt(5)
    v_mfma_f32_16x16x32_bf16 v[20:23], v[52:55], v[144:147], v[20:23]
    ds_read_b128 v[52:55], v13 offset:37888
    s_waitcnt lgkmcnt(5)
    v_mfma_f32_16x16x32_bf16 v[24:27], v[32:35], v[144:147], v[24:27]
    ds_read_b128 v[32:35], v12 offset:6144
    s_waitcnt lgkmcnt(5)
    v_mfma_f32_16x16x32_bf16 v[28:31], v[36:39], v[144:147], v[28:31]
    ds_read_b128 v[36:39], v12 offset:38912
    s_waitcnt lgkmcnt(5)
    v_mfma_f32_16x16x32_bf16 v[16:19], v[40:43], v[148:151], v[16:19]
    ds_read_b128 v[40:43], v13 offset:6144
    s_waitcnt lgkmcnt(5)
    v_mfma_f32_16x16x32_bf16 v[20:23], v[44:47], v[148:151], v[20:23]
    ds_read_b128 v[44:47], v13 offset:38912
    s_waitcnt lgkmcnt(5)
    v_mfma_f32_16x16x32_bf16 v[24:27], v[48:51], v[148:151], v[24:27]
    ds_read_b128 v[48:51], v12 offset:7168
    s_waitcnt lgkmcnt(5)
    v_mfma_f32_16x16x32_bf16 v[28:31], v[52:55], v[148:151], v[28:31]
    ds_read_b128 v[52:55], v12 offset:39936
    s_waitcnt lgkmcnt(5)
    v_mfma_f32_16x16x32_bf16 v[16:19], v[32:35], v[152:155], v[16:19]
    ds_read_b128 v[32:35], v13 offset:7168
    s_waitcnt lgkmcnt(5)
    v_mfma_f32_16x16x32_bf16 v[20:23], v[36:39], v[152:155], v[20:23]
    ds_read_b128 v[36:39], v13 offset:39936
    s_waitcnt lgkmcnt(5)
    v_mfma_f32_16x16x32_bf16 v[24:27], v[40:43], v[152:155], v[24:27]
    ds_read_b128 v[40:43], v12 offset:8192
    s_waitcnt lgkmcnt(5)
    v_mfma_f32_16x16x32_bf16 v[28:31], v[44:47], v[152:155], v[28:31]
    ds_read_b128 v[44:47], v12 offset:40960
    s_waitcnt lgkmcnt(5)
    v_mfma_f32_16x16x32_bf16 v[16:19], v[48:51], v[156:159], v[16:19]
    ds_read_b128 v[48:51], v13 offset:8192
    s_waitcnt lgkmcnt(5)
    v_mfma_f32_16x16x32_bf16 v[20:23], v[52:55], v[156:159], v[20:23]
    ds_read_b128 v[52:55], v13 offset:40960
    s_waitcnt lgkmcnt(5)
    v_mfma_f32_16x16x32_bf16 v[24:27], v[32:35], v[156:159], v[24:27]
    ds_read_b128 v[32:35], v12 offset:9216
    s_waitcnt lgkmcnt(5)
    v_mfma_f32_16x16x32_bf16 v[28:31], v[36:39], v[156:159], v[28:31]
    ds_read_b128 v[36:39], v12 offset:41984
    s_waitcnt lgkmcnt(5)
    v_mfma_f32_16x16x32_bf16 v[16:19], v[40:43], v[160:163], v[16:19]
    ds_read_b128 v[40:43], v13 offset:9216
    s_waitcnt lgkmcnt(5)
    v_mfma_f32_16x16x32_bf16 v[20:23], v[44:47], v[160:163], v[20:23]
    ds_read_b128 v[44:47], v13 offset:41984
    s_waitcnt lgkmcnt(5)
    v_mfma_f32_16x16x32_bf16 v[24:27], v[48:51], v[160:163], v[24:27]
    ds_read_b128 v[48:51], v12 offset:10240
    s_waitcnt lgkmcnt(5)
    v_mfma_f32_16x16x32_bf16 v[28:31], v[52:55], v[160:163], v[28:31]
    ds_read_b128 v[52:55], v12 offset:43008
    s_waitcnt lgkmcnt(5)
    v_mfma_f32_16x16x32_bf16 v[16:19], v[32:35], v[164:167], v[16:19]
    ds_read_b128 v[32:35], v13 offset:10240
    s_waitcnt lgkmcnt(5)
    v_mfma_f32_16x16x32_bf16 v[20:23], v[36:39], v[164:167], v[20:23]
    ds_read_b128 v[36:39], v13 offset:43008
    s_waitcnt lgkmcnt(5)
    v_mfma_f32_16x16x32_bf16 v[24:27], v[40:43], v[164:167], v[24:27]
    ds_read_b128 v[40:43], v12 offset:11264
    s_waitcnt lgkmcnt(5)
    v_mfma_f32_16x16x32_bf16 v[28:31], v[44:47], v[164:167], v[28:31]
    ds_read_b128 v[44:47], v12 offset:44032
    s_waitcnt lgkmcnt(5)
    v_mfma_f32_16x16x32_bf16 v[16:19], v[48:51], v[168:171], v[16:19]
    ds_read_b128 v[48:51], v13 offset:11264
    s_waitcnt lgkmcnt(5)
    v_mfma_f32_16x16x32_bf16 v[20:23], v[52:55], v[168:171], v[20:23]
    ds_read_b128 v[52:55], v13 offset:44032
    s_waitcnt lgkmcnt(5)
    v_mfma_f32_16x16x32_bf16 v[24:27], v[32:35], v[168:171], v[24:27]
    ds_read_b128 v[32:35], v12 offset:12288
    s_waitcnt lgkmcnt(5)
    v_mfma_f32_16x16x32_bf16 v[28:31], v[36:39], v[168:171], v[28:31]
    ds_read_b128 v[36:39], v12 offset:45056
    s_waitcnt lgkmcnt(5)
    v_mfma_f32_16x16x32_bf16 v[16:19], v[40:43], v[172:175], v[16:19]
    ds_read_b128 v[40:43], v13 offset:12288
    s_waitcnt lgkmcnt(5)
    v_mfma_f32_16x16x32_bf16 v[20:23], v[44:47], v[172:175], v[20:23]
    ds_read_b128 v[44:47], v13 offset:45056
    s_waitcnt lgkmcnt(5)
    v_mfma_f32_16x16x32_bf16 v[24:27], v[48:51], v[172:175], v[24:27]
    ds_read_b128 v[48:51], v12 offset:13312
    s_waitcnt lgkmcnt(5)
    v_mfma_f32_16x16x32_bf16 v[28:31], v[52:55], v[172:175], v[28:31]
    ds_read_b128 v[52:55], v12 offset:46080
    s_waitcnt lgkmcnt(5)
    v_mfma_f32_16x16x32_bf16 v[16:19], v[32:35], v[176:179], v[16:19]
    ds_read_b128 v[32:35], v13 offset:13312
    s_waitcnt lgkmcnt(5)
    v_mfma_f32_16x16x32_bf16 v[20:23], v[36:39], v[176:179], v[20:23]
    ds_read_b128 v[36:39], v13 offset:46080
    s_waitcnt lgkmcnt(5)
    v_mfma_f32_16x16x32_bf16 v[24:27], v[40:43], v[176:179], v[24:27]
    ds_read_b128 v[40:43], v12 offset:14336
    s_waitcnt lgkmcnt(5)
    v_mfma_f32_16x16x32_bf16 v[28:31], v[44:47], v[176:179], v[28:31]
    ds_read_b128 v[44:47], v12 offset:47104
    s_waitcnt lgkmcnt(5)
    v_mfma_f32_16x16x32_bf16 v[16:19], v[48:51], v[180:183], v[16:19]
    ds_read_b128 v[48:51], v13 offset:14336
    s_waitcnt lgkmcnt(5)
    v_mfma_f32_16x16x32_bf16 v[20:23], v[52:55], v[180:183], v[20:23]
    ds_read_b128 v[52:55], v13 offset:47104
    s_waitcnt lgkmcnt(5)
    v_mfma_f32_16x16x32_bf16 v[24:27], v[32:35], v[180:183], v[24:27]
    ds_read_b128 v[32:35], v12 offset:15360
    s_waitcnt lgkmcnt(5)
    v_mfma_f32_16x16x32_bf16 v[28:31], v[36:39], v[180:183], v[28:31]
    ds_read_b128 v[36:39], v12 offset:48128
    s_waitcnt lgkmcnt(5)
    v_mfma_f32_16x16x32_bf16 v[16:19], v[40:43], v[184:187], v[16:19]
    ds_read_b128 v[40:43], v13 offset:15360
    s_waitcnt lgkmcnt(5)
    v_mfma_f32_16x16x32_bf16 v[20:23], v[44:47], v[184:187], v[20:23]
    ds_read_b128 v[44:47], v13 offset:48128
    s_waitcnt lgkmcnt(5)
    v_mfma_f32_16x16x32_bf16 v[24:27], v[48:51], v[184:187], v[24:27]
    s_waitcnt lgkmcnt(4)
    v_mfma_f32_16x16x32_bf16 v[28:31], v[52:55], v[184:187], v[28:31]
    s_waitcnt lgkmcnt(3)
    v_mfma_f32_16x16x32_bf16 v[16:19], v[32:35], v[188:191], v[16:19]
    s_waitcnt lgkmcnt(2)
    v_mfma_f32_16x16x32_bf16 v[20:23], v[36:39], v[188:191], v[20:23]
    s_waitcnt lgkmcnt(1)
    v_mfma_f32_16x16x32_bf16 v[24:27], v[40:43], v[188:191], v[24:27]
    s_waitcnt lgkmcnt(0)
    v_mfma_f32_16x16x32_bf16 v[28:31], v[44:47], v[188:191], v[28:31]
    s_nop 7
    s_memtime s[40:41]
    s_waitcnt lgkmcnt(0)
    v_writelane_b32 v0, s40, 24
    s_lshl_b32 s32, s3, 11
    s_add_u32 s32, s32, 131072
    v_add_u32 v2, s32, v5
    s_cmp_eq_u32 s39, 0
    s_cbranch_scc0 p6_kh1
    ds_write_b128 v2, v[24:27] offset:0
    v_add_f32 v64, v16, v56
    v_add_f32 v65, v17, v57
    v_add_f32 v66, v18, v58
    v_add_f32 v67, v19, v59
    ds_write_b128 v2, v[28:31] offset:1024
    v_add_f32 v68, v20, v60
    v_add_f32 v69, v21, v61
    v_add_f32 v70, v22, v62
    v_add_f32 v71, v23, v63
    s_branch p6_x
p6_kh1:
    ds_write_b128 v2, v[16:19] offset:0
    v_add_f32 v64, v24, v56
    v_add_f32 v65, v25, v57
    v_add_f32 v66, v26, v58
    v_add_f32 v67, v27, v59
    ds_write_b128 v2, v[20:23] offset:1024
    v_add_f32 v68, v28, v60
    v_add_f32 v69, v29, v61
    v_add_f32 v70, v30, v62
    v_add_f32 v71, v31, v63
p6_x:
    s_xor_b32 s32, s3, 4
    s_lshl_b32 s32, s32, 11
    s_add_u32 s32, s32, 131072
    v_add_u32 v2, s32, v5
    s_waitcnt lgkmcnt(0)
    s_barrier
    ds_read_b128 v[16:19], v2
    ds_read_b128 v[20:23], v2 offset:1024
    s_waitcnt lgkmcnt(0)
    v_add_f32 v64, v64, v16
    v_add_f32 v65, v65, v17
    v_add_f32 v66, v66, v18
    v_add_f32 v67, v67, v19
    v_add_f32 v68, v68, v20
    v_add_f32 v69, v69, v21
    v_add_f32 v70, v70, v22
    v_add_f32 v71, v71, v23
    v_cvt_pk_bf16_f32 v16, v64, v65
    v_cvt_pk_bf16_f32 v17, v66, v67
    v_cvt_pk_bf16_f32 v18, v68, v69
    v_cvt_pk_bf16_f32 v19, v70, v71
    buffer_store_dwordx4 v[16:19], v7, s[52:55], s42 offen
    s_waitcnt vmcnt(0)
    s_memtime s[40:41]
    s_waitcnt lgkmcnt(0)
    v_writelane_b32 v0, s40, 25
    s_memrealtime s[40:41]
    s_waitcnt lgkmcnt(0)
    v_writelane_b32 v0, s40, 26
    s_mov_b32 s64, s28
    s_and_b32 s65, s29, 0xffff
    s_mov_b32 s66, 33554432
    s_mov_b32 s67, 0x20000
    s_lshl_b32 s40, s2, 3
    s_add_u32 s40, s40, s3
    s_lshl_b32 s40, s40, 8
    s_add_u32 s40, s40, 31457280
    v_lshlrev_b32 v2, 2, v1
    buffer_store_dword v0, v2, s[64:67], s40 offen
sequential_preLN__grouped_kv_mqa__mixer_gmlp__prompt_kernel_end:
    s_endpgm
.section .rodata,"a"
.p2align 6
.amdhsa_kernel sequential_preLN__grouped_kv_mqa__mixer_gmlp__prompt_kernel
  .amdhsa_next_free_vgpr 256
  .amdhsa_next_free_sgpr 100
  .amdhsa_accum_offset 256
  .amdhsa_group_segment_fixed_size 0
  .amdhsa_kernarg_size 104
  .amdhsa_user_sgpr_count 2
  .amdhsa_user_sgpr_kernarg_segment_ptr 1
  .amdhsa_system_sgpr_workgroup_id_x 1
  .amdhsa_float_denorm_mode_32 3
.end_amdhsa_kernel
```
